```python
import torch

def _softmax(x, axis=-1):
    return torch.softmax(x, dim=axis)
def _gelu(x):
    return torch.nn.functional.gelu(x, approximate="tanh")
def _silu(x):
    return torch.nn.functional.silu(x)
def _sigmoid(x):
    return torch.sigmoid(x)
def _layernorm(x, axis=-1, eps=1e-5):
    m = x.mean(dim=axis, keepdim=True)
    v = x.var(dim=axis, keepdim=True, unbiased=False)
    return (x - m) / torch.sqrt(v + eps)
def _scatter_add(tgt, idx, src, axis=0):
    return tgt.clone().index_add_(axis, idx, src)
def _segment_sum(src, seg, n):
    out = torch.zeros((n,) + src.shape[1:], dtype=src.dtype)
    return out.index_add_(0, seg, src)
def _pad(x, pw):
    flat = tuple(v for pair in reversed(pw) for v in pair)
    return torch.nn.functional.pad(x, flat)

kernel_name = 'parallel_sum__mha_block__swiglu_ffn__prompt'

def setup_inputs():

    _w = (lambda a: (lambda t: t.to(torch.bfloat16) if t.is_floating_point() else t)(torch.as_tensor(a)))
    def _A_setup():
        B, S, D, H = 1, 2048, 1024, 32
        return {
            "x": _w((lambda *s: torch.randn(*s, dtype=torch.bfloat16) * 0.05)(B, S, D)),
            "wqkv": _w((lambda *s: torch.randn(*s, dtype=torch.bfloat16) * 0.05)(D, 3 * D)),
            "wo": _w((lambda *s: torch.randn(*s, dtype=torch.bfloat16) * 0.05)(D, D)),
        }
    _A_in = _A_setup()

    def _B_setup():
        B, S, D, F = 1, 2048, 1024, 3584
        return {
            "x": _w((lambda *s: torch.randn(*s, dtype=torch.bfloat16) * 0.05)(B, S, D)),
            "w_gate": _w((lambda *s: torch.randn(*s, dtype=torch.bfloat16) * 0.05)(D, F)),
            "w_up": _w((lambda *s: torch.randn(*s, dtype=torch.bfloat16) * 0.05)(D, F)),
            "w_down": _w((lambda *s: torch.randn(*s, dtype=torch.bfloat16) * 0.05)(F, D)),
        }
    _B_in = _B_setup()

    return {
        "A_x": _A_in["x"],
        "A_wqkv": _A_in["wqkv"],
        "A_wo": _A_in["wo"],
        "B_x": _B_in["x"],
        "B_w_gate": _B_in["w_gate"],
        "B_w_up": _B_in["w_up"],
        "B_w_down": _B_in["w_down"],
    }

def reference(A_x, A_wqkv, A_wo, B_x, B_w_gate, B_w_up, B_w_down):
    def _A_ref(x, wqkv, wo):
        B, S, D = x.shape
        H = 32
        Dh = D // H
        qkv = (lambda x, *d: x.permute(*d))((x @ wqkv).reshape(B, S, 3, H, Dh), 2, 0, 3, 1, 4)
        q, k, v = qkv[0], qkv[1], qkv[2]
        scores = torch.einsum("bhqd,bhkd->bhqk", q, k) * (Dh ** -0.5)
        p = _softmax(scores, axis=-1)
        o = torch.einsum("bhqk,bhkd->bhqd", p, v)
        return (lambda x, *d: x.permute(*d))(o, 0, 2, 1, 3).reshape(B, S, D) @ wo

    def _B_ref(x, w_gate, w_up, w_down):
        g = _silu(x @ w_gate)
        u = x @ w_up
        return (g * u) @ w_down

    x = A_x
    xn = _layernorm(x, axis=-1)
    return x + _A_ref(xn, A_wqkv, A_wo) + _B_ref(xn, B_w_gate, B_w_up, B_w_down)
```

```asm
; @launch kernel=ln_kernel grid=(512,1,1) block=(256,1,1) lds=0
; @launch kernel=gemm1_kernel grid=(256,1,1) block=(512,1,1) lds=148480
; @launch kernel=attn_kernel grid=(512,1,1) block=(256,1,1) lds=81920
.amdgcn_target "amdgcn-amd-amdhsa--gfx950"
.text
.globl ln_kernel
.p2align 8
.type ln_kernel,@function
ln_kernel:
s_cmp_ge_u32 s2, 512
s_cbranch_scc1 L_k0_done
s_load_dwordx2 s[4:5], s[0:1], 0
s_load_dwordx2 s[6:7], s[0:1], 72
s_load_dwordx2 s[26:27], s[0:1], 8
s_load_dwordx2 s[28:29], s[0:1], 32
s_load_dwordx2 s[30:31], s[0:1], 40
v_and_b32 v1, 63, v0
v_lshrrev_b32 v2, 6, v0
s_lshl_b32 s3, s2, 2
v_add_u32 v2, s3, v2
v_lshlrev_b32 v2, 11, v2
v_lshl_add_u32 v2, v1, 4, v2
s_waitcnt lgkmcnt(0)
s_mov_b32 s8, s4
s_and_b32 s9, s5, 0xffff
s_mov_b32 s10, 4194304
s_mov_b32 s11, 0x00020000
s_mov_b32 s12, s6
s_and_b32 s13, s7, 0xffff
s_mov_b32 s14, 268435456
s_mov_b32 s15, 0x00020000
buffer_load_dwordx4 v[4:7], v2, s[8:11], 0 offen
buffer_load_dwordx4 v[8:11], v2, s[8:11], 0 offen offset:1024
s_mov_b32 s24, 0xffff0000
s_mov_b32 s32, s26
s_and_b32 s33, s27, 0xffff
s_mov_b32 s34, 1572864
s_mov_b32 s35, 0x00020000
s_mov_b32 s36, s28
s_and_b32 s37, s29, 0xffff
s_mov_b32 s38, 1835008
s_mov_b32 s39, 0x00020000
s_mov_b32 s40, s30
s_and_b32 s41, s31, 0xffff
s_mov_b32 s42, 1835008
s_mov_b32 s43, 0x00020000
v_lshrrev_b32 v3, 6, v0
v_add_u32 v3, s3, v3
v_lshlrev_b32 v13, 10, v3
v_lshl_add_u32 v13, v1, 4, v13
buffer_load_dwordx4 v[64:67], v13, s[32:35], 0 offen
buffer_load_dwordx4 v[68:71], v13, s[36:39], 0 offen
buffer_load_dwordx4 v[72:75], v13, s[40:43], 0 offen
s_waitcnt vmcnt(3)
v_lshlrev_b32 v16, 16, v4
v_and_b32 v17, s24, v4
v_lshlrev_b32 v18, 16, v5
v_and_b32 v19, s24, v5
v_lshlrev_b32 v20, 16, v6
v_and_b32 v21, s24, v6
v_lshlrev_b32 v22, 16, v7
v_and_b32 v23, s24, v7
v_lshlrev_b32 v24, 16, v8
v_and_b32 v25, s24, v8
v_lshlrev_b32 v26, 16, v9
v_and_b32 v27, s24, v9
v_lshlrev_b32 v28, 16, v10
v_and_b32 v29, s24, v10
v_lshlrev_b32 v30, 16, v11
v_and_b32 v31, s24, v11
v_add_f32 v32, v16, v17
v_add_f32 v33, v18, v19
v_add_f32 v34, v20, v21
v_add_f32 v35, v22, v23
v_add_f32 v36, v24, v25
v_add_f32 v37, v26, v27
v_add_f32 v38, v28, v29
v_add_f32 v39, v30, v31
v_add_f32 v32, v32, v36
v_add_f32 v33, v33, v37
v_add_f32 v34, v34, v38
v_add_f32 v35, v35, v39
v_add_f32 v32, v32, v34
v_add_f32 v33, v33, v35
v_add_f32 v40, v32, v33
s_nop 1
v_add_f32 v40, v40, v40 quad_perm:[1,0,3,2] row_mask:0xf bank_mask:0xf
s_nop 1
v_add_f32 v40, v40, v40 quad_perm:[2,3,0,1] row_mask:0xf bank_mask:0xf
s_nop 1
v_add_f32 v40, v40, v40 row_half_mirror row_mask:0xf bank_mask:0xf
s_nop 1
v_add_f32 v40, v40, v40 row_mirror row_mask:0xf bank_mask:0xf
s_nop 1
v_readlane_b32 s16, v40, 0
v_readlane_b32 s17, v40, 16
v_readlane_b32 s18, v40, 32
v_readlane_b32 s19, v40, 48
s_nop 1
v_mov_b32 v41, s16
v_add_f32 v41, s17, v41
v_add_f32 v41, s18, v41
v_add_f32 v41, s19, v41
v_mul_f32 v41, 0x3a800000, v41
v_sub_f32 v48, v16, v41
v_sub_f32 v49, v17, v41
v_sub_f32 v50, v18, v41
v_sub_f32 v51, v19, v41
v_sub_f32 v52, v20, v41
v_sub_f32 v53, v21, v41
v_sub_f32 v54, v22, v41
v_sub_f32 v55, v23, v41
v_sub_f32 v56, v24, v41
v_sub_f32 v57, v25, v41
v_sub_f32 v58, v26, v41
v_sub_f32 v59, v27, v41
v_sub_f32 v60, v28, v41
v_sub_f32 v61, v29, v41
v_sub_f32 v62, v30, v41
v_sub_f32 v63, v31, v41
v_mul_f32 v32, v48, v48
v_mul_f32 v33, v49, v49
v_mul_f32 v34, v50, v50
v_mul_f32 v35, v51, v51
v_fmac_f32 v32, v52, v52
v_fmac_f32 v33, v53, v53
v_fmac_f32 v34, v54, v54
v_fmac_f32 v35, v55, v55
v_fmac_f32 v32, v56, v56
v_fmac_f32 v33, v57, v57
v_fmac_f32 v34, v58, v58
v_fmac_f32 v35, v59, v59
v_fmac_f32 v32, v60, v60
v_fmac_f32 v33, v61, v61
v_fmac_f32 v34, v62, v62
v_fmac_f32 v35, v63, v63
v_add_f32 v32, v32, v33
v_add_f32 v34, v34, v35
v_add_f32 v40, v32, v34
s_nop 1
v_add_f32 v40, v40, v40 quad_perm:[1,0,3,2] row_mask:0xf bank_mask:0xf
s_nop 1
v_add_f32 v40, v40, v40 quad_perm:[2,3,0,1] row_mask:0xf bank_mask:0xf
s_nop 1
v_add_f32 v40, v40, v40 row_half_mirror row_mask:0xf bank_mask:0xf
s_nop 1
v_add_f32 v40, v40, v40 row_mirror row_mask:0xf bank_mask:0xf
s_nop 1
v_readlane_b32 s16, v40, 0
v_readlane_b32 s17, v40, 16
v_readlane_b32 s18, v40, 32
v_readlane_b32 s19, v40, 48
s_nop 1
v_mov_b32 v42, s16
v_add_f32 v42, s17, v42
v_add_f32 v42, s18, v42
v_add_f32 v42, s19, v42
v_mul_f32 v42, 0x3a800000, v42
v_cvt_pk_bf16_f32 v43, v41, v42
v_lshlrev_b32 v44, 16, v43
v_and_b32 v45, s24, v43
v_add_f32 v45, 0x3727c5ac, v45
v_cvt_pk_bf16_f32 v45, v45, v45
v_and_b32 v45, s24, v45
v_sqrt_f32 v45, v45
s_nop 0
v_cvt_pk_bf16_f32 v45, v45, v45
v_and_b32 v45, s24, v45
v_rcp_f32 v45, v45
v_sub_f32 v48, v16, v44
v_sub_f32 v49, v17, v44
v_sub_f32 v50, v18, v44
v_sub_f32 v51, v19, v44
v_sub_f32 v52, v20, v44
v_sub_f32 v53, v21, v44
v_sub_f32 v54, v22, v44
v_sub_f32 v55, v23, v44
v_sub_f32 v56, v24, v44
v_sub_f32 v57, v25, v44
v_sub_f32 v58, v26, v44
v_sub_f32 v59, v27, v44
v_sub_f32 v60, v28, v44
v_sub_f32 v61, v29, v44
v_sub_f32 v62, v30, v44
v_sub_f32 v63, v31, v44
v_cvt_pk_bf16_f32 v32, v48, v49
v_cvt_pk_bf16_f32 v33, v50, v51
v_cvt_pk_bf16_f32 v34, v52, v53
v_cvt_pk_bf16_f32 v35, v54, v55
v_cvt_pk_bf16_f32 v36, v56, v57
v_cvt_pk_bf16_f32 v37, v58, v59
v_cvt_pk_bf16_f32 v38, v60, v61
v_cvt_pk_bf16_f32 v39, v62, v63
v_lshlrev_b32 v48, 16, v32
v_and_b32 v49, s24, v32
v_lshlrev_b32 v50, 16, v33
v_and_b32 v51, s24, v33
v_lshlrev_b32 v52, 16, v34
v_and_b32 v53, s24, v34
v_lshlrev_b32 v54, 16, v35
v_and_b32 v55, s24, v35
v_lshlrev_b32 v56, 16, v36
v_and_b32 v57, s24, v36
v_lshlrev_b32 v58, 16, v37
v_and_b32 v59, s24, v37
v_lshlrev_b32 v60, 16, v38
v_and_b32 v61, s24, v38
v_lshlrev_b32 v62, 16, v39
v_and_b32 v63, s24, v39
v_mul_f32 v48, v48, v45
v_mul_f32 v49, v49, v45
v_mul_f32 v50, v50, v45
v_mul_f32 v51, v51, v45
v_mul_f32 v52, v52, v45
v_mul_f32 v53, v53, v45
v_mul_f32 v54, v54, v45
v_mul_f32 v55, v55, v45
v_mul_f32 v56, v56, v45
v_mul_f32 v57, v57, v45
v_mul_f32 v58, v58, v45
v_mul_f32 v59, v59, v45
v_mul_f32 v60, v60, v45
v_mul_f32 v61, v61, v45
v_mul_f32 v62, v62, v45
v_mul_f32 v63, v63, v45
v_cvt_pk_bf16_f32 v4, v48, v49
v_cvt_pk_bf16_f32 v5, v50, v51
v_cvt_pk_bf16_f32 v6, v52, v53
v_cvt_pk_bf16_f32 v7, v54, v55
v_cvt_pk_bf16_f32 v8, v56, v57
v_cvt_pk_bf16_f32 v9, v58, v59
v_cvt_pk_bf16_f32 v10, v60, v61
v_cvt_pk_bf16_f32 v11, v62, v63
v_lshrrev_b32 v3, 6, v0
v_add_u32 v3, s3, v3
v_cmp_gt_u32 vcc, 17, v3
s_and_saveexec_b64 s[20:21], vcc
s_cbranch_execz L_k0_noflag
v_lshlrev_b32 v3, 10, v3
v_lshl_add_u32 v3, v1, 4, v3
v_add_u32 v3, 50331648, v3
v_mov_b32 v12, 0
v_mov_b32 v13, 0
v_mov_b32 v14, 0
v_mov_b32 v15, 0
buffer_store_dwordx4 v[12:15], v3, s[12:15], 0 offen
L_k0_noflag:
s_mov_b64 exec, s[20:21]
v_and_b32 v3, 1, v1
v_lshlrev_b32 v3, 3, v3
v_sub_u32 v3, v2, v3
buffer_store_dwordx2 v[4:5], v3, s[12:15], 0 offen offset:0
buffer_store_dwordx2 v[6:7], v3, s[12:15], 0 offen offset:16
buffer_store_dwordx2 v[8:9], v3, s[12:15], 0 offen offset:1024
buffer_store_dwordx2 v[10:11], v3, s[12:15], 0 offen offset:1040
L_k0_done:
s_endpgm
.globl gemm1_kernel
.p2align 8
.type gemm1_kernel,@function
gemm1_kernel:
s_cmp_ge_u32 s2, 256
s_cbranch_scc1 L_k1_done
s_load_dwordx2 s[4:5], s[0:1], 8
s_load_dwordx2 s[6:7], s[0:1], 32
s_load_dwordx2 s[8:9], s[0:1], 40
s_load_dwordx2 s[10:11], s[0:1], 72
s_load_dwordx2 s[100:101], s[0:1], 48
s_and_b32 s28, s2, 31
s_lshr_b32 s29, s2, 5
v_and_b32 v1, 63, v0
v_lshrrev_b32 v11, 6, v0
s_nop 0
v_readfirstlane_b32 s30, v11
s_nop 3
s_and_b32 s31, s30, 3
v_and_b32 v11, 15, v1
s_lshl_b32 s62, s31, 6
v_add_u32 v11, s62, v11
v_lshlrev_b32 v11, 6, v11
v_bfe_u32 v12, v1, 2, 2
v_and_b32 v13, 1, v12
v_lshlrev_b32 v13, 1, v13
v_lshrrev_b32 v14, 1, v12
v_or_b32 v13, v13, v14
v_lshlrev_b32 v14, 1, v14
v_xor_b32 v13, v13, v14
v_lshrrev_b32 v12, 4, v1
v_xor_b32 v12, v12, v13
v_lshl_add_u32 v2, v12, 4, v11
v_lshrrev_b32 v11, 5, v1
v_lshlrev_b32 v11, 4, v11
v_bfe_u32 v12, v1, 4, 1
v_lshl_add_u32 v11, v12, 2, v11
v_bfe_u32 v13, v1, 2, 2
v_add_u32 v11, v11, v13
v_and_b32 v13, 3, v1
v_lshlrev_b32 v13, 3, v13
v_mul_u32_u24 v14, 192, v11
v_add_u32 v14, v14, v13
v_add_u32 v14, 65536, v14
v_lshl_add_u32 v3, v12, 5, v14
v_xor_b32 v12, 1, v12
v_lshl_add_u32 v4, v12, 5, v14
v_mul_u32_u24 v5, 224, v11
v_add_u32 v5, v5, v13
v_add_u32 v5, 90112, v5
s_lshl_b32 s62, s29, 8
s_lshl_b32 s63, s30, 5
s_add_u32 s62, s62, s63
v_lshrrev_b32 v11, 2, v1
v_add_u32 v11, s62, v11
v_lshlrev_b32 v11, 11, v11
v_bfe_u32 v12, v1, 4, 2
v_and_b32 v13, 1, v12
v_lshlrev_b32 v13, 1, v13
v_lshrrev_b32 v14, 1, v12
v_or_b32 v13, v13, v14
v_lshlrev_b32 v14, 1, v14
v_xor_b32 v13, v13, v14
v_and_b32 v12, 3, v1
v_xor_b32 v12, v12, v13
v_lshl_add_u32 v6, v12, 4, v11
v_add_u32 v7, 32768, v6
s_lshl_b32 s62, s30, 11
s_add_u32 s40, s62, 0
s_add_u32 s44, s62, 1024
s_add_u32 s41, s62, 16384
s_add_u32 s45, s62, 17408
s_add_u32 s42, s62, 32768
s_add_u32 s46, s62, 33792
s_add_u32 s43, s62, 49152
s_add_u32 s47, s62, 50176
s_mov_b32 s32, 0
s_cmp_ge_u32 s30, 4
s_cbranch_scc1 L_k1_path1
s_add_u32 s84, s31, 0
s_sub_u32 s63, s84, 6
s_mov_b32 s36, 229376
s_mov_b32 s64, 90112
s_mov_b32 s65, 14592
s_sub_u32 s67, s84, 13
s_cmp_ge_u32 s84, 13
s_cselect_b32 s63, s67, s63
s_cselect_b32 s64, 97408, s64
s_cmp_lt_u32 s84, 6
s_cselect_b32 s63, s84, s63
s_cselect_b32 s36, 196608, s36
s_cselect_b32 s64, 65536, s64
s_cselect_b32 s65, 6144, s65
s_cselect_b64 s[68:69], -1, 0
s_lshl_b32 s66, s63, 10
s_add_u32 s48, s64, s66
s_add_u32 s49, s48, s65
s_add_u32 s50, s49, s65
s_add_u32 s51, s50, s65
s_mov_b32 s33, 0
s_lshl_b32 s66, s63, 6
v_add_u32 v11, s66, v1
v_mul_u32_u24 v12, 5462, v11
v_lshrrev_b32 v12, 16, v12
v_mul_u32_u24 v13, 12, v12
v_sub_u32 v13, v11, v13
v_mul_u32_u24 v14, 6144, v12
v_bfe_u32 v12, v12, 2, 1
v_lshlrev_b32 v12, 1, v12
v_xor_b32 v13, v13, v12
v_lshrrev_b32 v12, 2, v13
v_lshl_add_u32 v14, v12, 11, v14
v_and_b32 v12, 3, v13
v_lshl_add_u32 v14, v12, 4, v14
s_lshl_b32 s66, s28, 6
v_add_u32 v14, s66, v14
v_mul_u32_u24 v12, 4682, v11
v_lshrrev_b32 v12, 16, v12
v_mul_u32_u24 v13, 14, v12
v_sub_u32 v13, v11, v13
v_mul_u32_u24 v15, 7168, v12
v_lshl_add_u32 v15, v13, 4, v15
s_mul_i32 s66, s28, 224
v_add_u32 v15, s66, v15
v_cndmask_b32 v8, v15, v14, s[68:69]
s_add_u32 s85, s31, 4
s_sub_u32 s63, s85, 6
s_mov_b32 s37, 229376
s_mov_b32 s64, 90112
s_mov_b32 s65, 14592
s_sub_u32 s67, s85, 13
s_cmp_ge_u32 s85, 13
s_cselect_b32 s63, s67, s63
s_cselect_b32 s64, 97408, s64
s_cmp_lt_u32 s85, 6
s_cselect_b32 s63, s85, s63
s_cselect_b32 s37, 196608, s37
s_cselect_b32 s64, 65536, s64
s_cselect_b32 s65, 6144, s65
s_cselect_b64 s[68:69], -1, 0
s_lshl_b32 s66, s63, 10
s_add_u32 s52, s64, s66
s_add_u32 s53, s52, s65
s_add_u32 s54, s53, s65
s_add_u32 s55, s54, s65
s_mov_b32 s34, 0
s_lshl_b32 s66, s63, 6
v_add_u32 v11, s66, v1
v_mul_u32_u24 v12, 5462, v11
v_lshrrev_b32 v12, 16, v12
v_mul_u32_u24 v13, 12, v12
v_sub_u32 v13, v11, v13
v_mul_u32_u24 v14, 6144, v12
v_bfe_u32 v12, v12, 2, 1
v_lshlrev_b32 v12, 1, v12
v_xor_b32 v13, v13, v12
v_lshrrev_b32 v12, 2, v13
v_lshl_add_u32 v14, v12, 11, v14
v_and_b32 v12, 3, v13
v_lshl_add_u32 v14, v12, 4, v14
s_lshl_b32 s66, s28, 6
v_add_u32 v14, s66, v14
v_mul_u32_u24 v12, 4682, v11
v_lshrrev_b32 v12, 16, v12
v_mul_u32_u24 v13, 14, v12
v_sub_u32 v13, v11, v13
v_mul_u32_u24 v15, 7168, v12
v_lshl_add_u32 v15, v13, 4, v15
s_mul_i32 s66, s28, 224
v_add_u32 v15, s66, v15
v_cndmask_b32 v9, v15, v14, s[68:69]
s_add_u32 s86, s31, 8
s_sub_u32 s63, s86, 6
s_mov_b32 s38, 229376
s_mov_b32 s64, 90112
s_mov_b32 s65, 14592
s_sub_u32 s67, s86, 13
s_cmp_ge_u32 s86, 13
s_cselect_b32 s63, s67, s63
s_cselect_b32 s64, 97408, s64
s_cmp_lt_u32 s86, 6
s_cselect_b32 s63, s86, s63
s_cselect_b32 s38, 196608, s38
s_cselect_b32 s64, 65536, s64
s_cselect_b32 s65, 6144, s65
s_cselect_b64 s[68:69], -1, 0
s_lshl_b32 s66, s63, 10
s_add_u32 s56, s64, s66
s_add_u32 s57, s56, s65
s_add_u32 s58, s57, s65
s_add_u32 s59, s58, s65
s_mov_b32 s35, 0
s_lshl_b32 s66, s63, 6
v_add_u32 v11, s66, v1
v_mul_u32_u24 v12, 5462, v11
v_lshrrev_b32 v12, 16, v12
v_mul_u32_u24 v13, 12, v12
v_sub_u32 v13, v11, v13
v_mul_u32_u24 v14, 6144, v12
v_bfe_u32 v12, v12, 2, 1
v_lshlrev_b32 v12, 1, v12
v_xor_b32 v13, v13, v12
v_lshrrev_b32 v12, 2, v13
v_lshl_add_u32 v14, v12, 11, v14
v_and_b32 v12, 3, v13
v_lshl_add_u32 v14, v12, 4, v14
s_lshl_b32 s66, s28, 6
v_add_u32 v14, s66, v14
v_mul_u32_u24 v12, 4682, v11
v_lshrrev_b32 v12, 16, v12
v_mul_u32_u24 v13, 14, v12
v_sub_u32 v13, v11, v13
v_mul_u32_u24 v15, 7168, v12
v_lshl_add_u32 v15, v13, 4, v15
s_mul_i32 s66, s28, 224
v_add_u32 v15, s66, v15
v_cndmask_b32 v10, v15, v14, s[68:69]
s_mov_b32 s60, 0
s_mov_b32 s61, 0
s_lshr_b32 s83, s29, 2
s_and_b32 s62, s29, 3
s_add_u32 s62, s62, 5
s_mul_i32 s80, s62, s36
s_mul_i32 s81, s62, s37
s_mul_i32 s82, s62, s38
s_waitcnt lgkmcnt(0)
s_mov_b32 s12, s10
s_and_b32 s13, s11, 0xffff
s_mov_b32 s14, 268435456
s_mov_b32 s15, 0x00020000
s_mov_b32 s16, s4
s_mov_b32 s17, s5
s_mov_b32 s18, 6291456
s_mov_b32 s19, 0x00020000
s_and_b32 s17, s17, 0xffff
s_mov_b32 s20, s4
s_mov_b32 s21, s5
s_mov_b32 s22, 6291456
s_mov_b32 s23, 0x00020000
s_cmp_ge_u32 s85, 6
s_cselect_b32 s20, s6, s20
s_cselect_b32 s21, s7, s21
s_cselect_b32 s22, 7340032, s22
s_and_b32 s21, s21, 0xffff
s_mov_b32 s24, s6
s_mov_b32 s25, s7
s_mov_b32 s26, 7340032
s_mov_b32 s27, 0x00020000
s_and_b32 s25, s25, 0xffff
s_mov_b32 m0, s40
s_nop 0
buffer_load_dwordx4 v6, s[12:15], s32 offen lds
s_mov_b32 m0, s44
s_nop 0
buffer_load_dwordx4 v7, s[12:15], s32 offen lds
s_mov_b32 m0, s48
s_nop 0
buffer_load_dwordx4 v8, s[16:19], s33 offen lds
s_mov_b32 m0, s52
s_nop 0
buffer_load_dwordx4 v9, s[20:23], s34 offen lds
s_mov_b32 m0, s56
s_nop 0
buffer_load_dwordx4 v10, s[24:27], s35 offen lds
s_add_u32 s32, s32, 64
s_add_u32 s33, s33, s36
s_add_u32 s34, s34, s37
s_add_u32 s35, s35, s38
s_mov_b32 m0, s41
s_nop 0
buffer_load_dwordx4 v6, s[12:15], s32 offen lds
s_mov_b32 m0, s45
s_nop 0
buffer_load_dwordx4 v7, s[12:15], s32 offen lds
s_mov_b32 m0, s49
s_nop 0
buffer_load_dwordx4 v8, s[16:19], s33 offen lds
s_mov_b32 m0, s53
s_nop 0
buffer_load_dwordx4 v9, s[20:23], s34 offen lds
s_mov_b32 m0, s57
s_nop 0
buffer_load_dwordx4 v10, s[24:27], s35 offen lds
s_add_u32 s32, s32, 64
s_add_u32 s33, s33, s36
s_add_u32 s34, s34, s37
s_add_u32 s35, s35, s38
s_mov_b32 s84, s100
s_and_b32 s85, s101, 0xffff
s_mov_b32 s86, 7340032
s_mov_b32 s87, 0x00020000
s_lshl_b32 s39, s2, 3
s_add_u32 s39, s39, s30
s_lshl_b32 s39, s39, 10
s_sub_u32 s39, s39, 6291456
v_lshlrev_b32 v11, 4, v1
s_waitcnt vmcnt(5)
s_barrier
ds_read_b128 v[16:19], v2 offset:0
ds_read_b128 v[20:23], v2 offset:1024
ds_read_b128 v[24:27], v2 offset:2048
ds_read_b128 v[28:31], v2 offset:3072
ds_read_b64_tr_b16 v[48:49], v3 offset:0
ds_read_b64_tr_b16 v[50:51], v3 offset:1536
ds_read_b64_tr_b16 v[52:53], v4 offset:0
ds_read_b64_tr_b16 v[54:55], v4 offset:1536
ds_read_b64_tr_b16 v[56:57], v3 offset:64
ds_read_b64_tr_b16 v[58:59], v3 offset:1600
ds_read_b64_tr_b16 v[60:61], v4 offset:64
ds_read_b64_tr_b16 v[62:63], v4 offset:1600
s_waitcnt lgkmcnt(6)
v_mfma_f32_16x16x32_bf16 v[96:99], v[48:51], v[16:19], 0
v_mfma_f32_16x16x32_bf16 v[100:103], v[48:51], v[20:23], 0
v_mfma_f32_16x16x32_bf16 v[104:107], v[48:51], v[24:27], 0
v_mfma_f32_16x16x32_bf16 v[108:111], v[48:51], v[28:31], 0
ds_read_b64_tr_b16 v[48:49], v3 offset:128
ds_read_b64_tr_b16 v[50:51], v3 offset:1664
s_mov_b32 m0, s42
s_nop 0
buffer_load_dwordx4 v6, s[12:15], s32 offen lds
s_mov_b32 m0, s46
s_nop 0
buffer_load_dwordx4 v7, s[12:15], s32 offen lds
s_mov_b32 m0, s50
s_nop 0
buffer_load_dwordx4 v8, s[16:19], s33 offen lds
s_mov_b32 m0, s54
s_nop 0
buffer_load_dwordx4 v9, s[20:23], s34 offen lds
s_mov_b32 m0, s58
s_nop 0
buffer_load_dwordx4 v10, s[24:27], s35 offen lds
s_add_u32 s32, s32, 64
s_add_u32 s33, s33, s36
s_add_u32 s34, s34, s37
s_add_u32 s35, s35, s38
s_waitcnt lgkmcnt(6)
v_mfma_f32_16x16x32_bf16 v[112:115], v[52:55], v[16:19], 0
v_mfma_f32_16x16x32_bf16 v[116:119], v[52:55], v[20:23], 0
v_mfma_f32_16x16x32_bf16 v[120:123], v[52:55], v[24:27], 0
v_mfma_f32_16x16x32_bf16 v[124:127], v[52:55], v[28:31], 0
ds_read_b64_tr_b16 v[52:53], v4 offset:128
ds_read_b64_tr_b16 v[54:55], v4 offset:1664
s_waitcnt lgkmcnt(6)
v_mfma_f32_16x16x32_bf16 v[128:131], v[56:59], v[16:19], 0
v_mfma_f32_16x16x32_bf16 v[132:135], v[56:59], v[20:23], 0
v_mfma_f32_16x16x32_bf16 v[136:139], v[56:59], v[24:27], 0
v_mfma_f32_16x16x32_bf16 v[140:143], v[56:59], v[28:31], 0
ds_read_b64_tr_b16 v[56:57], v5 offset:0
ds_read_b64_tr_b16 v[58:59], v5 offset:1792
s_waitcnt lgkmcnt(6)
v_mfma_f32_16x16x32_bf16 v[144:147], v[60:63], v[16:19], 0
v_mfma_f32_16x16x32_bf16 v[148:151], v[60:63], v[20:23], 0
v_mfma_f32_16x16x32_bf16 v[152:155], v[60:63], v[24:27], 0
v_mfma_f32_16x16x32_bf16 v[156:159], v[60:63], v[28:31], 0
ds_read_b64_tr_b16 v[60:61], v5 offset:7296
ds_read_b64_tr_b16 v[62:63], v5 offset:9088
s_waitcnt lgkmcnt(6)
v_mfma_f32_16x16x32_bf16 v[160:163], v[16:19], v[48:51], 0
v_mfma_f32_16x16x32_bf16 v[164:167], v[20:23], v[48:51], 0
v_mfma_f32_16x16x32_bf16 v[168:171], v[24:27], v[48:51], 0
v_mfma_f32_16x16x32_bf16 v[172:175], v[28:31], v[48:51], 0
ds_read_b64_tr_b16 v[48:49], v5 offset:32
ds_read_b64_tr_b16 v[50:51], v5 offset:1824
s_waitcnt lgkmcnt(6)
v_mfma_f32_16x16x32_bf16 v[176:179], v[16:19], v[52:55], 0
v_mfma_f32_16x16x32_bf16 v[180:183], v[20:23], v[52:55], 0
v_mfma_f32_16x16x32_bf16 v[184:187], v[24:27], v[52:55], 0
v_mfma_f32_16x16x32_bf16 v[188:191], v[28:31], v[52:55], 0
ds_read_b64_tr_b16 v[52:53], v5 offset:7328
ds_read_b64_tr_b16 v[54:55], v5 offset:9120
s_waitcnt vmcnt(5)
s_barrier
ds_read_b128 v[32:35], v2 offset:16384
ds_read_b128 v[36:39], v2 offset:17408
ds_read_b128 v[40:43], v2 offset:18432
ds_read_b128 v[44:47], v2 offset:19456
s_waitcnt lgkmcnt(10)
s_mov_b32 m0, s43
v_mfma_f32_16x16x32_bf16 v[192:195], v[56:59], v[16:19], 0
buffer_load_dwordx4 v6, s[12:15], s32 offen lds
v_mfma_f32_16x16x32_bf16 v[196:199], v[56:59], v[20:23], 0
v_mfma_f32_16x16x32_bf16 v[200:203], v[56:59], v[24:27], 0
v_mfma_f32_16x16x32_bf16 v[204:207], v[56:59], v[28:31], 0
ds_read_b64_tr_b16 v[56:57], v3 offset:6144
ds_read_b64_tr_b16 v[58:59], v3 offset:7680
s_waitcnt lgkmcnt(10)
s_mov_b32 m0, s47
v_mfma_f32_16x16x32_bf16 v[208:211], v[60:63], v[16:19], 0
buffer_load_dwordx4 v7, s[12:15], s32 offen lds
v_mfma_f32_16x16x32_bf16 v[212:215], v[60:63], v[20:23], 0
v_mfma_f32_16x16x32_bf16 v[216:219], v[60:63], v[24:27], 0
v_mfma_f32_16x16x32_bf16 v[220:223], v[60:63], v[28:31], 0
ds_read_b64_tr_b16 v[60:61], v4 offset:6144
ds_read_b64_tr_b16 v[62:63], v4 offset:7680
s_waitcnt lgkmcnt(10)
s_mov_b32 m0, s51
v_mfma_f32_16x16x32_bf16 v[224:227], v[48:51], v[16:19], 0
buffer_load_dwordx4 v8, s[16:19], s33 offen lds
v_mfma_f32_16x16x32_bf16 v[228:231], v[48:51], v[20:23], 0
v_mfma_f32_16x16x32_bf16 v[232:235], v[48:51], v[24:27], 0
v_mfma_f32_16x16x32_bf16 v[236:239], v[48:51], v[28:31], 0
ds_read_b64_tr_b16 v[48:49], v3 offset:6208
ds_read_b64_tr_b16 v[50:51], v3 offset:7744
s_waitcnt lgkmcnt(10)
s_mov_b32 m0, s55
v_mfma_f32_16x16x32_bf16 v[240:243], v[52:55], v[16:19], 0
buffer_load_dwordx4 v9, s[20:23], s34 offen lds
v_mfma_f32_16x16x32_bf16 v[244:247], v[52:55], v[20:23], 0
v_mfma_f32_16x16x32_bf16 v[248:251], v[52:55], v[24:27], 0
s_mov_b32 m0, s59
s_nop 0
buffer_load_dwordx4 v10, s[24:27], s35 offen lds
v_mfma_f32_16x16x32_bf16 v[252:255], v[52:55], v[28:31], 0
s_cmp_eq_u32 s61, s83
s_cbranch_scc0 L_k1_pfskip_1
s_add_u32 s62, s80, s33
buffer_load_dwordx4 v[68:71], v8, s[16:19], s62 offen
s_add_u32 s62, s81, s34
buffer_load_dwordx4 v[72:75], v9, s[20:23], s62 offen
s_add_u32 s62, s82, s35
buffer_load_dwordx4 v[76:79], v10, s[24:27], s62 offen
L_k1_pfskip_1:
s_xor_b32 s61, s61, 1
buffer_load_dwordx4 v[80:83], v11, s[84:87], s39 offen
s_add_u32 s39, s39, 2097152
ds_read_b64_tr_b16 v[52:53], v4 offset:6208
ds_read_b64_tr_b16 v[54:55], v4 offset:7744
s_add_u32 s32, s32, 64
s_add_u32 s33, s33, s36
s_add_u32 s34, s34, s37
s_add_u32 s35, s35, s38
s_waitcnt lgkmcnt(6)
v_mfma_f32_16x16x32_bf16 v[96:99], v[56:59], v[32:35], v[96:99]
v_mfma_f32_16x16x32_bf16 v[100:103], v[56:59], v[36:39], v[100:103]
v_mfma_f32_16x16x32_bf16 v[104:107], v[56:59], v[40:43], v[104:107]
v_mfma_f32_16x16x32_bf16 v[108:111], v[56:59], v[44:47], v[108:111]
ds_read_b64_tr_b16 v[56:57], v3 offset:6272
ds_read_b64_tr_b16 v[58:59], v3 offset:7808
s_waitcnt lgkmcnt(6)
v_mfma_f32_16x16x32_bf16 v[112:115], v[60:63], v[32:35], v[112:115]
v_mfma_f32_16x16x32_bf16 v[116:119], v[60:63], v[36:39], v[116:119]
v_mfma_f32_16x16x32_bf16 v[120:123], v[60:63], v[40:43], v[120:123]
v_mfma_f32_16x16x32_bf16 v[124:127], v[60:63], v[44:47], v[124:127]
ds_read_b64_tr_b16 v[60:61], v4 offset:6272
ds_read_b64_tr_b16 v[62:63], v4 offset:7808
s_waitcnt lgkmcnt(6)
v_mfma_f32_16x16x32_bf16 v[128:131], v[48:51], v[32:35], v[128:131]
v_mfma_f32_16x16x32_bf16 v[132:135], v[48:51], v[36:39], v[132:135]
v_mfma_f32_16x16x32_bf16 v[136:139], v[48:51], v[40:43], v[136:139]
v_mfma_f32_16x16x32_bf16 v[140:143], v[48:51], v[44:47], v[140:143]
ds_read_b64_tr_b16 v[48:49], v5 offset:14592
ds_read_b64_tr_b16 v[50:51], v5 offset:16384
s_waitcnt lgkmcnt(6)
v_mfma_f32_16x16x32_bf16 v[144:147], v[52:55], v[32:35], v[144:147]
v_mfma_f32_16x16x32_bf16 v[148:151], v[52:55], v[36:39], v[148:151]
v_mfma_f32_16x16x32_bf16 v[152:155], v[52:55], v[40:43], v[152:155]
v_mfma_f32_16x16x32_bf16 v[156:159], v[52:55], v[44:47], v[156:159]
ds_read_b64_tr_b16 v[52:53], v5 offset:21888
ds_read_b64_tr_b16 v[54:55], v5 offset:23680
s_waitcnt lgkmcnt(6)
v_mfma_f32_16x16x32_bf16 v[160:163], v[32:35], v[56:59], v[160:163]
v_mfma_f32_16x16x32_bf16 v[164:167], v[36:39], v[56:59], v[164:167]
v_mfma_f32_16x16x32_bf16 v[168:171], v[40:43], v[56:59], v[168:171]
v_mfma_f32_16x16x32_bf16 v[172:175], v[44:47], v[56:59], v[172:175]
ds_read_b64_tr_b16 v[56:57], v5 offset:14624
ds_read_b64_tr_b16 v[58:59], v5 offset:16416
s_waitcnt lgkmcnt(6)
v_mfma_f32_16x16x32_bf16 v[176:179], v[32:35], v[60:63], v[176:179]
v_mfma_f32_16x16x32_bf16 v[180:183], v[36:39], v[60:63], v[180:183]
v_mfma_f32_16x16x32_bf16 v[184:187], v[40:43], v[60:63], v[184:187]
v_mfma_f32_16x16x32_bf16 v[188:191], v[44:47], v[60:63], v[188:191]
ds_read_b64_tr_b16 v[60:61], v5 offset:21920
ds_read_b64_tr_b16 v[62:63], v5 offset:23712
s_waitcnt vmcnt(5)
s_barrier
ds_read_b128 v[16:19], v2 offset:32768
ds_read_b128 v[20:23], v2 offset:33792
ds_read_b128 v[24:27], v2 offset:34816
ds_read_b128 v[28:31], v2 offset:35840
s_waitcnt lgkmcnt(10)
s_mov_b32 m0, s40
v_mfma_f32_16x16x32_bf16 v[192:195], v[48:51], v[32:35], v[192:195]
buffer_load_dwordx4 v6, s[12:15], s32 offen lds
v_mfma_f32_16x16x32_bf16 v[196:199], v[48:51], v[36:39], v[196:199]
v_mfma_f32_16x16x32_bf16 v[200:203], v[48:51], v[40:43], v[200:203]
v_mfma_f32_16x16x32_bf16 v[204:207], v[48:51], v[44:47], v[204:207]
ds_read_b64_tr_b16 v[48:49], v3 offset:12288
ds_read_b64_tr_b16 v[50:51], v3 offset:13824
s_waitcnt lgkmcnt(10)
s_mov_b32 m0, s44
v_mfma_f32_16x16x32_bf16 v[208:211], v[52:55], v[32:35], v[208:211]
buffer_load_dwordx4 v7, s[12:15], s32 offen lds
v_mfma_f32_16x16x32_bf16 v[212:215], v[52:55], v[36:39], v[212:215]
v_mfma_f32_16x16x32_bf16 v[216:219], v[52:55], v[40:43], v[216:219]
v_mfma_f32_16x16x32_bf16 v[220:223], v[52:55], v[44:47], v[220:223]
ds_read_b64_tr_b16 v[52:53], v4 offset:12288
ds_read_b64_tr_b16 v[54:55], v4 offset:13824
s_waitcnt lgkmcnt(10)
s_mov_b32 m0, s48
v_mfma_f32_16x16x32_bf16 v[224:227], v[56:59], v[32:35], v[224:227]
buffer_load_dwordx4 v8, s[16:19], s33 offen lds
v_mfma_f32_16x16x32_bf16 v[228:231], v[56:59], v[36:39], v[228:231]
v_mfma_f32_16x16x32_bf16 v[232:235], v[56:59], v[40:43], v[232:235]
v_mfma_f32_16x16x32_bf16 v[236:239], v[56:59], v[44:47], v[236:239]
ds_read_b64_tr_b16 v[56:57], v3 offset:12352
ds_read_b64_tr_b16 v[58:59], v3 offset:13888
s_waitcnt lgkmcnt(10)
s_mov_b32 m0, s52
v_mfma_f32_16x16x32_bf16 v[240:243], v[60:63], v[32:35], v[240:243]
buffer_load_dwordx4 v9, s[20:23], s34 offen lds
v_mfma_f32_16x16x32_bf16 v[244:247], v[60:63], v[36:39], v[244:247]
v_mfma_f32_16x16x32_bf16 v[248:251], v[60:63], v[40:43], v[248:251]
s_mov_b32 m0, s56
s_nop 0
buffer_load_dwordx4 v10, s[24:27], s35 offen lds
v_mfma_f32_16x16x32_bf16 v[252:255], v[60:63], v[44:47], v[252:255]
ds_read_b64_tr_b16 v[60:61], v4 offset:12352
ds_read_b64_tr_b16 v[62:63], v4 offset:13888
s_add_u32 s32, s32, 64
s_add_u32 s33, s33, s36
s_add_u32 s34, s34, s37
s_add_u32 s35, s35, s38
s_waitcnt lgkmcnt(6)
v_mfma_f32_16x16x32_bf16 v[96:99], v[48:51], v[16:19], v[96:99]
v_mfma_f32_16x16x32_bf16 v[100:103], v[48:51], v[20:23], v[100:103]
v_mfma_f32_16x16x32_bf16 v[104:107], v[48:51], v[24:27], v[104:107]
v_mfma_f32_16x16x32_bf16 v[108:111], v[48:51], v[28:31], v[108:111]
ds_read_b64_tr_b16 v[48:49], v3 offset:12416
ds_read_b64_tr_b16 v[50:51], v3 offset:13952
s_waitcnt lgkmcnt(6)
v_mfma_f32_16x16x32_bf16 v[112:115], v[52:55], v[16:19], v[112:115]
v_mfma_f32_16x16x32_bf16 v[116:119], v[52:55], v[20:23], v[116:119]
v_mfma_f32_16x16x32_bf16 v[120:123], v[52:55], v[24:27], v[120:123]
v_mfma_f32_16x16x32_bf16 v[124:127], v[52:55], v[28:31], v[124:127]
ds_read_b64_tr_b16 v[52:53], v4 offset:12416
ds_read_b64_tr_b16 v[54:55], v4 offset:13952
s_waitcnt lgkmcnt(6)
v_mfma_f32_16x16x32_bf16 v[128:131], v[56:59], v[16:19], v[128:131]
v_mfma_f32_16x16x32_bf16 v[132:135], v[56:59], v[20:23], v[132:135]
v_mfma_f32_16x16x32_bf16 v[136:139], v[56:59], v[24:27], v[136:139]
v_mfma_f32_16x16x32_bf16 v[140:143], v[56:59], v[28:31], v[140:143]
ds_read_b64_tr_b16 v[56:57], v5 offset:29184
ds_read_b64_tr_b16 v[58:59], v5 offset:30976
s_waitcnt lgkmcnt(6)
v_mfma_f32_16x16x32_bf16 v[144:147], v[60:63], v[16:19], v[144:147]
v_mfma_f32_16x16x32_bf16 v[148:151], v[60:63], v[20:23], v[148:151]
v_mfma_f32_16x16x32_bf16 v[152:155], v[60:63], v[24:27], v[152:155]
v_mfma_f32_16x16x32_bf16 v[156:159], v[60:63], v[28:31], v[156:159]
ds_read_b64_tr_b16 v[60:61], v5 offset:36480
ds_read_b64_tr_b16 v[62:63], v5 offset:38272
s_waitcnt lgkmcnt(6)
v_mfma_f32_16x16x32_bf16 v[160:163], v[16:19], v[48:51], v[160:163]
v_mfma_f32_16x16x32_bf16 v[164:167], v[20:23], v[48:51], v[164:167]
v_mfma_f32_16x16x32_bf16 v[168:171], v[24:27], v[48:51], v[168:171]
v_mfma_f32_16x16x32_bf16 v[172:175], v[28:31], v[48:51], v[172:175]
ds_read_b64_tr_b16 v[48:49], v5 offset:29216
ds_read_b64_tr_b16 v[50:51], v5 offset:31008
s_waitcnt lgkmcnt(6)
v_mfma_f32_16x16x32_bf16 v[176:179], v[16:19], v[52:55], v[176:179]
v_mfma_f32_16x16x32_bf16 v[180:183], v[20:23], v[52:55], v[180:183]
v_mfma_f32_16x16x32_bf16 v[184:187], v[24:27], v[52:55], v[184:187]
v_mfma_f32_16x16x32_bf16 v[188:191], v[28:31], v[52:55], v[188:191]
ds_read_b64_tr_b16 v[52:53], v5 offset:36512
ds_read_b64_tr_b16 v[54:55], v5 offset:38304
s_waitcnt vmcnt(5)
s_barrier
ds_read_b128 v[32:35], v2 offset:49152
ds_read_b128 v[36:39], v2 offset:50176
ds_read_b128 v[40:43], v2 offset:51200
ds_read_b128 v[44:47], v2 offset:52224
s_waitcnt lgkmcnt(10)
s_mov_b32 m0, s41
v_mfma_f32_16x16x32_bf16 v[192:195], v[56:59], v[16:19], v[192:195]
buffer_load_dwordx4 v6, s[12:15], s32 offen lds
v_mfma_f32_16x16x32_bf16 v[196:199], v[56:59], v[20:23], v[196:199]
v_mfma_f32_16x16x32_bf16 v[200:203], v[56:59], v[24:27], v[200:203]
v_mfma_f32_16x16x32_bf16 v[204:207], v[56:59], v[28:31], v[204:207]
ds_read_b64_tr_b16 v[56:57], v3 offset:18432
ds_read_b64_tr_b16 v[58:59], v3 offset:19968
s_waitcnt lgkmcnt(10)
s_mov_b32 m0, s45
v_mfma_f32_16x16x32_bf16 v[208:211], v[60:63], v[16:19], v[208:211]
buffer_load_dwordx4 v7, s[12:15], s32 offen lds
v_mfma_f32_16x16x32_bf16 v[212:215], v[60:63], v[20:23], v[212:215]
v_mfma_f32_16x16x32_bf16 v[216:219], v[60:63], v[24:27], v[216:219]
v_mfma_f32_16x16x32_bf16 v[220:223], v[60:63], v[28:31], v[220:223]
ds_read_b64_tr_b16 v[60:61], v4 offset:18432
ds_read_b64_tr_b16 v[62:63], v4 offset:19968
s_waitcnt lgkmcnt(10)
s_mov_b32 m0, s49
v_mfma_f32_16x16x32_bf16 v[224:227], v[48:51], v[16:19], v[224:227]
buffer_load_dwordx4 v8, s[16:19], s33 offen lds
v_mfma_f32_16x16x32_bf16 v[228:231], v[48:51], v[20:23], v[228:231]
v_mfma_f32_16x16x32_bf16 v[232:235], v[48:51], v[24:27], v[232:235]
v_mfma_f32_16x16x32_bf16 v[236:239], v[48:51], v[28:31], v[236:239]
ds_read_b64_tr_b16 v[48:49], v3 offset:18496
ds_read_b64_tr_b16 v[50:51], v3 offset:20032
s_waitcnt lgkmcnt(10)
s_mov_b32 m0, s53
v_mfma_f32_16x16x32_bf16 v[240:243], v[52:55], v[16:19], v[240:243]
buffer_load_dwordx4 v9, s[20:23], s34 offen lds
v_mfma_f32_16x16x32_bf16 v[244:247], v[52:55], v[20:23], v[244:247]
v_mfma_f32_16x16x32_bf16 v[248:251], v[52:55], v[24:27], v[248:251]
s_mov_b32 m0, s57
s_nop 0
buffer_load_dwordx4 v10, s[24:27], s35 offen lds
v_mfma_f32_16x16x32_bf16 v[252:255], v[52:55], v[28:31], v[252:255]
ds_read_b64_tr_b16 v[52:53], v4 offset:18496
ds_read_b64_tr_b16 v[54:55], v4 offset:20032
s_add_u32 s32, s32, 64
s_add_u32 s33, s33, s36
s_add_u32 s34, s34, s37
s_add_u32 s35, s35, s38
s_waitcnt lgkmcnt(6)
v_mfma_f32_16x16x32_bf16 v[96:99], v[56:59], v[32:35], v[96:99]
v_mfma_f32_16x16x32_bf16 v[100:103], v[56:59], v[36:39], v[100:103]
v_mfma_f32_16x16x32_bf16 v[104:107], v[56:59], v[40:43], v[104:107]
v_mfma_f32_16x16x32_bf16 v[108:111], v[56:59], v[44:47], v[108:111]
ds_read_b64_tr_b16 v[56:57], v3 offset:18560
ds_read_b64_tr_b16 v[58:59], v3 offset:20096
s_waitcnt lgkmcnt(6)
v_mfma_f32_16x16x32_bf16 v[112:115], v[60:63], v[32:35], v[112:115]
v_mfma_f32_16x16x32_bf16 v[116:119], v[60:63], v[36:39], v[116:119]
v_mfma_f32_16x16x32_bf16 v[120:123], v[60:63], v[40:43], v[120:123]
v_mfma_f32_16x16x32_bf16 v[124:127], v[60:63], v[44:47], v[124:127]
ds_read_b64_tr_b16 v[60:61], v4 offset:18560
ds_read_b64_tr_b16 v[62:63], v4 offset:20096
s_waitcnt lgkmcnt(6)
v_mfma_f32_16x16x32_bf16 v[128:131], v[48:51], v[32:35], v[128:131]
v_mfma_f32_16x16x32_bf16 v[132:135], v[48:51], v[36:39], v[132:135]
v_mfma_f32_16x16x32_bf16 v[136:139], v[48:51], v[40:43], v[136:139]
v_mfma_f32_16x16x32_bf16 v[140:143], v[48:51], v[44:47], v[140:143]
ds_read_b64_tr_b16 v[48:49], v5 offset:43776
ds_read_b64_tr_b16 v[50:51], v5 offset:45568
s_waitcnt lgkmcnt(6)
v_mfma_f32_16x16x32_bf16 v[144:147], v[52:55], v[32:35], v[144:147]
v_mfma_f32_16x16x32_bf16 v[148:151], v[52:55], v[36:39], v[148:151]
v_mfma_f32_16x16x32_bf16 v[152:155], v[52:55], v[40:43], v[152:155]
v_mfma_f32_16x16x32_bf16 v[156:159], v[52:55], v[44:47], v[156:159]
ds_read_b64_tr_b16 v[52:53], v5 offset:51072
ds_read_b64_tr_b16 v[54:55], v5 offset:52864
s_waitcnt lgkmcnt(6)
v_mfma_f32_16x16x32_bf16 v[160:163], v[32:35], v[56:59], v[160:163]
v_mfma_f32_16x16x32_bf16 v[164:167], v[36:39], v[56:59], v[164:167]
v_mfma_f32_16x16x32_bf16 v[168:171], v[40:43], v[56:59], v[168:171]
v_mfma_f32_16x16x32_bf16 v[172:175], v[44:47], v[56:59], v[172:175]
ds_read_b64_tr_b16 v[56:57], v5 offset:43808
ds_read_b64_tr_b16 v[58:59], v5 offset:45600
s_waitcnt lgkmcnt(6)
v_mfma_f32_16x16x32_bf16 v[176:179], v[32:35], v[60:63], v[176:179]
v_mfma_f32_16x16x32_bf16 v[180:183], v[36:39], v[60:63], v[180:183]
v_mfma_f32_16x16x32_bf16 v[184:187], v[40:43], v[60:63], v[184:187]
v_mfma_f32_16x16x32_bf16 v[188:191], v[44:47], v[60:63], v[188:191]
ds_read_b64_tr_b16 v[60:61], v5 offset:51104
ds_read_b64_tr_b16 v[62:63], v5 offset:52896
s_waitcnt vmcnt(5)
s_barrier
ds_read_b128 v[16:19], v2 offset:0
ds_read_b128 v[20:23], v2 offset:1024
ds_read_b128 v[24:27], v2 offset:2048
ds_read_b128 v[28:31], v2 offset:3072
s_waitcnt lgkmcnt(10)
s_mov_b32 m0, s42
v_mfma_f32_16x16x32_bf16 v[192:195], v[48:51], v[32:35], v[192:195]
buffer_load_dwordx4 v6, s[12:15], s32 offen lds
v_mfma_f32_16x16x32_bf16 v[196:199], v[48:51], v[36:39], v[196:199]
v_mfma_f32_16x16x32_bf16 v[200:203], v[48:51], v[40:43], v[200:203]
v_mfma_f32_16x16x32_bf16 v[204:207], v[48:51], v[44:47], v[204:207]
ds_read_b64_tr_b16 v[48:49], v3 offset:0
ds_read_b64_tr_b16 v[50:51], v3 offset:1536
s_waitcnt lgkmcnt(10)
s_mov_b32 m0, s46
v_mfma_f32_16x16x32_bf16 v[208:211], v[52:55], v[32:35], v[208:211]
buffer_load_dwordx4 v7, s[12:15], s32 offen lds
v_mfma_f32_16x16x32_bf16 v[212:215], v[52:55], v[36:39], v[212:215]
v_mfma_f32_16x16x32_bf16 v[216:219], v[52:55], v[40:43], v[216:219]
v_mfma_f32_16x16x32_bf16 v[220:223], v[52:55], v[44:47], v[220:223]
ds_read_b64_tr_b16 v[52:53], v4 offset:0
ds_read_b64_tr_b16 v[54:55], v4 offset:1536
s_waitcnt lgkmcnt(10)
s_mov_b32 m0, s50
v_mfma_f32_16x16x32_bf16 v[224:227], v[56:59], v[32:35], v[224:227]
buffer_load_dwordx4 v8, s[16:19], s33 offen lds
v_mfma_f32_16x16x32_bf16 v[228:231], v[56:59], v[36:39], v[228:231]
v_mfma_f32_16x16x32_bf16 v[232:235], v[56:59], v[40:43], v[232:235]
v_mfma_f32_16x16x32_bf16 v[236:239], v[56:59], v[44:47], v[236:239]
ds_read_b64_tr_b16 v[56:57], v3 offset:64
ds_read_b64_tr_b16 v[58:59], v3 offset:1600
s_waitcnt lgkmcnt(10)
s_mov_b32 m0, s54
v_mfma_f32_16x16x32_bf16 v[240:243], v[60:63], v[32:35], v[240:243]
buffer_load_dwordx4 v9, s[20:23], s34 offen lds
v_mfma_f32_16x16x32_bf16 v[244:247], v[60:63], v[36:39], v[244:247]
v_mfma_f32_16x16x32_bf16 v[248:251], v[60:63], v[40:43], v[248:251]
s_mov_b32 m0, s58
s_nop 0
buffer_load_dwordx4 v10, s[24:27], s35 offen lds
v_mfma_f32_16x16x32_bf16 v[252:255], v[60:63], v[44:47], v[252:255]
ds_read_b64_tr_b16 v[60:61], v4 offset:64
ds_read_b64_tr_b16 v[62:63], v4 offset:1600
s_add_u32 s32, s32, 64
s_add_u32 s33, s33, s36
s_add_u32 s34, s34, s37
s_add_u32 s35, s35, s38
L_k1_loop_2:
s_waitcnt lgkmcnt(6)
v_mfma_f32_16x16x32_bf16 v[96:99], v[48:51], v[16:19], v[96:99]
v_mfma_f32_16x16x32_bf16 v[100:103], v[48:51], v[20:23], v[100:103]
v_mfma_f32_16x16x32_bf16 v[104:107], v[48:51], v[24:27], v[104:107]
v_mfma_f32_16x16x32_bf16 v[108:111], v[48:51], v[28:31], v[108:111]
ds_read_b64_tr_b16 v[48:49], v3 offset:128
ds_read_b64_tr_b16 v[50:51], v3 offset:1664
s_waitcnt lgkmcnt(6)
v_mfma_f32_16x16x32_bf16 v[112:115], v[52:55], v[16:19], v[112:115]
v_mfma_f32_16x16x32_bf16 v[116:119], v[52:55], v[20:23], v[116:119]
v_mfma_f32_16x16x32_bf16 v[120:123], v[52:55], v[24:27], v[120:123]
v_mfma_f32_16x16x32_bf16 v[124:127], v[52:55], v[28:31], v[124:127]
ds_read_b64_tr_b16 v[52:53], v4 offset:128
ds_read_b64_tr_b16 v[54:55], v4 offset:1664
s_waitcnt lgkmcnt(6)
v_mfma_f32_16x16x32_bf16 v[128:131], v[56:59], v[16:19], v[128:131]
v_mfma_f32_16x16x32_bf16 v[132:135], v[56:59], v[20:23], v[132:135]
v_mfma_f32_16x16x32_bf16 v[136:139], v[56:59], v[24:27], v[136:139]
v_mfma_f32_16x16x32_bf16 v[140:143], v[56:59], v[28:31], v[140:143]
ds_read_b64_tr_b16 v[56:57], v5 offset:0
ds_read_b64_tr_b16 v[58:59], v5 offset:1792
s_waitcnt lgkmcnt(6)
v_mfma_f32_16x16x32_bf16 v[144:147], v[60:63], v[16:19], v[144:147]
v_mfma_f32_16x16x32_bf16 v[148:151], v[60:63], v[20:23], v[148:151]
v_mfma_f32_16x16x32_bf16 v[152:155], v[60:63], v[24:27], v[152:155]
v_mfma_f32_16x16x32_bf16 v[156:159], v[60:63], v[28:31], v[156:159]
ds_read_b64_tr_b16 v[60:61], v5 offset:7296
ds_read_b64_tr_b16 v[62:63], v5 offset:9088
s_waitcnt lgkmcnt(6)
v_mfma_f32_16x16x32_bf16 v[160:163], v[16:19], v[48:51], v[160:163]
v_mfma_f32_16x16x32_bf16 v[164:167], v[20:23], v[48:51], v[164:167]
v_mfma_f32_16x16x32_bf16 v[168:171], v[24:27], v[48:51], v[168:171]
v_mfma_f32_16x16x32_bf16 v[172:175], v[28:31], v[48:51], v[172:175]
ds_read_b64_tr_b16 v[48:49], v5 offset:32
ds_read_b64_tr_b16 v[50:51], v5 offset:1824
s_waitcnt lgkmcnt(6)
v_mfma_f32_16x16x32_bf16 v[176:179], v[16:19], v[52:55], v[176:179]
v_mfma_f32_16x16x32_bf16 v[180:183], v[20:23], v[52:55], v[180:183]
v_mfma_f32_16x16x32_bf16 v[184:187], v[24:27], v[52:55], v[184:187]
v_mfma_f32_16x16x32_bf16 v[188:191], v[28:31], v[52:55], v[188:191]
ds_read_b64_tr_b16 v[52:53], v5 offset:7328
ds_read_b64_tr_b16 v[54:55], v5 offset:9120
s_waitcnt vmcnt(5)
s_barrier
ds_read_b128 v[32:35], v2 offset:16384
ds_read_b128 v[36:39], v2 offset:17408
ds_read_b128 v[40:43], v2 offset:18432
ds_read_b128 v[44:47], v2 offset:19456
s_waitcnt lgkmcnt(10)
s_mov_b32 m0, s43
v_mfma_f32_16x16x32_bf16 v[192:195], v[56:59], v[16:19], v[192:195]
buffer_load_dwordx4 v6, s[12:15], s32 offen lds
v_mfma_f32_16x16x32_bf16 v[196:199], v[56:59], v[20:23], v[196:199]
v_mfma_f32_16x16x32_bf16 v[200:203], v[56:59], v[24:27], v[200:203]
v_mfma_f32_16x16x32_bf16 v[204:207], v[56:59], v[28:31], v[204:207]
ds_read_b64_tr_b16 v[56:57], v3 offset:6144
ds_read_b64_tr_b16 v[58:59], v3 offset:7680
s_waitcnt lgkmcnt(10)
s_mov_b32 m0, s47
v_mfma_f32_16x16x32_bf16 v[208:211], v[60:63], v[16:19], v[208:211]
buffer_load_dwordx4 v7, s[12:15], s32 offen lds
v_mfma_f32_16x16x32_bf16 v[212:215], v[60:63], v[20:23], v[212:215]
v_mfma_f32_16x16x32_bf16 v[216:219], v[60:63], v[24:27], v[216:219]
v_mfma_f32_16x16x32_bf16 v[220:223], v[60:63], v[28:31], v[220:223]
ds_read_b64_tr_b16 v[60:61], v4 offset:6144
ds_read_b64_tr_b16 v[62:63], v4 offset:7680
s_waitcnt lgkmcnt(10)
s_mov_b32 m0, s51
v_mfma_f32_16x16x32_bf16 v[224:227], v[48:51], v[16:19], v[224:227]
buffer_load_dwordx4 v8, s[16:19], s33 offen lds
v_mfma_f32_16x16x32_bf16 v[228:231], v[48:51], v[20:23], v[228:231]
v_mfma_f32_16x16x32_bf16 v[232:235], v[48:51], v[24:27], v[232:235]
v_mfma_f32_16x16x32_bf16 v[236:239], v[48:51], v[28:31], v[236:239]
ds_read_b64_tr_b16 v[48:49], v3 offset:6208
ds_read_b64_tr_b16 v[50:51], v3 offset:7744
s_waitcnt lgkmcnt(10)
s_mov_b32 m0, s55
v_mfma_f32_16x16x32_bf16 v[240:243], v[52:55], v[16:19], v[240:243]
buffer_load_dwordx4 v9, s[20:23], s34 offen lds
v_mfma_f32_16x16x32_bf16 v[244:247], v[52:55], v[20:23], v[244:247]
v_mfma_f32_16x16x32_bf16 v[248:251], v[52:55], v[24:27], v[248:251]
s_mov_b32 m0, s59
s_nop 0
buffer_load_dwordx4 v10, s[24:27], s35 offen lds
v_mfma_f32_16x16x32_bf16 v[252:255], v[52:55], v[28:31], v[252:255]
s_cmp_eq_u32 s61, s83
s_cbranch_scc0 L_k1_pfskip_3
s_add_u32 s62, s80, s33
buffer_load_dwordx4 v[68:71], v8, s[16:19], s62 offen
s_add_u32 s62, s81, s34
buffer_load_dwordx4 v[72:75], v9, s[20:23], s62 offen
s_add_u32 s62, s82, s35
buffer_load_dwordx4 v[76:79], v10, s[24:27], s62 offen
L_k1_pfskip_3:
s_xor_b32 s61, s61, 1
buffer_load_dwordx4 v[80:83], v11, s[84:87], s39 offen
s_add_u32 s39, s39, 2097152
ds_read_b64_tr_b16 v[52:53], v4 offset:6208
ds_read_b64_tr_b16 v[54:55], v4 offset:7744
s_add_u32 s32, s32, 64
s_add_u32 s33, s33, s36
s_add_u32 s34, s34, s37
s_add_u32 s35, s35, s38
s_waitcnt lgkmcnt(6)
v_mfma_f32_16x16x32_bf16 v[96:99], v[56:59], v[32:35], v[96:99]
v_mfma_f32_16x16x32_bf16 v[100:103], v[56:59], v[36:39], v[100:103]
v_mfma_f32_16x16x32_bf16 v[104:107], v[56:59], v[40:43], v[104:107]
v_mfma_f32_16x16x32_bf16 v[108:111], v[56:59], v[44:47], v[108:111]
ds_read_b64_tr_b16 v[56:57], v3 offset:6272
ds_read_b64_tr_b16 v[58:59], v3 offset:7808
s_waitcnt lgkmcnt(6)
v_mfma_f32_16x16x32_bf16 v[112:115], v[60:63], v[32:35], v[112:115]
v_mfma_f32_16x16x32_bf16 v[116:119], v[60:63], v[36:39], v[116:119]
v_mfma_f32_16x16x32_bf16 v[120:123], v[60:63], v[40:43], v[120:123]
v_mfma_f32_16x16x32_bf16 v[124:127], v[60:63], v[44:47], v[124:127]
ds_read_b64_tr_b16 v[60:61], v4 offset:6272
ds_read_b64_tr_b16 v[62:63], v4 offset:7808
s_waitcnt lgkmcnt(6)
v_mfma_f32_16x16x32_bf16 v[128:131], v[48:51], v[32:35], v[128:131]
v_mfma_f32_16x16x32_bf16 v[132:135], v[48:51], v[36:39], v[132:135]
v_mfma_f32_16x16x32_bf16 v[136:139], v[48:51], v[40:43], v[136:139]
v_mfma_f32_16x16x32_bf16 v[140:143], v[48:51], v[44:47], v[140:143]
ds_read_b64_tr_b16 v[48:49], v5 offset:14592
ds_read_b64_tr_b16 v[50:51], v5 offset:16384
s_waitcnt lgkmcnt(6)
v_mfma_f32_16x16x32_bf16 v[144:147], v[52:55], v[32:35], v[144:147]
v_mfma_f32_16x16x32_bf16 v[148:151], v[52:55], v[36:39], v[148:151]
v_mfma_f32_16x16x32_bf16 v[152:155], v[52:55], v[40:43], v[152:155]
v_mfma_f32_16x16x32_bf16 v[156:159], v[52:55], v[44:47], v[156:159]
ds_read_b64_tr_b16 v[52:53], v5 offset:21888
ds_read_b64_tr_b16 v[54:55], v5 offset:23680
s_waitcnt lgkmcnt(6)
v_mfma_f32_16x16x32_bf16 v[160:163], v[32:35], v[56:59], v[160:163]
v_mfma_f32_16x16x32_bf16 v[164:167], v[36:39], v[56:59], v[164:167]
v_mfma_f32_16x16x32_bf16 v[168:171], v[40:43], v[56:59], v[168:171]
v_mfma_f32_16x16x32_bf16 v[172:175], v[44:47], v[56:59], v[172:175]
ds_read_b64_tr_b16 v[56:57], v5 offset:14624
ds_read_b64_tr_b16 v[58:59], v5 offset:16416
s_waitcnt lgkmcnt(6)
v_mfma_f32_16x16x32_bf16 v[176:179], v[32:35], v[60:63], v[176:179]
v_mfma_f32_16x16x32_bf16 v[180:183], v[36:39], v[60:63], v[180:183]
v_mfma_f32_16x16x32_bf16 v[184:187], v[40:43], v[60:63], v[184:187]
v_mfma_f32_16x16x32_bf16 v[188:191], v[44:47], v[60:63], v[188:191]
ds_read_b64_tr_b16 v[60:61], v5 offset:21920
ds_read_b64_tr_b16 v[62:63], v5 offset:23712
s_waitcnt vmcnt(5)
s_barrier
ds_read_b128 v[16:19], v2 offset:32768
ds_read_b128 v[20:23], v2 offset:33792
ds_read_b128 v[24:27], v2 offset:34816
ds_read_b128 v[28:31], v2 offset:35840
s_waitcnt lgkmcnt(10)
s_mov_b32 m0, s40
v_mfma_f32_16x16x32_bf16 v[192:195], v[48:51], v[32:35], v[192:195]
buffer_load_dwordx4 v6, s[12:15], s32 offen lds
v_mfma_f32_16x16x32_bf16 v[196:199], v[48:51], v[36:39], v[196:199]
v_mfma_f32_16x16x32_bf16 v[200:203], v[48:51], v[40:43], v[200:203]
v_mfma_f32_16x16x32_bf16 v[204:207], v[48:51], v[44:47], v[204:207]
ds_read_b64_tr_b16 v[48:49], v3 offset:12288
ds_read_b64_tr_b16 v[50:51], v3 offset:13824
s_waitcnt lgkmcnt(10)
s_mov_b32 m0, s44
v_mfma_f32_16x16x32_bf16 v[208:211], v[52:55], v[32:35], v[208:211]
buffer_load_dwordx4 v7, s[12:15], s32 offen lds
v_mfma_f32_16x16x32_bf16 v[212:215], v[52:55], v[36:39], v[212:215]
v_mfma_f32_16x16x32_bf16 v[216:219], v[52:55], v[40:43], v[216:219]
v_mfma_f32_16x16x32_bf16 v[220:223], v[52:55], v[44:47], v[220:223]
ds_read_b64_tr_b16 v[52:53], v4 offset:12288
ds_read_b64_tr_b16 v[54:55], v4 offset:13824
s_waitcnt lgkmcnt(10)
s_mov_b32 m0, s48
v_mfma_f32_16x16x32_bf16 v[224:227], v[56:59], v[32:35], v[224:227]
buffer_load_dwordx4 v8, s[16:19], s33 offen lds
v_mfma_f32_16x16x32_bf16 v[228:231], v[56:59], v[36:39], v[228:231]
v_mfma_f32_16x16x32_bf16 v[232:235], v[56:59], v[40:43], v[232:235]
v_mfma_f32_16x16x32_bf16 v[236:239], v[56:59], v[44:47], v[236:239]
ds_read_b64_tr_b16 v[56:57], v3 offset:12352
ds_read_b64_tr_b16 v[58:59], v3 offset:13888
s_waitcnt lgkmcnt(10)
s_mov_b32 m0, s52
v_mfma_f32_16x16x32_bf16 v[240:243], v[60:63], v[32:35], v[240:243]
buffer_load_dwordx4 v9, s[20:23], s34 offen lds
v_mfma_f32_16x16x32_bf16 v[244:247], v[60:63], v[36:39], v[244:247]
v_mfma_f32_16x16x32_bf16 v[248:251], v[60:63], v[40:43], v[248:251]
s_mov_b32 m0, s56
s_nop 0
buffer_load_dwordx4 v10, s[24:27], s35 offen lds
v_mfma_f32_16x16x32_bf16 v[252:255], v[60:63], v[44:47], v[252:255]
ds_read_b64_tr_b16 v[60:61], v4 offset:12352
ds_read_b64_tr_b16 v[62:63], v4 offset:13888
s_add_u32 s32, s32, 64
s_add_u32 s33, s33, s36
s_add_u32 s34, s34, s37
s_add_u32 s35, s35, s38
s_waitcnt lgkmcnt(6)
v_mfma_f32_16x16x32_bf16 v[96:99], v[48:51], v[16:19], v[96:99]
v_mfma_f32_16x16x32_bf16 v[100:103], v[48:51], v[20:23], v[100:103]
v_mfma_f32_16x16x32_bf16 v[104:107], v[48:51], v[24:27], v[104:107]
v_mfma_f32_16x16x32_bf16 v[108:111], v[48:51], v[28:31], v[108:111]
ds_read_b64_tr_b16 v[48:49], v3 offset:12416
ds_read_b64_tr_b16 v[50:51], v3 offset:13952
s_waitcnt lgkmcnt(6)
v_mfma_f32_16x16x32_bf16 v[112:115], v[52:55], v[16:19], v[112:115]
v_mfma_f32_16x16x32_bf16 v[116:119], v[52:55], v[20:23], v[116:119]
v_mfma_f32_16x16x32_bf16 v[120:123], v[52:55], v[24:27], v[120:123]
v_mfma_f32_16x16x32_bf16 v[124:127], v[52:55], v[28:31], v[124:127]
ds_read_b64_tr_b16 v[52:53], v4 offset:12416
ds_read_b64_tr_b16 v[54:55], v4 offset:13952
s_waitcnt lgkmcnt(6)
v_mfma_f32_16x16x32_bf16 v[128:131], v[56:59], v[16:19], v[128:131]
v_mfma_f32_16x16x32_bf16 v[132:135], v[56:59], v[20:23], v[132:135]
v_mfma_f32_16x16x32_bf16 v[136:139], v[56:59], v[24:27], v[136:139]
v_mfma_f32_16x16x32_bf16 v[140:143], v[56:59], v[28:31], v[140:143]
ds_read_b64_tr_b16 v[56:57], v5 offset:29184
ds_read_b64_tr_b16 v[58:59], v5 offset:30976
s_waitcnt lgkmcnt(6)
v_mfma_f32_16x16x32_bf16 v[144:147], v[60:63], v[16:19], v[144:147]
v_mfma_f32_16x16x32_bf16 v[148:151], v[60:63], v[20:23], v[148:151]
v_mfma_f32_16x16x32_bf16 v[152:155], v[60:63], v[24:27], v[152:155]
v_mfma_f32_16x16x32_bf16 v[156:159], v[60:63], v[28:31], v[156:159]
ds_read_b64_tr_b16 v[60:61], v5 offset:36480
ds_read_b64_tr_b16 v[62:63], v5 offset:38272
s_waitcnt lgkmcnt(6)
v_mfma_f32_16x16x32_bf16 v[160:163], v[16:19], v[48:51], v[160:163]
v_mfma_f32_16x16x32_bf16 v[164:167], v[20:23], v[48:51], v[164:167]
v_mfma_f32_16x16x32_bf16 v[168:171], v[24:27], v[48:51], v[168:171]
v_mfma_f32_16x16x32_bf16 v[172:175], v[28:31], v[48:51], v[172:175]
ds_read_b64_tr_b16 v[48:49], v5 offset:29216
ds_read_b64_tr_b16 v[50:51], v5 offset:31008
s_waitcnt lgkmcnt(6)
v_mfma_f32_16x16x32_bf16 v[176:179], v[16:19], v[52:55], v[176:179]
v_mfma_f32_16x16x32_bf16 v[180:183], v[20:23], v[52:55], v[180:183]
v_mfma_f32_16x16x32_bf16 v[184:187], v[24:27], v[52:55], v[184:187]
v_mfma_f32_16x16x32_bf16 v[188:191], v[28:31], v[52:55], v[188:191]
ds_read_b64_tr_b16 v[52:53], v5 offset:36512
ds_read_b64_tr_b16 v[54:55], v5 offset:38304
s_waitcnt vmcnt(5)
s_barrier
ds_read_b128 v[32:35], v2 offset:49152
ds_read_b128 v[36:39], v2 offset:50176
ds_read_b128 v[40:43], v2 offset:51200
ds_read_b128 v[44:47], v2 offset:52224
s_waitcnt lgkmcnt(10)
s_mov_b32 m0, s41
v_mfma_f32_16x16x32_bf16 v[192:195], v[56:59], v[16:19], v[192:195]
buffer_load_dwordx4 v6, s[12:15], s32 offen lds
v_mfma_f32_16x16x32_bf16 v[196:199], v[56:59], v[20:23], v[196:199]
v_mfma_f32_16x16x32_bf16 v[200:203], v[56:59], v[24:27], v[200:203]
v_mfma_f32_16x16x32_bf16 v[204:207], v[56:59], v[28:31], v[204:207]
ds_read_b64_tr_b16 v[56:57], v3 offset:18432
ds_read_b64_tr_b16 v[58:59], v3 offset:19968
s_waitcnt lgkmcnt(10)
s_mov_b32 m0, s45
v_mfma_f32_16x16x32_bf16 v[208:211], v[60:63], v[16:19], v[208:211]
buffer_load_dwordx4 v7, s[12:15], s32 offen lds
v_mfma_f32_16x16x32_bf16 v[212:215], v[60:63], v[20:23], v[212:215]
v_mfma_f32_16x16x32_bf16 v[216:219], v[60:63], v[24:27], v[216:219]
v_mfma_f32_16x16x32_bf16 v[220:223], v[60:63], v[28:31], v[220:223]
ds_read_b64_tr_b16 v[60:61], v4 offset:18432
ds_read_b64_tr_b16 v[62:63], v4 offset:19968
s_waitcnt lgkmcnt(10)
s_mov_b32 m0, s49
v_mfma_f32_16x16x32_bf16 v[224:227], v[48:51], v[16:19], v[224:227]
buffer_load_dwordx4 v8, s[16:19], s33 offen lds
v_mfma_f32_16x16x32_bf16 v[228:231], v[48:51], v[20:23], v[228:231]
v_mfma_f32_16x16x32_bf16 v[232:235], v[48:51], v[24:27], v[232:235]
v_mfma_f32_16x16x32_bf16 v[236:239], v[48:51], v[28:31], v[236:239]
ds_read_b64_tr_b16 v[48:49], v3 offset:18496
ds_read_b64_tr_b16 v[50:51], v3 offset:20032
s_waitcnt lgkmcnt(10)
s_mov_b32 m0, s53
v_mfma_f32_16x16x32_bf16 v[240:243], v[52:55], v[16:19], v[240:243]
buffer_load_dwordx4 v9, s[20:23], s34 offen lds
v_mfma_f32_16x16x32_bf16 v[244:247], v[52:55], v[20:23], v[244:247]
v_mfma_f32_16x16x32_bf16 v[248:251], v[52:55], v[24:27], v[248:251]
s_mov_b32 m0, s57
s_nop 0
buffer_load_dwordx4 v10, s[24:27], s35 offen lds
v_mfma_f32_16x16x32_bf16 v[252:255], v[52:55], v[28:31], v[252:255]
ds_read_b64_tr_b16 v[52:53], v4 offset:18496
ds_read_b64_tr_b16 v[54:55], v4 offset:20032
s_add_u32 s32, s32, 64
s_add_u32 s33, s33, s36
s_add_u32 s34, s34, s37
s_add_u32 s35, s35, s38
s_waitcnt lgkmcnt(6)
v_mfma_f32_16x16x32_bf16 v[96:99], v[56:59], v[32:35], v[96:99]
v_mfma_f32_16x16x32_bf16 v[100:103], v[56:59], v[36:39], v[100:103]
v_mfma_f32_16x16x32_bf16 v[104:107], v[56:59], v[40:43], v[104:107]
v_mfma_f32_16x16x32_bf16 v[108:111], v[56:59], v[44:47], v[108:111]
ds_read_b64_tr_b16 v[56:57], v3 offset:18560
ds_read_b64_tr_b16 v[58:59], v3 offset:20096
s_waitcnt lgkmcnt(6)
v_mfma_f32_16x16x32_bf16 v[112:115], v[60:63], v[32:35], v[112:115]
v_mfma_f32_16x16x32_bf16 v[116:119], v[60:63], v[36:39], v[116:119]
v_mfma_f32_16x16x32_bf16 v[120:123], v[60:63], v[40:43], v[120:123]
v_mfma_f32_16x16x32_bf16 v[124:127], v[60:63], v[44:47], v[124:127]
ds_read_b64_tr_b16 v[60:61], v4 offset:18560
ds_read_b64_tr_b16 v[62:63], v4 offset:20096
s_waitcnt lgkmcnt(6)
v_mfma_f32_16x16x32_bf16 v[128:131], v[48:51], v[32:35], v[128:131]
v_mfma_f32_16x16x32_bf16 v[132:135], v[48:51], v[36:39], v[132:135]
v_mfma_f32_16x16x32_bf16 v[136:139], v[48:51], v[40:43], v[136:139]
v_mfma_f32_16x16x32_bf16 v[140:143], v[48:51], v[44:47], v[140:143]
ds_read_b64_tr_b16 v[48:49], v5 offset:43776
ds_read_b64_tr_b16 v[50:51], v5 offset:45568
s_waitcnt lgkmcnt(6)
v_mfma_f32_16x16x32_bf16 v[144:147], v[52:55], v[32:35], v[144:147]
v_mfma_f32_16x16x32_bf16 v[148:151], v[52:55], v[36:39], v[148:151]
v_mfma_f32_16x16x32_bf16 v[152:155], v[52:55], v[40:43], v[152:155]
v_mfma_f32_16x16x32_bf16 v[156:159], v[52:55], v[44:47], v[156:159]
ds_read_b64_tr_b16 v[52:53], v5 offset:51072
ds_read_b64_tr_b16 v[54:55], v5 offset:52864
s_waitcnt lgkmcnt(6)
v_mfma_f32_16x16x32_bf16 v[160:163], v[32:35], v[56:59], v[160:163]
v_mfma_f32_16x16x32_bf16 v[164:167], v[36:39], v[56:59], v[164:167]
v_mfma_f32_16x16x32_bf16 v[168:171], v[40:43], v[56:59], v[168:171]
v_mfma_f32_16x16x32_bf16 v[172:175], v[44:47], v[56:59], v[172:175]
ds_read_b64_tr_b16 v[56:57], v5 offset:43808
ds_read_b64_tr_b16 v[58:59], v5 offset:45600
s_waitcnt lgkmcnt(6)
v_mfma_f32_16x16x32_bf16 v[176:179], v[32:35], v[60:63], v[176:179]
v_mfma_f32_16x16x32_bf16 v[180:183], v[36:39], v[60:63], v[180:183]
v_mfma_f32_16x16x32_bf16 v[184:187], v[40:43], v[60:63], v[184:187]
v_mfma_f32_16x16x32_bf16 v[188:191], v[44:47], v[60:63], v[188:191]
ds_read_b64_tr_b16 v[60:61], v5 offset:51104
ds_read_b64_tr_b16 v[62:63], v5 offset:52896
s_waitcnt vmcnt(5)
s_barrier
ds_read_b128 v[16:19], v2 offset:0
ds_read_b128 v[20:23], v2 offset:1024
ds_read_b128 v[24:27], v2 offset:2048
ds_read_b128 v[28:31], v2 offset:3072
s_waitcnt lgkmcnt(10)
s_mov_b32 m0, s42
v_mfma_f32_16x16x32_bf16 v[192:195], v[48:51], v[32:35], v[192:195]
buffer_load_dwordx4 v6, s[12:15], s32 offen lds
v_mfma_f32_16x16x32_bf16 v[196:199], v[48:51], v[36:39], v[196:199]
v_mfma_f32_16x16x32_bf16 v[200:203], v[48:51], v[40:43], v[200:203]
v_mfma_f32_16x16x32_bf16 v[204:207], v[48:51], v[44:47], v[204:207]
ds_read_b64_tr_b16 v[48:49], v3 offset:0
ds_read_b64_tr_b16 v[50:51], v3 offset:1536
s_waitcnt lgkmcnt(10)
s_mov_b32 m0, s46
v_mfma_f32_16x16x32_bf16 v[208:211], v[52:55], v[32:35], v[208:211]
buffer_load_dwordx4 v7, s[12:15], s32 offen lds
v_mfma_f32_16x16x32_bf16 v[212:215], v[52:55], v[36:39], v[212:215]
v_mfma_f32_16x16x32_bf16 v[216:219], v[52:55], v[40:43], v[216:219]
v_mfma_f32_16x16x32_bf16 v[220:223], v[52:55], v[44:47], v[220:223]
ds_read_b64_tr_b16 v[52:53], v4 offset:0
ds_read_b64_tr_b16 v[54:55], v4 offset:1536
s_waitcnt lgkmcnt(10)
s_mov_b32 m0, s50
v_mfma_f32_16x16x32_bf16 v[224:227], v[56:59], v[32:35], v[224:227]
buffer_load_dwordx4 v8, s[16:19], s33 offen lds
v_mfma_f32_16x16x32_bf16 v[228:231], v[56:59], v[36:39], v[228:231]
v_mfma_f32_16x16x32_bf16 v[232:235], v[56:59], v[40:43], v[232:235]
v_mfma_f32_16x16x32_bf16 v[236:239], v[56:59], v[44:47], v[236:239]
ds_read_b64_tr_b16 v[56:57], v3 offset:64
ds_read_b64_tr_b16 v[58:59], v3 offset:1600
s_waitcnt lgkmcnt(10)
s_mov_b32 m0, s54
v_mfma_f32_16x16x32_bf16 v[240:243], v[60:63], v[32:35], v[240:243]
buffer_load_dwordx4 v9, s[20:23], s34 offen lds
v_mfma_f32_16x16x32_bf16 v[244:247], v[60:63], v[36:39], v[244:247]
v_mfma_f32_16x16x32_bf16 v[248:251], v[60:63], v[40:43], v[248:251]
s_mov_b32 m0, s58
s_nop 0
buffer_load_dwordx4 v10, s[24:27], s35 offen lds
v_mfma_f32_16x16x32_bf16 v[252:255], v[60:63], v[44:47], v[252:255]
ds_read_b64_tr_b16 v[60:61], v4 offset:64
ds_read_b64_tr_b16 v[62:63], v4 offset:1600
s_add_u32 s32, s32, 64
s_add_u32 s33, s33, s36
s_add_u32 s34, s34, s37
s_add_u32 s35, s35, s38
s_add_u32 s60, s60, 1
s_cmp_lt_u32 s60, 6
s_cbranch_scc1 L_k1_loop_2
s_lshl_b32 s62, s29, 3
s_lshl_b32 s63, s31, 1
s_add_u32 s62, s62, s63
v_and_b32 v12, 15, v1
v_bfe_u32 v13, v1, 4, 1
v_lshl_add_u32 v12, v13, 5, v12
v_lshlrev_b32 v12, 4, v12
v_lshrrev_b32 v13, 5, v1
s_mul_i32 s63, s62, 288
s_mul_i32 s64, s28, 7
s_add_u32 s63, s63, s64
s_lshl_b32 s63, s63, 10
s_add_u32 s63, s63, 16842752
v_lshl_add_u32 v91, v13, 8, v12
v_add_u32 v91, s63, v91
v_add_u32 v92, 294912, v91
s_lshl_b32 s63, s28, 6
s_add_u32 s63, s63, s62
s_lshl_b32 s64, s63, 11
s_add_u32 s64, s64, 4194304
s_lshl_b32 s65, s63, 12
s_add_u32 s65, s65, 8388608
v_lshl_add_u32 v93, v13, 10, v12
v_add_u32 v94, s65, v93
v_add_u32 v93, s64, v93
v_lshl_add_u32 v95, v13, 10, v12
v_add_u32 v95, s65, v95
s_mov_b32 s76, 0xbfb8aa3b
s_mov_b32 s77, 0xbfb8aa3b
s_mov_b32 s78, 0x3e8293ee
s_mov_b32 s79, 0x3e8293ee
s_mov_b32 s72, 1.0
s_mov_b32 s73, 1.0
s_mov_b32 s75, 4096
s_waitcnt lgkmcnt(6)
v_mfma_f32_16x16x32_bf16 v[96:99], v[48:51], v[16:19], v[96:99]
v_mfma_f32_16x16x32_bf16 v[100:103], v[48:51], v[20:23], v[100:103]
v_mfma_f32_16x16x32_bf16 v[104:107], v[48:51], v[24:27], v[104:107]
v_mfma_f32_16x16x32_bf16 v[108:111], v[48:51], v[28:31], v[108:111]
ds_read_b64_tr_b16 v[48:49], v3 offset:128
ds_read_b64_tr_b16 v[50:51], v3 offset:1664
s_waitcnt lgkmcnt(6)
v_mfma_f32_16x16x32_bf16 v[112:115], v[52:55], v[16:19], v[112:115]
v_mfma_f32_16x16x32_bf16 v[116:119], v[52:55], v[20:23], v[116:119]
v_mfma_f32_16x16x32_bf16 v[120:123], v[52:55], v[24:27], v[120:123]
v_mfma_f32_16x16x32_bf16 v[124:127], v[52:55], v[28:31], v[124:127]
ds_read_b64_tr_b16 v[52:53], v4 offset:128
ds_read_b64_tr_b16 v[54:55], v4 offset:1664
s_waitcnt lgkmcnt(6)
v_mfma_f32_16x16x32_bf16 v[128:131], v[56:59], v[16:19], v[128:131]
v_mfma_f32_16x16x32_bf16 v[132:135], v[56:59], v[20:23], v[132:135]
v_mfma_f32_16x16x32_bf16 v[136:139], v[56:59], v[24:27], v[136:139]
v_mfma_f32_16x16x32_bf16 v[140:143], v[56:59], v[28:31], v[140:143]
ds_read_b64_tr_b16 v[56:57], v5 offset:0
ds_read_b64_tr_b16 v[58:59], v5 offset:1792
s_waitcnt lgkmcnt(6)
v_mfma_f32_16x16x32_bf16 v[144:147], v[60:63], v[16:19], v[144:147]
v_mfma_f32_16x16x32_bf16 v[148:151], v[60:63], v[20:23], v[148:151]
v_mfma_f32_16x16x32_bf16 v[152:155], v[60:63], v[24:27], v[152:155]
v_mfma_f32_16x16x32_bf16 v[156:159], v[60:63], v[28:31], v[156:159]
ds_read_b64_tr_b16 v[60:61], v5 offset:7296
ds_read_b64_tr_b16 v[62:63], v5 offset:9088
s_waitcnt lgkmcnt(6)
v_mfma_f32_16x16x32_bf16 v[160:163], v[16:19], v[48:51], v[160:163]
v_mfma_f32_16x16x32_bf16 v[164:167], v[20:23], v[48:51], v[164:167]
v_mfma_f32_16x16x32_bf16 v[168:171], v[24:27], v[48:51], v[168:171]
v_mfma_f32_16x16x32_bf16 v[172:175], v[28:31], v[48:51], v[172:175]
ds_read_b64_tr_b16 v[48:49], v5 offset:32
ds_read_b64_tr_b16 v[50:51], v5 offset:1824
s_waitcnt lgkmcnt(6)
v_mfma_f32_16x16x32_bf16 v[176:179], v[16:19], v[52:55], v[176:179]
v_mfma_f32_16x16x32_bf16 v[180:183], v[20:23], v[52:55], v[180:183]
v_mfma_f32_16x16x32_bf16 v[184:187], v[24:27], v[52:55], v[184:187]
v_mfma_f32_16x16x32_bf16 v[188:191], v[28:31], v[52:55], v[188:191]
ds_read_b64_tr_b16 v[52:53], v5 offset:7328
ds_read_b64_tr_b16 v[54:55], v5 offset:9120
s_waitcnt vmcnt(5)
s_barrier
s_waitcnt lgkmcnt(6)
s_mov_b32 m0, s43
v_mfma_f32_16x16x32_bf16 v[192:195], v[56:59], v[16:19], v[192:195]
buffer_load_dwordx4 v6, s[12:15], s32 offen lds
v_mfma_f32_16x16x32_bf16 v[196:199], v[56:59], v[20:23], v[196:199]
v_mfma_f32_16x16x32_bf16 v[200:203], v[56:59], v[24:27], v[200:203]
v_mfma_f32_16x16x32_bf16 v[204:207], v[56:59], v[28:31], v[204:207]
s_waitcnt lgkmcnt(4)
s_mov_b32 m0, s47
v_mfma_f32_16x16x32_bf16 v[208:211], v[60:63], v[16:19], v[208:211]
buffer_load_dwordx4 v7, s[12:15], s32 offen lds
v_mfma_f32_16x16x32_bf16 v[212:215], v[60:63], v[20:23], v[212:215]
v_mfma_f32_16x16x32_bf16 v[216:219], v[60:63], v[24:27], v[216:219]
v_mfma_f32_16x16x32_bf16 v[220:223], v[60:63], v[28:31], v[220:223]
s_waitcnt lgkmcnt(2)
s_mov_b32 m0, s51
v_mfma_f32_16x16x32_bf16 v[224:227], v[48:51], v[16:19], v[224:227]
buffer_load_dwordx4 v8, s[16:19], s33 offen lds
v_mfma_f32_16x16x32_bf16 v[228:231], v[48:51], v[20:23], v[228:231]
v_mfma_f32_16x16x32_bf16 v[232:235], v[48:51], v[24:27], v[232:235]
v_mfma_f32_16x16x32_bf16 v[236:239], v[48:51], v[28:31], v[236:239]
s_waitcnt lgkmcnt(0)
s_mov_b32 m0, s55
v_mfma_f32_16x16x32_bf16 v[240:243], v[52:55], v[16:19], v[240:243]
buffer_load_dwordx4 v9, s[20:23], s34 offen lds
v_mfma_f32_16x16x32_bf16 v[244:247], v[52:55], v[20:23], v[244:247]
v_mfma_f32_16x16x32_bf16 v[248:251], v[52:55], v[24:27], v[248:251]
s_mov_b32 m0, s59
s_nop 0
buffer_load_dwordx4 v10, s[24:27], s35 offen lds
v_mfma_f32_16x16x32_bf16 v[252:255], v[52:55], v[28:31], v[252:255]
s_add_u32 s32, s32, 64
s_add_u32 s33, s33, s36
s_add_u32 s34, s34, s37
s_add_u32 s35, s35, s38
ds_read_b128 v[16:19], v2 offset:16384
ds_read_b128 v[20:23], v2 offset:17408
ds_read_b128 v[24:27], v2 offset:18432
ds_read_b128 v[28:31], v2 offset:19456
ds_read_b64_tr_b16 v[48:49], v3 offset:6144
ds_read_b64_tr_b16 v[50:51], v3 offset:7680
ds_read_b64_tr_b16 v[52:53], v4 offset:6144
ds_read_b64_tr_b16 v[54:55], v4 offset:7680
s_waitcnt vmcnt(5)
s_barrier
ds_read_b128 v[32:35], v2 offset:32768
ds_read_b128 v[36:39], v2 offset:33792
ds_read_b128 v[40:43], v2 offset:34816
ds_read_b128 v[44:47], v2 offset:35840
ds_read_b64_tr_b16 v[56:57], v3 offset:12288
ds_read_b64_tr_b16 v[58:59], v3 offset:13824
ds_read_b64_tr_b16 v[60:61], v4 offset:12288
ds_read_b64_tr_b16 v[62:63], v4 offset:13824
s_waitcnt lgkmcnt(8)
v_mfma_f32_16x16x32_bf16 v[96:99], v[48:51], v[16:19], v[96:99]
v_mfma_f32_16x16x32_bf16 v[100:103], v[48:51], v[20:23], v[100:103]
v_mfma_f32_16x16x32_bf16 v[104:107], v[48:51], v[24:27], v[104:107]
v_mfma_f32_16x16x32_bf16 v[108:111], v[48:51], v[28:31], v[108:111]
v_mfma_f32_16x16x32_bf16 v[112:115], v[52:55], v[16:19], v[112:115]
v_mfma_f32_16x16x32_bf16 v[116:119], v[52:55], v[20:23], v[116:119]
v_mfma_f32_16x16x32_bf16 v[120:123], v[52:55], v[24:27], v[120:123]
v_mfma_f32_16x16x32_bf16 v[124:127], v[52:55], v[28:31], v[124:127]
s_waitcnt vmcnt(0)
s_barrier
ds_read_b128 v[16:19], v2 offset:49152
ds_read_b128 v[20:23], v2 offset:50176
ds_read_b128 v[24:27], v2 offset:51200
ds_read_b128 v[28:31], v2 offset:52224
ds_read_b64_tr_b16 v[48:49], v3 offset:18432
ds_read_b64_tr_b16 v[50:51], v3 offset:19968
ds_read_b64_tr_b16 v[52:53], v4 offset:18432
ds_read_b64_tr_b16 v[54:55], v4 offset:19968
s_waitcnt lgkmcnt(8)
v_mfma_f32_16x16x32_bf16 v[96:99], v[56:59], v[32:35], v[96:99]
v_mfma_f32_16x16x32_bf16 v[100:103], v[56:59], v[36:39], v[100:103]
v_mfma_f32_16x16x32_bf16 v[104:107], v[56:59], v[40:43], v[104:107]
v_mfma_f32_16x16x32_bf16 v[108:111], v[56:59], v[44:47], v[108:111]
v_mfma_f32_16x16x32_bf16 v[112:115], v[60:63], v[32:35], v[112:115]
v_mfma_f32_16x16x32_bf16 v[116:119], v[60:63], v[36:39], v[116:119]
v_mfma_f32_16x16x32_bf16 v[120:123], v[60:63], v[40:43], v[120:123]
v_mfma_f32_16x16x32_bf16 v[124:127], v[60:63], v[44:47], v[124:127]
ds_read_b128 v[32:35], v2 offset:16384
ds_read_b128 v[36:39], v2 offset:17408
ds_read_b128 v[40:43], v2 offset:18432
ds_read_b128 v[44:47], v2 offset:19456
ds_read_b64_tr_b16 v[56:57], v3 offset:6208
ds_read_b64_tr_b16 v[58:59], v3 offset:7744
ds_read_b64_tr_b16 v[60:61], v4 offset:6208
ds_read_b64_tr_b16 v[62:63], v4 offset:7744
s_waitcnt lgkmcnt(8)
v_mfma_f32_16x16x32_bf16 v[96:99], v[48:51], v[16:19], v[96:99]
v_mfma_f32_16x16x32_bf16 v[100:103], v[48:51], v[20:23], v[100:103]
v_mfma_f32_16x16x32_bf16 v[104:107], v[48:51], v[24:27], v[104:107]
v_mfma_f32_16x16x32_bf16 v[108:111], v[48:51], v[28:31], v[108:111]
v_mfma_f32_16x16x32_bf16 v[112:115], v[52:55], v[16:19], v[112:115]
v_mfma_f32_16x16x32_bf16 v[116:119], v[52:55], v[20:23], v[116:119]
v_mfma_f32_16x16x32_bf16 v[120:123], v[52:55], v[24:27], v[120:123]
v_mfma_f32_16x16x32_bf16 v[124:127], v[52:55], v[28:31], v[124:127]
ds_read_b128 v[16:19], v2 offset:32768
ds_read_b128 v[20:23], v2 offset:33792
ds_read_b128 v[24:27], v2 offset:34816
ds_read_b128 v[28:31], v2 offset:35840
ds_read_b64_tr_b16 v[48:49], v3 offset:12352
ds_read_b64_tr_b16 v[50:51], v3 offset:13888
ds_read_b64_tr_b16 v[52:53], v4 offset:12352
ds_read_b64_tr_b16 v[54:55], v4 offset:13888
s_waitcnt lgkmcnt(8)
v_mfma_f32_16x16x32_bf16 v[128:131], v[56:59], v[32:35], v[128:131]
v_mfma_f32_16x16x32_bf16 v[132:135], v[56:59], v[36:39], v[132:135]
v_mfma_f32_16x16x32_bf16 v[136:139], v[56:59], v[40:43], v[136:139]
v_mfma_f32_16x16x32_bf16 v[140:143], v[56:59], v[44:47], v[140:143]
v_pk_mul_f32 v[96:97], v[96:97], s[78:79]
v_pk_mul_f32 v[98:99], v[98:99], s[78:79]
v_mfma_f32_16x16x32_bf16 v[144:147], v[60:63], v[32:35], v[144:147]
v_pk_mul_f32 v[100:101], v[100:101], s[78:79]
v_pk_mul_f32 v[102:103], v[102:103], s[78:79]
v_mfma_f32_16x16x32_bf16 v[148:151], v[60:63], v[36:39], v[148:151]
v_pk_mul_f32 v[104:105], v[104:105], s[78:79]
v_pk_mul_f32 v[106:107], v[106:107], s[78:79]
v_mfma_f32_16x16x32_bf16 v[152:155], v[60:63], v[40:43], v[152:155]
v_pk_mul_f32 v[108:109], v[108:109], s[78:79]
v_pk_mul_f32 v[110:111], v[110:111], s[78:79]
v_mfma_f32_16x16x32_bf16 v[156:159], v[60:63], v[44:47], v[156:159]
v_pk_mul_f32 v[112:113], v[112:113], s[78:79]
v_pk_mul_f32 v[114:115], v[114:115], s[78:79]
ds_read_b128 v[32:35], v2 offset:49152
ds_read_b128 v[36:39], v2 offset:50176
ds_read_b128 v[40:43], v2 offset:51200
ds_read_b128 v[44:47], v2 offset:52224
ds_read_b64_tr_b16 v[56:57], v3 offset:18496
ds_read_b64_tr_b16 v[58:59], v3 offset:20032
ds_read_b64_tr_b16 v[60:61], v4 offset:18496
ds_read_b64_tr_b16 v[62:63], v4 offset:20032
s_waitcnt lgkmcnt(8)
v_mfma_f32_16x16x32_bf16 v[128:131], v[48:51], v[16:19], v[128:131]
v_pk_mul_f32 v[116:117], v[116:117], s[78:79]
v_pk_mul_f32 v[118:119], v[118:119], s[78:79]
v_mfma_f32_16x16x32_bf16 v[132:135], v[48:51], v[20:23], v[132:135]
v_pk_mul_f32 v[120:121], v[120:121], s[78:79]
v_pk_mul_f32 v[122:123], v[122:123], s[78:79]
v_mfma_f32_16x16x32_bf16 v[136:139], v[48:51], v[24:27], v[136:139]
v_pk_mul_f32 v[124:125], v[124:125], s[78:79]
v_pk_mul_f32 v[126:127], v[126:127], s[78:79]
v_mfma_f32_16x16x32_bf16 v[140:143], v[48:51], v[28:31], v[140:143]
v_cvt_pk_bf16_f32 v68, v96, v97
v_cvt_pk_bf16_f32 v69, v98, v99
v_mfma_f32_16x16x32_bf16 v[144:147], v[52:55], v[16:19], v[144:147]
v_cvt_pk_bf16_f32 v70, v112, v113
v_cvt_pk_bf16_f32 v71, v114, v115
v_mfma_f32_16x16x32_bf16 v[148:151], v[52:55], v[20:23], v[148:151]
v_cvt_pk_bf16_f32 v72, v100, v101
v_cvt_pk_bf16_f32 v73, v102, v103
v_mfma_f32_16x16x32_bf16 v[152:155], v[52:55], v[24:27], v[152:155]
v_cvt_pk_bf16_f32 v74, v116, v117
v_cvt_pk_bf16_f32 v75, v118, v119
v_mfma_f32_16x16x32_bf16 v[156:159], v[52:55], v[28:31], v[156:159]
v_cvt_pk_bf16_f32 v76, v104, v105
v_cvt_pk_bf16_f32 v77, v106, v107
ds_read_b128 v[16:19], v2 offset:16384
ds_read_b128 v[20:23], v2 offset:17408
ds_read_b128 v[24:27], v2 offset:18432
ds_read_b128 v[28:31], v2 offset:19456
ds_read_b64_tr_b16 v[48:49], v3 offset:6272
ds_read_b64_tr_b16 v[50:51], v3 offset:7808
ds_read_b64_tr_b16 v[52:53], v4 offset:6272
ds_read_b64_tr_b16 v[54:55], v4 offset:7808
s_waitcnt lgkmcnt(8)
v_mfma_f32_16x16x32_bf16 v[128:131], v[56:59], v[32:35], v[128:131]
v_cvt_pk_bf16_f32 v78, v120, v121
v_cvt_pk_bf16_f32 v79, v122, v123
v_mfma_f32_16x16x32_bf16 v[132:135], v[56:59], v[36:39], v[132:135]
v_cvt_pk_bf16_f32 v80, v108, v109
v_cvt_pk_bf16_f32 v81, v110, v111
v_mfma_f32_16x16x32_bf16 v[136:139], v[56:59], v[40:43], v[136:139]
v_cvt_pk_bf16_f32 v82, v124, v125
v_cvt_pk_bf16_f32 v83, v126, v127
v_mfma_f32_16x16x32_bf16 v[140:143], v[56:59], v[44:47], v[140:143]
buffer_store_dwordx4 v[68:71], v93, s[12:15], 0 offen offset:0 sc1
v_mfma_f32_16x16x32_bf16 v[144:147], v[60:63], v[32:35], v[144:147]
buffer_store_dwordx4 v[72:75], v93, s[12:15], 0 offen offset:256 sc1
v_mfma_f32_16x16x32_bf16 v[148:151], v[60:63], v[36:39], v[148:151]
buffer_store_dwordx4 v[76:79], v93, s[12:15], 0 offen offset:2048 sc1
v_mfma_f32_16x16x32_bf16 v[152:155], v[60:63], v[40:43], v[152:155]
buffer_store_dwordx4 v[80:83], v93, s[12:15], 0 offen offset:2304 sc1
v_mfma_f32_16x16x32_bf16 v[156:159], v[60:63], v[44:47], v[156:159]
s_nop 1
ds_read_b128 v[32:35], v2 offset:32768
ds_read_b128 v[36:39], v2 offset:33792
ds_read_b128 v[40:43], v2 offset:34816
ds_read_b128 v[44:47], v2 offset:35840
ds_read_b64_tr_b16 v[56:57], v3 offset:12416
ds_read_b64_tr_b16 v[58:59], v3 offset:13952
ds_read_b64_tr_b16 v[60:61], v4 offset:12416
ds_read_b64_tr_b16 v[62:63], v4 offset:13952
s_waitcnt lgkmcnt(8)
v_mfma_f32_16x16x32_bf16 v[160:163], v[16:19], v[48:51], v[160:163]
v_mfma_f32_16x16x32_bf16 v[164:167], v[20:23], v[48:51], v[164:167]
v_mfma_f32_16x16x32_bf16 v[168:171], v[24:27], v[48:51], v[168:171]
v_mfma_f32_16x16x32_bf16 v[172:175], v[28:31], v[48:51], v[172:175]
v_cvt_pk_bf16_f32 v68, v128, v129
v_mfma_f32_16x16x32_bf16 v[176:179], v[16:19], v[52:55], v[176:179]
v_cvt_pk_bf16_f32 v69, v130, v131
v_mfma_f32_16x16x32_bf16 v[180:183], v[20:23], v[52:55], v[180:183]
v_cvt_pk_bf16_f32 v70, v144, v145
v_mfma_f32_16x16x32_bf16 v[184:187], v[24:27], v[52:55], v[184:187]
v_cvt_pk_bf16_f32 v71, v146, v147
v_mfma_f32_16x16x32_bf16 v[188:191], v[28:31], v[52:55], v[188:191]
v_cvt_pk_bf16_f32 v72, v132, v133
ds_read_b128 v[16:19], v2 offset:49152
ds_read_b128 v[20:23], v2 offset:50176
ds_read_b128 v[24:27], v2 offset:51200
ds_read_b128 v[28:31], v2 offset:52224
ds_read_b64_tr_b16 v[48:49], v3 offset:18560
ds_read_b64_tr_b16 v[50:51], v3 offset:20096
ds_read_b64_tr_b16 v[52:53], v4 offset:18560
ds_read_b64_tr_b16 v[54:55], v4 offset:20096
s_waitcnt lgkmcnt(8)
v_mfma_f32_16x16x32_bf16 v[160:163], v[32:35], v[56:59], v[160:163]
v_cvt_pk_bf16_f32 v73, v134, v135
v_mfma_f32_16x16x32_bf16 v[164:167], v[36:39], v[56:59], v[164:167]
v_cvt_pk_bf16_f32 v74, v148, v149
v_mfma_f32_16x16x32_bf16 v[168:171], v[40:43], v[56:59], v[168:171]
v_cvt_pk_bf16_f32 v75, v150, v151
v_mfma_f32_16x16x32_bf16 v[172:175], v[44:47], v[56:59], v[172:175]
v_cvt_pk_bf16_f32 v76, v136, v137
v_mfma_f32_16x16x32_bf16 v[176:179], v[32:35], v[60:63], v[176:179]
v_cvt_pk_bf16_f32 v77, v138, v139
v_mfma_f32_16x16x32_bf16 v[180:183], v[36:39], v[60:63], v[180:183]
v_cvt_pk_bf16_f32 v78, v152, v153
v_mfma_f32_16x16x32_bf16 v[184:187], v[40:43], v[60:63], v[184:187]
v_cvt_pk_bf16_f32 v79, v154, v155
v_mfma_f32_16x16x32_bf16 v[188:191], v[44:47], v[60:63], v[188:191]
v_cvt_pk_bf16_f32 v80, v140, v141
ds_read_b128 v[32:35], v2 offset:16384
ds_read_b128 v[36:39], v2 offset:17408
ds_read_b128 v[40:43], v2 offset:18432
ds_read_b128 v[44:47], v2 offset:19456
ds_read_b64_tr_b16 v[56:57], v5 offset:14592
ds_read_b64_tr_b16 v[58:59], v5 offset:16384
ds_read_b64_tr_b16 v[60:61], v5 offset:21888
ds_read_b64_tr_b16 v[62:63], v5 offset:23680
s_waitcnt lgkmcnt(8)
v_mfma_f32_16x16x32_bf16 v[160:163], v[16:19], v[48:51], v[160:163]
v_cvt_pk_bf16_f32 v81, v142, v143
v_mfma_f32_16x16x32_bf16 v[164:167], v[20:23], v[48:51], v[164:167]
v_cvt_pk_bf16_f32 v82, v156, v157
v_mfma_f32_16x16x32_bf16 v[168:171], v[24:27], v[48:51], v[168:171]
v_cvt_pk_bf16_f32 v83, v158, v159
v_mfma_f32_16x16x32_bf16 v[172:175], v[28:31], v[48:51], v[172:175]
buffer_store_dwordx4 v[68:71], v94, s[12:15], 0 offen offset:0 sc1
v_mfma_f32_16x16x32_bf16 v[176:179], v[16:19], v[52:55], v[176:179]
buffer_store_dwordx4 v[72:75], v94, s[12:15], 0 offen offset:256 sc1
v_mfma_f32_16x16x32_bf16 v[180:183], v[20:23], v[52:55], v[180:183]
buffer_store_dwordx4 v[76:79], v94, s[12:15], s75 offen offset:0 sc1
v_mfma_f32_16x16x32_bf16 v[184:187], v[24:27], v[52:55], v[184:187]
buffer_store_dwordx4 v[80:83], v94, s[12:15], s75 offen offset:256 sc1
v_mfma_f32_16x16x32_bf16 v[188:191], v[28:31], v[52:55], v[188:191]
s_nop 1
ds_read_b128 v[16:19], v2 offset:32768
ds_read_b128 v[20:23], v2 offset:33792
ds_read_b128 v[24:27], v2 offset:34816
ds_read_b128 v[28:31], v2 offset:35840
ds_read_b64_tr_b16 v[48:49], v5 offset:29184
ds_read_b64_tr_b16 v[50:51], v5 offset:30976
ds_read_b64_tr_b16 v[52:53], v5 offset:36480
ds_read_b64_tr_b16 v[54:55], v5 offset:38272
s_waitcnt lgkmcnt(8)
v_mfma_f32_16x16x32_bf16 v[192:195], v[56:59], v[32:35], v[192:195]
v_mfma_f32_16x16x32_bf16 v[196:199], v[56:59], v[36:39], v[196:199]
v_mfma_f32_16x16x32_bf16 v[200:203], v[56:59], v[40:43], v[200:203]
v_mfma_f32_16x16x32_bf16 v[204:207], v[56:59], v[44:47], v[204:207]
v_cvt_pk_bf16_f32 v68, v160, v161
v_cvt_pk_bf16_f32 v69, v162, v163
v_mfma_f32_16x16x32_bf16 v[208:211], v[60:63], v[32:35], v[208:211]
v_cvt_pk_bf16_f32 v70, v164, v165
v_cvt_pk_bf16_f32 v71, v166, v167
v_mfma_f32_16x16x32_bf16 v[212:215], v[60:63], v[36:39], v[212:215]
v_cvt_pk_bf16_f32 v72, v168, v169
v_cvt_pk_bf16_f32 v73, v170, v171
v_mfma_f32_16x16x32_bf16 v[216:219], v[60:63], v[40:43], v[216:219]
v_cvt_pk_bf16_f32 v74, v172, v173
v_cvt_pk_bf16_f32 v75, v174, v175
v_mfma_f32_16x16x32_bf16 v[220:223], v[60:63], v[44:47], v[220:223]
v_cvt_pk_bf16_f32 v76, v176, v177
v_cvt_pk_bf16_f32 v77, v178, v179
ds_read_b128 v[32:35], v2 offset:49152
ds_read_b128 v[36:39], v2 offset:50176
ds_read_b128 v[40:43], v2 offset:51200
ds_read_b128 v[44:47], v2 offset:52224
ds_read_b64_tr_b16 v[56:57], v5 offset:43776
ds_read_b64_tr_b16 v[58:59], v5 offset:45568
ds_read_b64_tr_b16 v[60:61], v5 offset:51072
ds_read_b64_tr_b16 v[62:63], v5 offset:52864
s_waitcnt lgkmcnt(8)
v_mfma_f32_16x16x32_bf16 v[192:195], v[48:51], v[16:19], v[192:195]
v_cvt_pk_bf16_f32 v78, v180, v181
v_cvt_pk_bf16_f32 v79, v182, v183
v_mfma_f32_16x16x32_bf16 v[196:199], v[48:51], v[20:23], v[196:199]
v_cvt_pk_bf16_f32 v80, v184, v185
v_cvt_pk_bf16_f32 v81, v186, v187
v_mfma_f32_16x16x32_bf16 v[200:203], v[48:51], v[24:27], v[200:203]
v_cvt_pk_bf16_f32 v82, v188, v189
v_cvt_pk_bf16_f32 v83, v190, v191
v_mfma_f32_16x16x32_bf16 v[204:207], v[48:51], v[28:31], v[204:207]
s_nop 1
v_permlane32_swap_b32 v68, v70
v_mfma_f32_16x16x32_bf16 v[208:211], v[52:55], v[16:19], v[208:211]
v_permlane32_swap_b32 v69, v71
v_mfma_f32_16x16x32_bf16 v[212:215], v[52:55], v[20:23], v[212:215]
v_permlane32_swap_b32 v72, v74
v_mfma_f32_16x16x32_bf16 v[216:219], v[52:55], v[24:27], v[216:219]
v_permlane32_swap_b32 v73, v75
v_mfma_f32_16x16x32_bf16 v[220:223], v[52:55], v[28:31], v[220:223]
v_permlane32_swap_b32 v76, v78
ds_read_b128 v[16:19], v2 offset:16384
ds_read_b128 v[20:23], v2 offset:17408
ds_read_b128 v[24:27], v2 offset:18432
ds_read_b128 v[28:31], v2 offset:19456
ds_read_b64_tr_b16 v[48:49], v5 offset:14624
ds_read_b64_tr_b16 v[50:51], v5 offset:16416
ds_read_b64_tr_b16 v[52:53], v5 offset:21920
ds_read_b64_tr_b16 v[54:55], v5 offset:23712
s_waitcnt lgkmcnt(8)
v_mfma_f32_16x16x32_bf16 v[192:195], v[56:59], v[32:35], v[192:195]
v_permlane32_swap_b32 v77, v79
v_mfma_f32_16x16x32_bf16 v[196:199], v[56:59], v[36:39], v[196:199]
v_permlane32_swap_b32 v80, v82
v_mfma_f32_16x16x32_bf16 v[200:203], v[56:59], v[40:43], v[200:203]
v_permlane32_swap_b32 v81, v83
v_mfma_f32_16x16x32_bf16 v[204:207], v[56:59], v[44:47], v[204:207]
buffer_store_dwordx4 v[68:71], v95, s[12:15], 0 offen offset:2048 sc1
v_mfma_f32_16x16x32_bf16 v[208:211], v[60:63], v[32:35], v[208:211]
buffer_store_dwordx4 v[72:75], v95, s[12:15], s75 offen offset:2048 sc1
v_mfma_f32_16x16x32_bf16 v[212:215], v[60:63], v[36:39], v[212:215]
buffer_store_dwordx4 v[76:79], v95, s[12:15], 0 offen offset:2304 sc1
v_mfma_f32_16x16x32_bf16 v[216:219], v[60:63], v[40:43], v[216:219]
buffer_store_dwordx4 v[80:83], v95, s[12:15], s75 offen offset:2304 sc1
v_mfma_f32_16x16x32_bf16 v[220:223], v[60:63], v[44:47], v[220:223]
s_nop 1
ds_read_b128 v[32:35], v2 offset:32768
ds_read_b128 v[36:39], v2 offset:33792
ds_read_b128 v[40:43], v2 offset:34816
ds_read_b128 v[44:47], v2 offset:35840
ds_read_b64_tr_b16 v[56:57], v5 offset:29216
ds_read_b64_tr_b16 v[58:59], v5 offset:31008
ds_read_b64_tr_b16 v[60:61], v5 offset:36512
ds_read_b64_tr_b16 v[62:63], v5 offset:38304
s_waitcnt lgkmcnt(8)
v_mfma_f32_16x16x32_bf16 v[224:227], v[48:51], v[16:19], v[224:227]
v_mfma_f32_16x16x32_bf16 v[228:231], v[48:51], v[20:23], v[228:231]
v_mfma_f32_16x16x32_bf16 v[232:235], v[48:51], v[24:27], v[232:235]
v_mfma_f32_16x16x32_bf16 v[236:239], v[48:51], v[28:31], v[236:239]
v_pk_mul_f32 v[68:69], v[192:193], s[76:77]
v_pk_mul_f32 v[70:71], v[194:195], s[76:77]
v_pk_mul_f32 v[72:73], v[196:197], s[76:77]
v_pk_mul_f32 v[74:75], v[198:199], s[76:77]
v_mfma_f32_16x16x32_bf16 v[240:243], v[52:55], v[16:19], v[240:243]
v_pk_mul_f32 v[76:77], v[200:201], s[76:77]
v_pk_mul_f32 v[78:79], v[202:203], s[76:77]
v_pk_mul_f32 v[80:81], v[204:205], s[76:77]
v_pk_mul_f32 v[82:83], v[206:207], s[76:77]
v_mfma_f32_16x16x32_bf16 v[244:247], v[52:55], v[20:23], v[244:247]
v_exp_f32 v68, v68
v_exp_f32 v69, v69
v_exp_f32 v70, v70
v_exp_f32 v71, v71
v_mfma_f32_16x16x32_bf16 v[248:251], v[52:55], v[24:27], v[248:251]
v_exp_f32 v72, v72
v_exp_f32 v73, v73
v_exp_f32 v74, v74
v_exp_f32 v75, v75
v_mfma_f32_16x16x32_bf16 v[252:255], v[52:55], v[28:31], v[252:255]
v_exp_f32 v76, v76
v_exp_f32 v77, v77
v_exp_f32 v78, v78
v_exp_f32 v79, v79
ds_read_b128 v[16:19], v2 offset:49152
ds_read_b128 v[20:23], v2 offset:50176
ds_read_b128 v[24:27], v2 offset:51200
ds_read_b128 v[28:31], v2 offset:52224
ds_read_b64_tr_b16 v[48:49], v5 offset:43808
ds_read_b64_tr_b16 v[50:51], v5 offset:45600
ds_read_b64_tr_b16 v[52:53], v5 offset:51104
ds_read_b64_tr_b16 v[54:55], v5 offset:52896
s_waitcnt lgkmcnt(8)
v_mfma_f32_16x16x32_bf16 v[224:227], v[56:59], v[32:35], v[224:227]
v_exp_f32 v80, v80
v_exp_f32 v81, v81
v_exp_f32 v82, v82
v_exp_f32 v83, v83
v_mfma_f32_16x16x32_bf16 v[228:231], v[56:59], v[36:39], v[228:231]
v_pk_mul_f32 v[192:193], v[192:193], v[208:209]
v_pk_mul_f32 v[194:195], v[194:195], v[210:211]
v_pk_mul_f32 v[196:197], v[196:197], v[212:213]
v_pk_mul_f32 v[198:199], v[198:199], v[214:215]
v_mfma_f32_16x16x32_bf16 v[232:235], v[56:59], v[40:43], v[232:235]
v_pk_mul_f32 v[200:201], v[200:201], v[216:217]
v_pk_mul_f32 v[202:203], v[202:203], v[218:219]
v_pk_mul_f32 v[204:205], v[204:205], v[220:221]
v_pk_mul_f32 v[206:207], v[206:207], v[222:223]
v_mfma_f32_16x16x32_bf16 v[236:239], v[56:59], v[44:47], v[236:239]
v_pk_add_f32 v[68:69], v[68:69], s[72:73]
v_pk_add_f32 v[70:71], v[70:71], s[72:73]
v_pk_add_f32 v[72:73], v[72:73], s[72:73]
v_pk_add_f32 v[74:75], v[74:75], s[72:73]
v_mfma_f32_16x16x32_bf16 v[240:243], v[60:63], v[32:35], v[240:243]
v_pk_add_f32 v[76:77], v[76:77], s[72:73]
v_pk_add_f32 v[78:79], v[78:79], s[72:73]
v_pk_add_f32 v[80:81], v[80:81], s[72:73]
v_pk_add_f32 v[82:83], v[82:83], s[72:73]
v_mfma_f32_16x16x32_bf16 v[244:247], v[60:63], v[36:39], v[244:247]
v_rcp_f32 v68, v68
v_rcp_f32 v69, v69
v_rcp_f32 v70, v70
v_rcp_f32 v71, v71
v_mfma_f32_16x16x32_bf16 v[248:251], v[60:63], v[40:43], v[248:251]
v_rcp_f32 v72, v72
v_rcp_f32 v73, v73
v_rcp_f32 v74, v74
v_rcp_f32 v75, v75
v_mfma_f32_16x16x32_bf16 v[252:255], v[60:63], v[44:47], v[252:255]
v_rcp_f32 v76, v76
v_rcp_f32 v77, v77
v_rcp_f32 v78, v78
v_rcp_f32 v79, v79
s_waitcnt lgkmcnt(0)
v_mfma_f32_16x16x32_bf16 v[224:227], v[48:51], v[16:19], v[224:227]
v_rcp_f32 v80, v80
v_rcp_f32 v81, v81
v_rcp_f32 v82, v82
v_rcp_f32 v83, v83
v_mfma_f32_16x16x32_bf16 v[228:231], v[48:51], v[20:23], v[228:231]
s_mov_b32 s74, 0
v_pk_mul_f32 v[192:193], v[192:193], v[68:69]
v_pk_mul_f32 v[194:195], v[194:195], v[70:71]
v_pk_mul_f32 v[196:197], v[196:197], v[72:73]
v_mfma_f32_16x16x32_bf16 v[232:235], v[48:51], v[24:27], v[232:235]
v_pk_mul_f32 v[198:199], v[198:199], v[74:75]
v_pk_mul_f32 v[200:201], v[200:201], v[76:77]
v_pk_mul_f32 v[202:203], v[202:203], v[78:79]
v_pk_mul_f32 v[204:205], v[204:205], v[80:81]
v_mfma_f32_16x16x32_bf16 v[236:239], v[48:51], v[28:31], v[236:239]
v_pk_mul_f32 v[206:207], v[206:207], v[82:83]
v_cvt_pk_bf16_f32 v208, v192, v193
v_cvt_pk_bf16_f32 v209, v194, v195
v_cvt_pk_bf16_f32 v210, v196, v197
v_mfma_f32_16x16x32_bf16 v[240:243], v[52:55], v[16:19], v[240:243]
v_cvt_pk_bf16_f32 v211, v198, v199
v_cvt_pk_bf16_f32 v212, v200, v201
v_cvt_pk_bf16_f32 v213, v202, v203
v_mfma_f32_16x16x32_bf16 v[244:247], v[52:55], v[20:23], v[244:247]
v_cvt_pk_bf16_f32 v214, v204, v205
v_cvt_pk_bf16_f32 v215, v206, v207
s_nop 1
v_mfma_f32_16x16x32_bf16 v[248:251], v[52:55], v[24:27], v[248:251]
v_permlane32_swap_b32 v208, v210
v_permlane32_swap_b32 v209, v211
v_permlane32_swap_b32 v212, v214
v_mfma_f32_16x16x32_bf16 v[252:255], v[52:55], v[28:31], v[252:255]
v_permlane32_swap_b32 v213, v215
buffer_store_dwordx4 v[208:211], v91, s[12:15], s74 offen sc1
buffer_store_dwordx4 v[212:215], v92, s[12:15], s74 offen sc1
s_nop 15
v_pk_mul_f32 v[68:69], v[224:225], s[76:77]
v_pk_mul_f32 v[70:71], v[226:227], s[76:77]
v_pk_mul_f32 v[72:73], v[228:229], s[76:77]
v_pk_mul_f32 v[74:75], v[230:231], s[76:77]
v_pk_mul_f32 v[76:77], v[232:233], s[76:77]
v_pk_mul_f32 v[78:79], v[234:235], s[76:77]
v_pk_mul_f32 v[80:81], v[236:237], s[76:77]
v_pk_mul_f32 v[82:83], v[238:239], s[76:77]
v_exp_f32 v68, v68
v_exp_f32 v69, v69
v_exp_f32 v70, v70
v_exp_f32 v71, v71
v_exp_f32 v72, v72
v_exp_f32 v73, v73
v_exp_f32 v74, v74
v_exp_f32 v75, v75
v_exp_f32 v76, v76
v_exp_f32 v77, v77
v_exp_f32 v78, v78
v_exp_f32 v79, v79
v_exp_f32 v80, v80
v_exp_f32 v81, v81
v_exp_f32 v82, v82
v_exp_f32 v83, v83
v_pk_mul_f32 v[224:225], v[224:225], v[240:241]
v_pk_mul_f32 v[226:227], v[226:227], v[242:243]
v_pk_mul_f32 v[228:229], v[228:229], v[244:245]
v_pk_mul_f32 v[230:231], v[230:231], v[246:247]
v_pk_mul_f32 v[232:233], v[232:233], v[248:249]
v_pk_mul_f32 v[234:235], v[234:235], v[250:251]
v_pk_mul_f32 v[236:237], v[236:237], v[252:253]
v_pk_mul_f32 v[238:239], v[238:239], v[254:255]
v_pk_add_f32 v[68:69], v[68:69], s[72:73]
v_pk_add_f32 v[70:71], v[70:71], s[72:73]
v_pk_add_f32 v[72:73], v[72:73], s[72:73]
v_pk_add_f32 v[74:75], v[74:75], s[72:73]
v_pk_add_f32 v[76:77], v[76:77], s[72:73]
v_pk_add_f32 v[78:79], v[78:79], s[72:73]
v_pk_add_f32 v[80:81], v[80:81], s[72:73]
v_pk_add_f32 v[82:83], v[82:83], s[72:73]
v_rcp_f32 v68, v68
v_rcp_f32 v69, v69
v_rcp_f32 v70, v70
v_rcp_f32 v71, v71
v_rcp_f32 v72, v72
v_rcp_f32 v73, v73
v_rcp_f32 v74, v74
v_rcp_f32 v75, v75
v_rcp_f32 v76, v76
v_rcp_f32 v77, v77
v_rcp_f32 v78, v78
v_rcp_f32 v79, v79
v_rcp_f32 v80, v80
v_rcp_f32 v81, v81
v_rcp_f32 v82, v82
v_rcp_f32 v83, v83
s_mov_b32 s74, 1024
v_pk_mul_f32 v[224:225], v[224:225], v[68:69]
v_pk_mul_f32 v[226:227], v[226:227], v[70:71]
v_pk_mul_f32 v[228:229], v[228:229], v[72:73]
v_pk_mul_f32 v[230:231], v[230:231], v[74:75]
v_pk_mul_f32 v[232:233], v[232:233], v[76:77]
v_pk_mul_f32 v[234:235], v[234:235], v[78:79]
v_pk_mul_f32 v[236:237], v[236:237], v[80:81]
v_pk_mul_f32 v[238:239], v[238:239], v[82:83]
v_cvt_pk_bf16_f32 v240, v224, v225
v_cvt_pk_bf16_f32 v241, v226, v227
v_cvt_pk_bf16_f32 v242, v228, v229
v_cvt_pk_bf16_f32 v243, v230, v231
v_cvt_pk_bf16_f32 v244, v232, v233
v_cvt_pk_bf16_f32 v245, v234, v235
v_cvt_pk_bf16_f32 v246, v236, v237
v_cvt_pk_bf16_f32 v247, v238, v239
s_nop 1
v_permlane32_swap_b32 v240, v242
v_permlane32_swap_b32 v241, v243
v_permlane32_swap_b32 v244, v246
v_permlane32_swap_b32 v245, v247
buffer_store_dwordx4 v[240:243], v91, s[12:15], s74 offen sc1
buffer_store_dwordx4 v[244:247], v92, s[12:15], s74 offen sc1
s_endpgm
L_k1_path1:
s_add_u32 s84, s31, 12
s_sub_u32 s63, s84, 6
s_mov_b32 s36, 229376
s_mov_b32 s64, 90112
s_mov_b32 s65, 14592
s_sub_u32 s67, s84, 13
s_cmp_ge_u32 s84, 13
s_cselect_b32 s63, s67, s63
s_cselect_b32 s64, 97408, s64
s_cmp_lt_u32 s84, 6
s_cselect_b32 s63, s84, s63
s_cselect_b32 s36, 196608, s36
s_cselect_b32 s64, 65536, s64
s_cselect_b32 s65, 6144, s65
s_cselect_b64 s[68:69], -1, 0
s_lshl_b32 s66, s63, 10
s_add_u32 s48, s64, s66
s_add_u32 s49, s48, s65
s_add_u32 s50, s49, s65
s_add_u32 s51, s50, s65
s_mov_b32 s33, 0
s_lshl_b32 s66, s63, 6
v_add_u32 v11, s66, v1
v_mul_u32_u24 v12, 5462, v11
v_lshrrev_b32 v12, 16, v12
v_mul_u32_u24 v13, 12, v12
v_sub_u32 v13, v11, v13
v_mul_u32_u24 v14, 6144, v12
v_bfe_u32 v12, v12, 2, 1
v_lshlrev_b32 v12, 1, v12
v_xor_b32 v13, v13, v12
v_lshrrev_b32 v12, 2, v13
v_lshl_add_u32 v14, v12, 11, v14
v_and_b32 v12, 3, v13
v_lshl_add_u32 v14, v12, 4, v14
s_lshl_b32 s66, s28, 6
v_add_u32 v14, s66, v14
v_mul_u32_u24 v12, 4682, v11
v_lshrrev_b32 v12, 16, v12
v_mul_u32_u24 v13, 14, v12
v_sub_u32 v13, v11, v13
v_mul_u32_u24 v15, 7168, v12
v_lshl_add_u32 v15, v13, 4, v15
s_mul_i32 s66, s28, 224
v_add_u32 v15, s66, v15
v_cndmask_b32 v8, v15, v14, s[68:69]
s_add_u32 s85, s31, 16
s_sub_u32 s63, s85, 6
s_mov_b32 s37, 229376
s_mov_b32 s64, 90112
s_mov_b32 s65, 14592
s_sub_u32 s67, s85, 13
s_cmp_ge_u32 s85, 13
s_cselect_b32 s63, s67, s63
s_cselect_b32 s64, 97408, s64
s_cmp_lt_u32 s85, 6
s_cselect_b32 s63, s85, s63
s_cselect_b32 s37, 196608, s37
s_cselect_b32 s64, 65536, s64
s_cselect_b32 s65, 6144, s65
s_cselect_b64 s[68:69], -1, 0
s_lshl_b32 s66, s63, 10
s_add_u32 s52, s64, s66
s_add_u32 s53, s52, s65
s_add_u32 s54, s53, s65
s_add_u32 s55, s54, s65
s_mov_b32 s34, 0
s_lshl_b32 s66, s63, 6
v_add_u32 v11, s66, v1
v_mul_u32_u24 v12, 5462, v11
v_lshrrev_b32 v12, 16, v12
v_mul_u32_u24 v13, 12, v12
v_sub_u32 v13, v11, v13
v_mul_u32_u24 v14, 6144, v12
v_bfe_u32 v12, v12, 2, 1
v_lshlrev_b32 v12, 1, v12
v_xor_b32 v13, v13, v12
v_lshrrev_b32 v12, 2, v13
v_lshl_add_u32 v14, v12, 11, v14
v_and_b32 v12, 3, v13
v_lshl_add_u32 v14, v12, 4, v14
s_lshl_b32 s66, s28, 6
v_add_u32 v14, s66, v14
v_mul_u32_u24 v12, 4682, v11
v_lshrrev_b32 v12, 16, v12
v_mul_u32_u24 v13, 14, v12
v_sub_u32 v13, v11, v13
v_mul_u32_u24 v15, 7168, v12
v_lshl_add_u32 v15, v13, 4, v15
s_mul_i32 s66, s28, 224
v_add_u32 v15, s66, v15
v_cndmask_b32 v9, v15, v14, s[68:69]
s_mov_b32 s60, 0
s_mov_b32 s61, 0
s_lshr_b32 s83, s29, 2
s_and_b32 s62, s29, 3
s_add_u32 s62, s62, 5
s_mul_i32 s80, s62, s36
s_mul_i32 s81, s62, s37
s_waitcnt lgkmcnt(0)
s_mov_b32 s12, s10
s_and_b32 s13, s11, 0xffff
s_mov_b32 s14, 268435456
s_mov_b32 s15, 0x00020000
s_mov_b32 s16, s6
s_mov_b32 s17, s7
s_mov_b32 s18, 7340032
s_mov_b32 s19, 0x00020000
s_cmp_ge_u32 s84, 13
s_cselect_b32 s16, s8, s16
s_cselect_b32 s17, s9, s17
s_cselect_b32 s18, 7340032, s18
s_and_b32 s17, s17, 0xffff
s_mov_b32 s20, s8
s_mov_b32 s21, s9
s_mov_b32 s22, 7340032
s_mov_b32 s23, 0x00020000
s_and_b32 s21, s21, 0xffff
s_mov_b32 m0, s40
s_nop 0
buffer_load_dwordx4 v6, s[12:15], s32 offen lds
s_mov_b32 m0, s44
s_nop 0
buffer_load_dwordx4 v7, s[12:15], s32 offen lds
s_mov_b32 m0, s48
s_nop 0
buffer_load_dwordx4 v8, s[16:19], s33 offen lds
s_mov_b32 m0, s52
s_nop 0
buffer_load_dwordx4 v9, s[20:23], s34 offen lds
s_add_u32 s32, s32, 64
s_add_u32 s33, s33, s36
s_add_u32 s34, s34, s37
s_mov_b32 m0, s41
s_nop 0
buffer_load_dwordx4 v6, s[12:15], s32 offen lds
s_mov_b32 m0, s45
s_nop 0
buffer_load_dwordx4 v7, s[12:15], s32 offen lds
s_mov_b32 m0, s49
s_nop 0
buffer_load_dwordx4 v8, s[16:19], s33 offen lds
s_mov_b32 m0, s53
s_nop 0
buffer_load_dwordx4 v9, s[20:23], s34 offen lds
s_add_u32 s32, s32, 64
s_add_u32 s33, s33, s36
s_add_u32 s34, s34, s37
s_mov_b32 s84, s100
s_and_b32 s85, s101, 0xffff
s_mov_b32 s86, 7340032
s_mov_b32 s87, 0x00020000
s_lshl_b32 s39, s2, 3
s_add_u32 s39, s39, s30
s_lshl_b32 s39, s39, 10
s_sub_u32 s39, s39, 6291456
v_lshlrev_b32 v11, 4, v1
s_waitcnt vmcnt(4)
s_barrier
ds_read_b128 v[16:19], v2 offset:0
ds_read_b128 v[20:23], v2 offset:1024
ds_read_b128 v[24:27], v2 offset:2048
ds_read_b128 v[28:31], v2 offset:3072
ds_read_b64_tr_b16 v[48:49], v5 offset:64
ds_read_b64_tr_b16 v[50:51], v5 offset:1856
ds_read_b64_tr_b16 v[52:53], v5 offset:7360
ds_read_b64_tr_b16 v[54:55], v5 offset:9152
ds_read_b64_tr_b16 v[56:57], v5 offset:96
ds_read_b64_tr_b16 v[58:59], v5 offset:1888
ds_read_b64_tr_b16 v[60:61], v5 offset:7392
ds_read_b64_tr_b16 v[62:63], v5 offset:9184
s_waitcnt lgkmcnt(6)
v_mfma_f32_16x16x32_bf16 v[96:99], v[48:51], v[16:19], 0
v_mfma_f32_16x16x32_bf16 v[100:103], v[48:51], v[20:23], 0
v_mfma_f32_16x16x32_bf16 v[104:107], v[48:51], v[24:27], 0
v_mfma_f32_16x16x32_bf16 v[108:111], v[48:51], v[28:31], 0
ds_read_b64_tr_b16 v[48:49], v5 offset:128
ds_read_b64_tr_b16 v[50:51], v5 offset:1920
s_mov_b32 m0, s42
s_nop 0
buffer_load_dwordx4 v6, s[12:15], s32 offen lds
s_mov_b32 m0, s46
s_nop 0
buffer_load_dwordx4 v7, s[12:15], s32 offen lds
s_mov_b32 m0, s50
s_nop 0
buffer_load_dwordx4 v8, s[16:19], s33 offen lds
s_mov_b32 m0, s54
s_nop 0
buffer_load_dwordx4 v9, s[20:23], s34 offen lds
s_add_u32 s32, s32, 64
s_add_u32 s33, s33, s36
s_add_u32 s34, s34, s37
s_waitcnt lgkmcnt(6)
v_mfma_f32_16x16x32_bf16 v[112:115], v[52:55], v[16:19], 0
v_mfma_f32_16x16x32_bf16 v[116:119], v[52:55], v[20:23], 0
v_mfma_f32_16x16x32_bf16 v[120:123], v[52:55], v[24:27], 0
v_mfma_f32_16x16x32_bf16 v[124:127], v[52:55], v[28:31], 0
ds_read_b64_tr_b16 v[52:53], v5 offset:7424
ds_read_b64_tr_b16 v[54:55], v5 offset:9216
s_waitcnt lgkmcnt(6)
v_mfma_f32_16x16x32_bf16 v[128:131], v[56:59], v[16:19], 0
v_mfma_f32_16x16x32_bf16 v[132:135], v[56:59], v[20:23], 0
v_mfma_f32_16x16x32_bf16 v[136:139], v[56:59], v[24:27], 0
v_mfma_f32_16x16x32_bf16 v[140:143], v[56:59], v[28:31], 0
ds_read_b64_tr_b16 v[56:57], v5 offset:160
ds_read_b64_tr_b16 v[58:59], v5 offset:1952
s_waitcnt lgkmcnt(6)
v_mfma_f32_16x16x32_bf16 v[144:147], v[60:63], v[16:19], 0
v_mfma_f32_16x16x32_bf16 v[148:151], v[60:63], v[20:23], 0
v_mfma_f32_16x16x32_bf16 v[152:155], v[60:63], v[24:27], 0
v_mfma_f32_16x16x32_bf16 v[156:159], v[60:63], v[28:31], 0
ds_read_b64_tr_b16 v[60:61], v5 offset:7456
ds_read_b64_tr_b16 v[62:63], v5 offset:9248
s_waitcnt lgkmcnt(6)
v_mfma_f32_16x16x32_bf16 v[160:163], v[48:51], v[16:19], 0
v_mfma_f32_16x16x32_bf16 v[164:167], v[48:51], v[20:23], 0
v_mfma_f32_16x16x32_bf16 v[168:171], v[48:51], v[24:27], 0
v_mfma_f32_16x16x32_bf16 v[172:175], v[48:51], v[28:31], 0
ds_read_b64_tr_b16 v[48:49], v5 offset:192
ds_read_b64_tr_b16 v[50:51], v5 offset:1984
s_waitcnt lgkmcnt(6)
v_mfma_f32_16x16x32_bf16 v[176:179], v[52:55], v[16:19], 0
v_mfma_f32_16x16x32_bf16 v[180:183], v[52:55], v[20:23], 0
v_mfma_f32_16x16x32_bf16 v[184:187], v[52:55], v[24:27], 0
v_mfma_f32_16x16x32_bf16 v[188:191], v[52:55], v[28:31], 0
ds_read_b64_tr_b16 v[52:53], v5 offset:7488
ds_read_b64_tr_b16 v[54:55], v5 offset:9280
s_waitcnt vmcnt(4)
s_barrier
ds_read_b128 v[32:35], v2 offset:16384
ds_read_b128 v[36:39], v2 offset:17408
ds_read_b128 v[40:43], v2 offset:18432
ds_read_b128 v[44:47], v2 offset:19456
s_waitcnt lgkmcnt(10)
s_mov_b32 m0, s43
v_mfma_f32_16x16x32_bf16 v[192:195], v[56:59], v[16:19], 0
buffer_load_dwordx4 v6, s[12:15], s32 offen lds
v_mfma_f32_16x16x32_bf16 v[196:199], v[56:59], v[20:23], 0
v_mfma_f32_16x16x32_bf16 v[200:203], v[56:59], v[24:27], 0
v_mfma_f32_16x16x32_bf16 v[204:207], v[56:59], v[28:31], 0
ds_read_b64_tr_b16 v[56:57], v5 offset:14656
ds_read_b64_tr_b16 v[58:59], v5 offset:16448
s_waitcnt lgkmcnt(10)
s_mov_b32 m0, s47
v_mfma_f32_16x16x32_bf16 v[208:211], v[60:63], v[16:19], 0
buffer_load_dwordx4 v7, s[12:15], s32 offen lds
v_mfma_f32_16x16x32_bf16 v[212:215], v[60:63], v[20:23], 0
v_mfma_f32_16x16x32_bf16 v[216:219], v[60:63], v[24:27], 0
v_mfma_f32_16x16x32_bf16 v[220:223], v[60:63], v[28:31], 0
ds_read_b64_tr_b16 v[60:61], v5 offset:21952
ds_read_b64_tr_b16 v[62:63], v5 offset:23744
s_waitcnt lgkmcnt(10)
s_mov_b32 m0, s51
v_mfma_f32_16x16x32_bf16 v[224:227], v[48:51], v[16:19], 0
buffer_load_dwordx4 v8, s[16:19], s33 offen lds
v_mfma_f32_16x16x32_bf16 v[228:231], v[48:51], v[20:23], 0
v_mfma_f32_16x16x32_bf16 v[232:235], v[48:51], v[24:27], 0
v_mfma_f32_16x16x32_bf16 v[236:239], v[48:51], v[28:31], 0
ds_read_b64_tr_b16 v[48:49], v5 offset:14688
ds_read_b64_tr_b16 v[50:51], v5 offset:16480
s_waitcnt lgkmcnt(10)
s_mov_b32 m0, s55
v_mfma_f32_16x16x32_bf16 v[240:243], v[52:55], v[16:19], 0
buffer_load_dwordx4 v9, s[20:23], s34 offen lds
v_mfma_f32_16x16x32_bf16 v[244:247], v[52:55], v[20:23], 0
v_mfma_f32_16x16x32_bf16 v[248:251], v[52:55], v[24:27], 0
v_mfma_f32_16x16x32_bf16 v[252:255], v[52:55], v[28:31], 0
s_cmp_eq_u32 s61, s83
s_cbranch_scc0 L_k1_pfskip_4
s_add_u32 s62, s80, s33
buffer_load_dwordx4 v[68:71], v8, s[16:19], s62 offen
s_add_u32 s62, s81, s34
buffer_load_dwordx4 v[72:75], v9, s[20:23], s62 offen
L_k1_pfskip_4:
s_xor_b32 s61, s61, 1
buffer_load_dwordx4 v[80:83], v11, s[84:87], s39 offen
s_add_u32 s39, s39, 2097152
ds_read_b64_tr_b16 v[52:53], v5 offset:21984
ds_read_b64_tr_b16 v[54:55], v5 offset:23776
s_add_u32 s32, s32, 64
s_add_u32 s33, s33, s36
s_add_u32 s34, s34, s37
s_waitcnt lgkmcnt(6)
v_mfma_f32_16x16x32_bf16 v[96:99], v[56:59], v[32:35], v[96:99]
v_mfma_f32_16x16x32_bf16 v[100:103], v[56:59], v[36:39], v[100:103]
v_mfma_f32_16x16x32_bf16 v[104:107], v[56:59], v[40:43], v[104:107]
v_mfma_f32_16x16x32_bf16 v[108:111], v[56:59], v[44:47], v[108:111]
ds_read_b64_tr_b16 v[56:57], v5 offset:14720
ds_read_b64_tr_b16 v[58:59], v5 offset:16512
s_waitcnt lgkmcnt(6)
v_mfma_f32_16x16x32_bf16 v[112:115], v[60:63], v[32:35], v[112:115]
v_mfma_f32_16x16x32_bf16 v[116:119], v[60:63], v[36:39], v[116:119]
v_mfma_f32_16x16x32_bf16 v[120:123], v[60:63], v[40:43], v[120:123]
v_mfma_f32_16x16x32_bf16 v[124:127], v[60:63], v[44:47], v[124:127]
ds_read_b64_tr_b16 v[60:61], v5 offset:22016
ds_read_b64_tr_b16 v[62:63], v5 offset:23808
s_waitcnt lgkmcnt(6)
v_mfma_f32_16x16x32_bf16 v[128:131], v[48:51], v[32:35], v[128:131]
v_mfma_f32_16x16x32_bf16 v[132:135], v[48:51], v[36:39], v[132:135]
v_mfma_f32_16x16x32_bf16 v[136:139], v[48:51], v[40:43], v[136:139]
v_mfma_f32_16x16x32_bf16 v[140:143], v[48:51], v[44:47], v[140:143]
ds_read_b64_tr_b16 v[48:49], v5 offset:14752
ds_read_b64_tr_b16 v[50:51], v5 offset:16544
s_waitcnt lgkmcnt(6)
v_mfma_f32_16x16x32_bf16 v[144:147], v[52:55], v[32:35], v[144:147]
v_mfma_f32_16x16x32_bf16 v[148:151], v[52:55], v[36:39], v[148:151]
v_mfma_f32_16x16x32_bf16 v[152:155], v[52:55], v[40:43], v[152:155]
v_mfma_f32_16x16x32_bf16 v[156:159], v[52:55], v[44:47], v[156:159]
ds_read_b64_tr_b16 v[52:53], v5 offset:22048
ds_read_b64_tr_b16 v[54:55], v5 offset:23840
s_waitcnt lgkmcnt(6)
v_mfma_f32_16x16x32_bf16 v[160:163], v[56:59], v[32:35], v[160:163]
v_mfma_f32_16x16x32_bf16 v[164:167], v[56:59], v[36:39], v[164:167]
v_mfma_f32_16x16x32_bf16 v[168:171], v[56:59], v[40:43], v[168:171]
v_mfma_f32_16x16x32_bf16 v[172:175], v[56:59], v[44:47], v[172:175]
ds_read_b64_tr_b16 v[56:57], v5 offset:14784
ds_read_b64_tr_b16 v[58:59], v5 offset:16576
s_waitcnt lgkmcnt(6)
v_mfma_f32_16x16x32_bf16 v[176:179], v[60:63], v[32:35], v[176:179]
v_mfma_f32_16x16x32_bf16 v[180:183], v[60:63], v[36:39], v[180:183]
v_mfma_f32_16x16x32_bf16 v[184:187], v[60:63], v[40:43], v[184:187]
v_mfma_f32_16x16x32_bf16 v[188:191], v[60:63], v[44:47], v[188:191]
ds_read_b64_tr_b16 v[60:61], v5 offset:22080
ds_read_b64_tr_b16 v[62:63], v5 offset:23872
s_waitcnt vmcnt(4)
s_barrier
ds_read_b128 v[16:19], v2 offset:32768
ds_read_b128 v[20:23], v2 offset:33792
ds_read_b128 v[24:27], v2 offset:34816
ds_read_b128 v[28:31], v2 offset:35840
s_waitcnt lgkmcnt(10)
s_mov_b32 m0, s40
v_mfma_f32_16x16x32_bf16 v[192:195], v[48:51], v[32:35], v[192:195]
buffer_load_dwordx4 v6, s[12:15], s32 offen lds
v_mfma_f32_16x16x32_bf16 v[196:199], v[48:51], v[36:39], v[196:199]
v_mfma_f32_16x16x32_bf16 v[200:203], v[48:51], v[40:43], v[200:203]
v_mfma_f32_16x16x32_bf16 v[204:207], v[48:51], v[44:47], v[204:207]
ds_read_b64_tr_b16 v[48:49], v5 offset:29248
ds_read_b64_tr_b16 v[50:51], v5 offset:31040
s_waitcnt lgkmcnt(10)
s_mov_b32 m0, s44
v_mfma_f32_16x16x32_bf16 v[208:211], v[52:55], v[32:35], v[208:211]
buffer_load_dwordx4 v7, s[12:15], s32 offen lds
v_mfma_f32_16x16x32_bf16 v[212:215], v[52:55], v[36:39], v[212:215]
v_mfma_f32_16x16x32_bf16 v[216:219], v[52:55], v[40:43], v[216:219]
v_mfma_f32_16x16x32_bf16 v[220:223], v[52:55], v[44:47], v[220:223]
ds_read_b64_tr_b16 v[52:53], v5 offset:36544
ds_read_b64_tr_b16 v[54:55], v5 offset:38336
s_waitcnt lgkmcnt(10)
s_mov_b32 m0, s48
v_mfma_f32_16x16x32_bf16 v[224:227], v[56:59], v[32:35], v[224:227]
buffer_load_dwordx4 v8, s[16:19], s33 offen lds
v_mfma_f32_16x16x32_bf16 v[228:231], v[56:59], v[36:39], v[228:231]
v_mfma_f32_16x16x32_bf16 v[232:235], v[56:59], v[40:43], v[232:235]
v_mfma_f32_16x16x32_bf16 v[236:239], v[56:59], v[44:47], v[236:239]
ds_read_b64_tr_b16 v[56:57], v5 offset:29280
ds_read_b64_tr_b16 v[58:59], v5 offset:31072
s_waitcnt lgkmcnt(10)
s_mov_b32 m0, s52
v_mfma_f32_16x16x32_bf16 v[240:243], v[60:63], v[32:35], v[240:243]
buffer_load_dwordx4 v9, s[20:23], s34 offen lds
v_mfma_f32_16x16x32_bf16 v[244:247], v[60:63], v[36:39], v[244:247]
v_mfma_f32_16x16x32_bf16 v[248:251], v[60:63], v[40:43], v[248:251]
v_mfma_f32_16x16x32_bf16 v[252:255], v[60:63], v[44:47], v[252:255]
ds_read_b64_tr_b16 v[60:61], v5 offset:36576
ds_read_b64_tr_b16 v[62:63], v5 offset:38368
s_add_u32 s32, s32, 64
s_add_u32 s33, s33, s36
s_add_u32 s34, s34, s37
s_waitcnt lgkmcnt(6)
v_mfma_f32_16x16x32_bf16 v[96:99], v[48:51], v[16:19], v[96:99]
v_mfma_f32_16x16x32_bf16 v[100:103], v[48:51], v[20:23], v[100:103]
v_mfma_f32_16x16x32_bf16 v[104:107], v[48:51], v[24:27], v[104:107]
v_mfma_f32_16x16x32_bf16 v[108:111], v[48:51], v[28:31], v[108:111]
ds_read_b64_tr_b16 v[48:49], v5 offset:29312
ds_read_b64_tr_b16 v[50:51], v5 offset:31104
s_waitcnt lgkmcnt(6)
v_mfma_f32_16x16x32_bf16 v[112:115], v[52:55], v[16:19], v[112:115]
v_mfma_f32_16x16x32_bf16 v[116:119], v[52:55], v[20:23], v[116:119]
v_mfma_f32_16x16x32_bf16 v[120:123], v[52:55], v[24:27], v[120:123]
v_mfma_f32_16x16x32_bf16 v[124:127], v[52:55], v[28:31], v[124:127]
ds_read_b64_tr_b16 v[52:53], v5 offset:36608
ds_read_b64_tr_b16 v[54:55], v5 offset:38400
s_waitcnt lgkmcnt(6)
v_mfma_f32_16x16x32_bf16 v[128:131], v[56:59], v[16:19], v[128:131]
v_mfma_f32_16x16x32_bf16 v[132:135], v[56:59], v[20:23], v[132:135]
v_mfma_f32_16x16x32_bf16 v[136:139], v[56:59], v[24:27], v[136:139]
v_mfma_f32_16x16x32_bf16 v[140:143], v[56:59], v[28:31], v[140:143]
ds_read_b64_tr_b16 v[56:57], v5 offset:29344
ds_read_b64_tr_b16 v[58:59], v5 offset:31136
s_waitcnt lgkmcnt(6)
v_mfma_f32_16x16x32_bf16 v[144:147], v[60:63], v[16:19], v[144:147]
v_mfma_f32_16x16x32_bf16 v[148:151], v[60:63], v[20:23], v[148:151]
v_mfma_f32_16x16x32_bf16 v[152:155], v[60:63], v[24:27], v[152:155]
v_mfma_f32_16x16x32_bf16 v[156:159], v[60:63], v[28:31], v[156:159]
ds_read_b64_tr_b16 v[60:61], v5 offset:36640
ds_read_b64_tr_b16 v[62:63], v5 offset:38432
s_waitcnt lgkmcnt(6)
v_mfma_f32_16x16x32_bf16 v[160:163], v[48:51], v[16:19], v[160:163]
v_mfma_f32_16x16x32_bf16 v[164:167], v[48:51], v[20:23], v[164:167]
v_mfma_f32_16x16x32_bf16 v[168:171], v[48:51], v[24:27], v[168:171]
v_mfma_f32_16x16x32_bf16 v[172:175], v[48:51], v[28:31], v[172:175]
ds_read_b64_tr_b16 v[48:49], v5 offset:29376
ds_read_b64_tr_b16 v[50:51], v5 offset:31168
s_waitcnt lgkmcnt(6)
v_mfma_f32_16x16x32_bf16 v[176:179], v[52:55], v[16:19], v[176:179]
v_mfma_f32_16x16x32_bf16 v[180:183], v[52:55], v[20:23], v[180:183]
v_mfma_f32_16x16x32_bf16 v[184:187], v[52:55], v[24:27], v[184:187]
v_mfma_f32_16x16x32_bf16 v[188:191], v[52:55], v[28:31], v[188:191]
ds_read_b64_tr_b16 v[52:53], v5 offset:36672
ds_read_b64_tr_b16 v[54:55], v5 offset:38464
s_waitcnt vmcnt(4)
s_barrier
ds_read_b128 v[32:35], v2 offset:49152
ds_read_b128 v[36:39], v2 offset:50176
ds_read_b128 v[40:43], v2 offset:51200
ds_read_b128 v[44:47], v2 offset:52224
s_waitcnt lgkmcnt(10)
s_mov_b32 m0, s41
v_mfma_f32_16x16x32_bf16 v[192:195], v[56:59], v[16:19], v[192:195]
buffer_load_dwordx4 v6, s[12:15], s32 offen lds
v_mfma_f32_16x16x32_bf16 v[196:199], v[56:59], v[20:23], v[196:199]
v_mfma_f32_16x16x32_bf16 v[200:203], v[56:59], v[24:27], v[200:203]
v_mfma_f32_16x16x32_bf16 v[204:207], v[56:59], v[28:31], v[204:207]
ds_read_b64_tr_b16 v[56:57], v5 offset:43840
ds_read_b64_tr_b16 v[58:59], v5 offset:45632
s_waitcnt lgkmcnt(10)
s_mov_b32 m0, s45
v_mfma_f32_16x16x32_bf16 v[208:211], v[60:63], v[16:19], v[208:211]
buffer_load_dwordx4 v7, s[12:15], s32 offen lds
v_mfma_f32_16x16x32_bf16 v[212:215], v[60:63], v[20:23], v[212:215]
v_mfma_f32_16x16x32_bf16 v[216:219], v[60:63], v[24:27], v[216:219]
v_mfma_f32_16x16x32_bf16 v[220:223], v[60:63], v[28:31], v[220:223]
ds_read_b64_tr_b16 v[60:61], v5 offset:51136
ds_read_b64_tr_b16 v[62:63], v5 offset:52928
s_waitcnt lgkmcnt(10)
s_mov_b32 m0, s49
v_mfma_f32_16x16x32_bf16 v[224:227], v[48:51], v[16:19], v[224:227]
buffer_load_dwordx4 v8, s[16:19], s33 offen lds
v_mfma_f32_16x16x32_bf16 v[228:231], v[48:51], v[20:23], v[228:231]
v_mfma_f32_16x16x32_bf16 v[232:235], v[48:51], v[24:27], v[232:235]
v_mfma_f32_16x16x32_bf16 v[236:239], v[48:51], v[28:31], v[236:239]
ds_read_b64_tr_b16 v[48:49], v5 offset:43872
ds_read_b64_tr_b16 v[50:51], v5 offset:45664
s_waitcnt lgkmcnt(10)
s_mov_b32 m0, s53
v_mfma_f32_16x16x32_bf16 v[240:243], v[52:55], v[16:19], v[240:243]
buffer_load_dwordx4 v9, s[20:23], s34 offen lds
v_mfma_f32_16x16x32_bf16 v[244:247], v[52:55], v[20:23], v[244:247]
v_mfma_f32_16x16x32_bf16 v[248:251], v[52:55], v[24:27], v[248:251]
v_mfma_f32_16x16x32_bf16 v[252:255], v[52:55], v[28:31], v[252:255]
ds_read_b64_tr_b16 v[52:53], v5 offset:51168
ds_read_b64_tr_b16 v[54:55], v5 offset:52960
s_add_u32 s32, s32, 64
s_add_u32 s33, s33, s36
s_add_u32 s34, s34, s37
s_waitcnt lgkmcnt(6)
v_mfma_f32_16x16x32_bf16 v[96:99], v[56:59], v[32:35], v[96:99]
v_mfma_f32_16x16x32_bf16 v[100:103], v[56:59], v[36:39], v[100:103]
v_mfma_f32_16x16x32_bf16 v[104:107], v[56:59], v[40:43], v[104:107]
v_mfma_f32_16x16x32_bf16 v[108:111], v[56:59], v[44:47], v[108:111]
ds_read_b64_tr_b16 v[56:57], v5 offset:43904
ds_read_b64_tr_b16 v[58:59], v5 offset:45696
s_waitcnt lgkmcnt(6)
v_mfma_f32_16x16x32_bf16 v[112:115], v[60:63], v[32:35], v[112:115]
v_mfma_f32_16x16x32_bf16 v[116:119], v[60:63], v[36:39], v[116:119]
v_mfma_f32_16x16x32_bf16 v[120:123], v[60:63], v[40:43], v[120:123]
v_mfma_f32_16x16x32_bf16 v[124:127], v[60:63], v[44:47], v[124:127]
ds_read_b64_tr_b16 v[60:61], v5 offset:51200
ds_read_b64_tr_b16 v[62:63], v5 offset:52992
s_waitcnt lgkmcnt(6)
v_mfma_f32_16x16x32_bf16 v[128:131], v[48:51], v[32:35], v[128:131]
v_mfma_f32_16x16x32_bf16 v[132:135], v[48:51], v[36:39], v[132:135]
v_mfma_f32_16x16x32_bf16 v[136:139], v[48:51], v[40:43], v[136:139]
v_mfma_f32_16x16x32_bf16 v[140:143], v[48:51], v[44:47], v[140:143]
ds_read_b64_tr_b16 v[48:49], v5 offset:43936
ds_read_b64_tr_b16 v[50:51], v5 offset:45728
s_waitcnt lgkmcnt(6)
v_mfma_f32_16x16x32_bf16 v[144:147], v[52:55], v[32:35], v[144:147]
v_mfma_f32_16x16x32_bf16 v[148:151], v[52:55], v[36:39], v[148:151]
v_mfma_f32_16x16x32_bf16 v[152:155], v[52:55], v[40:43], v[152:155]
v_mfma_f32_16x16x32_bf16 v[156:159], v[52:55], v[44:47], v[156:159]
ds_read_b64_tr_b16 v[52:53], v5 offset:51232
ds_read_b64_tr_b16 v[54:55], v5 offset:53024
s_waitcnt lgkmcnt(6)
v_mfma_f32_16x16x32_bf16 v[160:163], v[56:59], v[32:35], v[160:163]
v_mfma_f32_16x16x32_bf16 v[164:167], v[56:59], v[36:39], v[164:167]
v_mfma_f32_16x16x32_bf16 v[168:171], v[56:59], v[40:43], v[168:171]
v_mfma_f32_16x16x32_bf16 v[172:175], v[56:59], v[44:47], v[172:175]
ds_read_b64_tr_b16 v[56:57], v5 offset:43968
ds_read_b64_tr_b16 v[58:59], v5 offset:45760
s_waitcnt lgkmcnt(6)
v_mfma_f32_16x16x32_bf16 v[176:179], v[60:63], v[32:35], v[176:179]
v_mfma_f32_16x16x32_bf16 v[180:183], v[60:63], v[36:39], v[180:183]
v_mfma_f32_16x16x32_bf16 v[184:187], v[60:63], v[40:43], v[184:187]
v_mfma_f32_16x16x32_bf16 v[188:191], v[60:63], v[44:47], v[188:191]
ds_read_b64_tr_b16 v[60:61], v5 offset:51264
ds_read_b64_tr_b16 v[62:63], v5 offset:53056
s_waitcnt vmcnt(4)
s_barrier
ds_read_b128 v[16:19], v2 offset:0
ds_read_b128 v[20:23], v2 offset:1024
ds_read_b128 v[24:27], v2 offset:2048
ds_read_b128 v[28:31], v2 offset:3072
s_waitcnt lgkmcnt(10)
s_mov_b32 m0, s42
v_mfma_f32_16x16x32_bf16 v[192:195], v[48:51], v[32:35], v[192:195]
buffer_load_dwordx4 v6, s[12:15], s32 offen lds
v_mfma_f32_16x16x32_bf16 v[196:199], v[48:51], v[36:39], v[196:199]
v_mfma_f32_16x16x32_bf16 v[200:203], v[48:51], v[40:43], v[200:203]
v_mfma_f32_16x16x32_bf16 v[204:207], v[48:51], v[44:47], v[204:207]
ds_read_b64_tr_b16 v[48:49], v5 offset:64
ds_read_b64_tr_b16 v[50:51], v5 offset:1856
s_waitcnt lgkmcnt(10)
s_mov_b32 m0, s46
v_mfma_f32_16x16x32_bf16 v[208:211], v[52:55], v[32:35], v[208:211]
buffer_load_dwordx4 v7, s[12:15], s32 offen lds
v_mfma_f32_16x16x32_bf16 v[212:215], v[52:55], v[36:39], v[212:215]
v_mfma_f32_16x16x32_bf16 v[216:219], v[52:55], v[40:43], v[216:219]
v_mfma_f32_16x16x32_bf16 v[220:223], v[52:55], v[44:47], v[220:223]
ds_read_b64_tr_b16 v[52:53], v5 offset:7360
ds_read_b64_tr_b16 v[54:55], v5 offset:9152
s_waitcnt lgkmcnt(10)
s_mov_b32 m0, s50
v_mfma_f32_16x16x32_bf16 v[224:227], v[56:59], v[32:35], v[224:227]
buffer_load_dwordx4 v8, s[16:19], s33 offen lds
v_mfma_f32_16x16x32_bf16 v[228:231], v[56:59], v[36:39], v[228:231]
v_mfma_f32_16x16x32_bf16 v[232:235], v[56:59], v[40:43], v[232:235]
v_mfma_f32_16x16x32_bf16 v[236:239], v[56:59], v[44:47], v[236:239]
ds_read_b64_tr_b16 v[56:57], v5 offset:96
ds_read_b64_tr_b16 v[58:59], v5 offset:1888
s_waitcnt lgkmcnt(10)
s_mov_b32 m0, s54
v_mfma_f32_16x16x32_bf16 v[240:243], v[60:63], v[32:35], v[240:243]
buffer_load_dwordx4 v9, s[20:23], s34 offen lds
v_mfma_f32_16x16x32_bf16 v[244:247], v[60:63], v[36:39], v[244:247]
v_mfma_f32_16x16x32_bf16 v[248:251], v[60:63], v[40:43], v[248:251]
v_mfma_f32_16x16x32_bf16 v[252:255], v[60:63], v[44:47], v[252:255]
ds_read_b64_tr_b16 v[60:61], v5 offset:7392
ds_read_b64_tr_b16 v[62:63], v5 offset:9184
s_add_u32 s32, s32, 64
s_add_u32 s33, s33, s36
s_add_u32 s34, s34, s37
L_k1_loop_5:
s_waitcnt lgkmcnt(6)
v_mfma_f32_16x16x32_bf16 v[96:99], v[48:51], v[16:19], v[96:99]
v_mfma_f32_16x16x32_bf16 v[100:103], v[48:51], v[20:23], v[100:103]
v_mfma_f32_16x16x32_bf16 v[104:107], v[48:51], v[24:27], v[104:107]
v_mfma_f32_16x16x32_bf16 v[108:111], v[48:51], v[28:31], v[108:111]
ds_read_b64_tr_b16 v[48:49], v5 offset:128
ds_read_b64_tr_b16 v[50:51], v5 offset:1920
s_waitcnt lgkmcnt(6)
v_mfma_f32_16x16x32_bf16 v[112:115], v[52:55], v[16:19], v[112:115]
v_mfma_f32_16x16x32_bf16 v[116:119], v[52:55], v[20:23], v[116:119]
v_mfma_f32_16x16x32_bf16 v[120:123], v[52:55], v[24:27], v[120:123]
v_mfma_f32_16x16x32_bf16 v[124:127], v[52:55], v[28:31], v[124:127]
ds_read_b64_tr_b16 v[52:53], v5 offset:7424
ds_read_b64_tr_b16 v[54:55], v5 offset:9216
s_waitcnt lgkmcnt(6)
v_mfma_f32_16x16x32_bf16 v[128:131], v[56:59], v[16:19], v[128:131]
v_mfma_f32_16x16x32_bf16 v[132:135], v[56:59], v[20:23], v[132:135]
v_mfma_f32_16x16x32_bf16 v[136:139], v[56:59], v[24:27], v[136:139]
v_mfma_f32_16x16x32_bf16 v[140:143], v[56:59], v[28:31], v[140:143]
ds_read_b64_tr_b16 v[56:57], v5 offset:160
ds_read_b64_tr_b16 v[58:59], v5 offset:1952
s_waitcnt lgkmcnt(6)
v_mfma_f32_16x16x32_bf16 v[144:147], v[60:63], v[16:19], v[144:147]
v_mfma_f32_16x16x32_bf16 v[148:151], v[60:63], v[20:23], v[148:151]
v_mfma_f32_16x16x32_bf16 v[152:155], v[60:63], v[24:27], v[152:155]
v_mfma_f32_16x16x32_bf16 v[156:159], v[60:63], v[28:31], v[156:159]
ds_read_b64_tr_b16 v[60:61], v5 offset:7456
ds_read_b64_tr_b16 v[62:63], v5 offset:9248
s_waitcnt lgkmcnt(6)
v_mfma_f32_16x16x32_bf16 v[160:163], v[48:51], v[16:19], v[160:163]
v_mfma_f32_16x16x32_bf16 v[164:167], v[48:51], v[20:23], v[164:167]
v_mfma_f32_16x16x32_bf16 v[168:171], v[48:51], v[24:27], v[168:171]
v_mfma_f32_16x16x32_bf16 v[172:175], v[48:51], v[28:31], v[172:175]
ds_read_b64_tr_b16 v[48:49], v5 offset:192
ds_read_b64_tr_b16 v[50:51], v5 offset:1984
s_waitcnt lgkmcnt(6)
v_mfma_f32_16x16x32_bf16 v[176:179], v[52:55], v[16:19], v[176:179]
v_mfma_f32_16x16x32_bf16 v[180:183], v[52:55], v[20:23], v[180:183]
v_mfma_f32_16x16x32_bf16 v[184:187], v[52:55], v[24:27], v[184:187]
v_mfma_f32_16x16x32_bf16 v[188:191], v[52:55], v[28:31], v[188:191]
ds_read_b64_tr_b16 v[52:53], v5 offset:7488
ds_read_b64_tr_b16 v[54:55], v5 offset:9280
s_waitcnt vmcnt(4)
s_barrier
ds_read_b128 v[32:35], v2 offset:16384
ds_read_b128 v[36:39], v2 offset:17408
ds_read_b128 v[40:43], v2 offset:18432
ds_read_b128 v[44:47], v2 offset:19456
s_waitcnt lgkmcnt(10)
s_mov_b32 m0, s43
v_mfma_f32_16x16x32_bf16 v[192:195], v[56:59], v[16:19], v[192:195]
buffer_load_dwordx4 v6, s[12:15], s32 offen lds
v_mfma_f32_16x16x32_bf16 v[196:199], v[56:59], v[20:23], v[196:199]
v_mfma_f32_16x16x32_bf16 v[200:203], v[56:59], v[24:27], v[200:203]
v_mfma_f32_16x16x32_bf16 v[204:207], v[56:59], v[28:31], v[204:207]
ds_read_b64_tr_b16 v[56:57], v5 offset:14656
ds_read_b64_tr_b16 v[58:59], v5 offset:16448
s_waitcnt lgkmcnt(10)
s_mov_b32 m0, s47
v_mfma_f32_16x16x32_bf16 v[208:211], v[60:63], v[16:19], v[208:211]
buffer_load_dwordx4 v7, s[12:15], s32 offen lds
v_mfma_f32_16x16x32_bf16 v[212:215], v[60:63], v[20:23], v[212:215]
v_mfma_f32_16x16x32_bf16 v[216:219], v[60:63], v[24:27], v[216:219]
v_mfma_f32_16x16x32_bf16 v[220:223], v[60:63], v[28:31], v[220:223]
ds_read_b64_tr_b16 v[60:61], v5 offset:21952
ds_read_b64_tr_b16 v[62:63], v5 offset:23744
s_waitcnt lgkmcnt(10)
s_mov_b32 m0, s51
v_mfma_f32_16x16x32_bf16 v[224:227], v[48:51], v[16:19], v[224:227]
buffer_load_dwordx4 v8, s[16:19], s33 offen lds
v_mfma_f32_16x16x32_bf16 v[228:231], v[48:51], v[20:23], v[228:231]
v_mfma_f32_16x16x32_bf16 v[232:235], v[48:51], v[24:27], v[232:235]
v_mfma_f32_16x16x32_bf16 v[236:239], v[48:51], v[28:31], v[236:239]
ds_read_b64_tr_b16 v[48:49], v5 offset:14688
ds_read_b64_tr_b16 v[50:51], v5 offset:16480
s_waitcnt lgkmcnt(10)
s_mov_b32 m0, s55
v_mfma_f32_16x16x32_bf16 v[240:243], v[52:55], v[16:19], v[240:243]
buffer_load_dwordx4 v9, s[20:23], s34 offen lds
v_mfma_f32_16x16x32_bf16 v[244:247], v[52:55], v[20:23], v[244:247]
v_mfma_f32_16x16x32_bf16 v[248:251], v[52:55], v[24:27], v[248:251]
v_mfma_f32_16x16x32_bf16 v[252:255], v[52:55], v[28:31], v[252:255]
s_cmp_eq_u32 s61, s83
s_cbranch_scc0 L_k1_pfskip_6
s_add_u32 s62, s80, s33
buffer_load_dwordx4 v[68:71], v8, s[16:19], s62 offen
s_add_u32 s62, s81, s34
buffer_load_dwordx4 v[72:75], v9, s[20:23], s62 offen
L_k1_pfskip_6:
s_xor_b32 s61, s61, 1
buffer_load_dwordx4 v[80:83], v11, s[84:87], s39 offen
s_add_u32 s39, s39, 2097152
ds_read_b64_tr_b16 v[52:53], v5 offset:21984
ds_read_b64_tr_b16 v[54:55], v5 offset:23776
s_add_u32 s32, s32, 64
s_add_u32 s33, s33, s36
s_add_u32 s34, s34, s37
s_waitcnt lgkmcnt(6)
v_mfma_f32_16x16x32_bf16 v[96:99], v[56:59], v[32:35], v[96:99]
v_mfma_f32_16x16x32_bf16 v[100:103], v[56:59], v[36:39], v[100:103]
v_mfma_f32_16x16x32_bf16 v[104:107], v[56:59], v[40:43], v[104:107]
v_mfma_f32_16x16x32_bf16 v[108:111], v[56:59], v[44:47], v[108:111]
ds_read_b64_tr_b16 v[56:57], v5 offset:14720
ds_read_b64_tr_b16 v[58:59], v5 offset:16512
s_waitcnt lgkmcnt(6)
v_mfma_f32_16x16x32_bf16 v[112:115], v[60:63], v[32:35], v[112:115]
v_mfma_f32_16x16x32_bf16 v[116:119], v[60:63], v[36:39], v[116:119]
v_mfma_f32_16x16x32_bf16 v[120:123], v[60:63], v[40:43], v[120:123]
v_mfma_f32_16x16x32_bf16 v[124:127], v[60:63], v[44:47], v[124:127]
ds_read_b64_tr_b16 v[60:61], v5 offset:22016
ds_read_b64_tr_b16 v[62:63], v5 offset:23808
s_waitcnt lgkmcnt(6)
v_mfma_f32_16x16x32_bf16 v[128:131], v[48:51], v[32:35], v[128:131]
v_mfma_f32_16x16x32_bf16 v[132:135], v[48:51], v[36:39], v[132:135]
v_mfma_f32_16x16x32_bf16 v[136:139], v[48:51], v[40:43], v[136:139]
v_mfma_f32_16x16x32_bf16 v[140:143], v[48:51], v[44:47], v[140:143]
ds_read_b64_tr_b16 v[48:49], v5 offset:14752
ds_read_b64_tr_b16 v[50:51], v5 offset:16544
s_waitcnt lgkmcnt(6)
v_mfma_f32_16x16x32_bf16 v[144:147], v[52:55], v[32:35], v[144:147]
v_mfma_f32_16x16x32_bf16 v[148:151], v[52:55], v[36:39], v[148:151]
v_mfma_f32_16x16x32_bf16 v[152:155], v[52:55], v[40:43], v[152:155]
v_mfma_f32_16x16x32_bf16 v[156:159], v[52:55], v[44:47], v[156:159]
ds_read_b64_tr_b16 v[52:53], v5 offset:22048
ds_read_b64_tr_b16 v[54:55], v5 offset:23840
s_waitcnt lgkmcnt(6)
v_mfma_f32_16x16x32_bf16 v[160:163], v[56:59], v[32:35], v[160:163]
v_mfma_f32_16x16x32_bf16 v[164:167], v[56:59], v[36:39], v[164:167]
v_mfma_f32_16x16x32_bf16 v[168:171], v[56:59], v[40:43], v[168:171]
v_mfma_f32_16x16x32_bf16 v[172:175], v[56:59], v[44:47], v[172:175]
ds_read_b64_tr_b16 v[56:57], v5 offset:14784
ds_read_b64_tr_b16 v[58:59], v5 offset:16576
s_waitcnt lgkmcnt(6)
v_mfma_f32_16x16x32_bf16 v[176:179], v[60:63], v[32:35], v[176:179]
v_mfma_f32_16x16x32_bf16 v[180:183], v[60:63], v[36:39], v[180:183]
v_mfma_f32_16x16x32_bf16 v[184:187], v[60:63], v[40:43], v[184:187]
v_mfma_f32_16x16x32_bf16 v[188:191], v[60:63], v[44:47], v[188:191]
ds_read_b64_tr_b16 v[60:61], v5 offset:22080
ds_read_b64_tr_b16 v[62:63], v5 offset:23872
s_waitcnt vmcnt(4)
s_barrier
ds_read_b128 v[16:19], v2 offset:32768
ds_read_b128 v[20:23], v2 offset:33792
ds_read_b128 v[24:27], v2 offset:34816
ds_read_b128 v[28:31], v2 offset:35840
s_waitcnt lgkmcnt(10)
s_mov_b32 m0, s40
v_mfma_f32_16x16x32_bf16 v[192:195], v[48:51], v[32:35], v[192:195]
buffer_load_dwordx4 v6, s[12:15], s32 offen lds
v_mfma_f32_16x16x32_bf16 v[196:199], v[48:51], v[36:39], v[196:199]
v_mfma_f32_16x16x32_bf16 v[200:203], v[48:51], v[40:43], v[200:203]
v_mfma_f32_16x16x32_bf16 v[204:207], v[48:51], v[44:47], v[204:207]
ds_read_b64_tr_b16 v[48:49], v5 offset:29248
ds_read_b64_tr_b16 v[50:51], v5 offset:31040
s_waitcnt lgkmcnt(10)
s_mov_b32 m0, s44
v_mfma_f32_16x16x32_bf16 v[208:211], v[52:55], v[32:35], v[208:211]
buffer_load_dwordx4 v7, s[12:15], s32 offen lds
v_mfma_f32_16x16x32_bf16 v[212:215], v[52:55], v[36:39], v[212:215]
v_mfma_f32_16x16x32_bf16 v[216:219], v[52:55], v[40:43], v[216:219]
v_mfma_f32_16x16x32_bf16 v[220:223], v[52:55], v[44:47], v[220:223]
ds_read_b64_tr_b16 v[52:53], v5 offset:36544
ds_read_b64_tr_b16 v[54:55], v5 offset:38336
s_waitcnt lgkmcnt(10)
s_mov_b32 m0, s48
v_mfma_f32_16x16x32_bf16 v[224:227], v[56:59], v[32:35], v[224:227]
buffer_load_dwordx4 v8, s[16:19], s33 offen lds
v_mfma_f32_16x16x32_bf16 v[228:231], v[56:59], v[36:39], v[228:231]
v_mfma_f32_16x16x32_bf16 v[232:235], v[56:59], v[40:43], v[232:235]
v_mfma_f32_16x16x32_bf16 v[236:239], v[56:59], v[44:47], v[236:239]
ds_read_b64_tr_b16 v[56:57], v5 offset:29280
ds_read_b64_tr_b16 v[58:59], v5 offset:31072
s_waitcnt lgkmcnt(10)
s_mov_b32 m0, s52
v_mfma_f32_16x16x32_bf16 v[240:243], v[60:63], v[32:35], v[240:243]
buffer_load_dwordx4 v9, s[20:23], s34 offen lds
v_mfma_f32_16x16x32_bf16 v[244:247], v[60:63], v[36:39], v[244:247]
v_mfma_f32_16x16x32_bf16 v[248:251], v[60:63], v[40:43], v[248:251]
v_mfma_f32_16x16x32_bf16 v[252:255], v[60:63], v[44:47], v[252:255]
ds_read_b64_tr_b16 v[60:61], v5 offset:36576
ds_read_b64_tr_b16 v[62:63], v5 offset:38368
s_add_u32 s32, s32, 64
s_add_u32 s33, s33, s36
s_add_u32 s34, s34, s37
s_waitcnt lgkmcnt(6)
v_mfma_f32_16x16x32_bf16 v[96:99], v[48:51], v[16:19], v[96:99]
v_mfma_f32_16x16x32_bf16 v[100:103], v[48:51], v[20:23], v[100:103]
v_mfma_f32_16x16x32_bf16 v[104:107], v[48:51], v[24:27], v[104:107]
v_mfma_f32_16x16x32_bf16 v[108:111], v[48:51], v[28:31], v[108:111]
ds_read_b64_tr_b16 v[48:49], v5 offset:29312
ds_read_b64_tr_b16 v[50:51], v5 offset:31104
s_waitcnt lgkmcnt(6)
v_mfma_f32_16x16x32_bf16 v[112:115], v[52:55], v[16:19], v[112:115]
v_mfma_f32_16x16x32_bf16 v[116:119], v[52:55], v[20:23], v[116:119]
v_mfma_f32_16x16x32_bf16 v[120:123], v[52:55], v[24:27], v[120:123]
v_mfma_f32_16x16x32_bf16 v[124:127], v[52:55], v[28:31], v[124:127]
ds_read_b64_tr_b16 v[52:53], v5 offset:36608
ds_read_b64_tr_b16 v[54:55], v5 offset:38400
s_waitcnt lgkmcnt(6)
v_mfma_f32_16x16x32_bf16 v[128:131], v[56:59], v[16:19], v[128:131]
v_mfma_f32_16x16x32_bf16 v[132:135], v[56:59], v[20:23], v[132:135]
v_mfma_f32_16x16x32_bf16 v[136:139], v[56:59], v[24:27], v[136:139]
v_mfma_f32_16x16x32_bf16 v[140:143], v[56:59], v[28:31], v[140:143]
ds_read_b64_tr_b16 v[56:57], v5 offset:29344
ds_read_b64_tr_b16 v[58:59], v5 offset:31136
s_waitcnt lgkmcnt(6)
v_mfma_f32_16x16x32_bf16 v[144:147], v[60:63], v[16:19], v[144:147]
v_mfma_f32_16x16x32_bf16 v[148:151], v[60:63], v[20:23], v[148:151]
v_mfma_f32_16x16x32_bf16 v[152:155], v[60:63], v[24:27], v[152:155]
v_mfma_f32_16x16x32_bf16 v[156:159], v[60:63], v[28:31], v[156:159]
ds_read_b64_tr_b16 v[60:61], v5 offset:36640
ds_read_b64_tr_b16 v[62:63], v5 offset:38432
s_waitcnt lgkmcnt(6)
v_mfma_f32_16x16x32_bf16 v[160:163], v[48:51], v[16:19], v[160:163]
v_mfma_f32_16x16x32_bf16 v[164:167], v[48:51], v[20:23], v[164:167]
v_mfma_f32_16x16x32_bf16 v[168:171], v[48:51], v[24:27], v[168:171]
v_mfma_f32_16x16x32_bf16 v[172:175], v[48:51], v[28:31], v[172:175]
ds_read_b64_tr_b16 v[48:49], v5 offset:29376
ds_read_b64_tr_b16 v[50:51], v5 offset:31168
s_waitcnt lgkmcnt(6)
v_mfma_f32_16x16x32_bf16 v[176:179], v[52:55], v[16:19], v[176:179]
v_mfma_f32_16x16x32_bf16 v[180:183], v[52:55], v[20:23], v[180:183]
v_mfma_f32_16x16x32_bf16 v[184:187], v[52:55], v[24:27], v[184:187]
v_mfma_f32_16x16x32_bf16 v[188:191], v[52:55], v[28:31], v[188:191]
ds_read_b64_tr_b16 v[52:53], v5 offset:36672
ds_read_b64_tr_b16 v[54:55], v5 offset:38464
s_waitcnt vmcnt(4)
s_barrier
ds_read_b128 v[32:35], v2 offset:49152
ds_read_b128 v[36:39], v2 offset:50176
ds_read_b128 v[40:43], v2 offset:51200
ds_read_b128 v[44:47], v2 offset:52224
s_waitcnt lgkmcnt(10)
s_mov_b32 m0, s41
v_mfma_f32_16x16x32_bf16 v[192:195], v[56:59], v[16:19], v[192:195]
buffer_load_dwordx4 v6, s[12:15], s32 offen lds
v_mfma_f32_16x16x32_bf16 v[196:199], v[56:59], v[20:23], v[196:199]
v_mfma_f32_16x16x32_bf16 v[200:203], v[56:59], v[24:27], v[200:203]
v_mfma_f32_16x16x32_bf16 v[204:207], v[56:59], v[28:31], v[204:207]
ds_read_b64_tr_b16 v[56:57], v5 offset:43840
ds_read_b64_tr_b16 v[58:59], v5 offset:45632
s_waitcnt lgkmcnt(10)
s_mov_b32 m0, s45
v_mfma_f32_16x16x32_bf16 v[208:211], v[60:63], v[16:19], v[208:211]
buffer_load_dwordx4 v7, s[12:15], s32 offen lds
v_mfma_f32_16x16x32_bf16 v[212:215], v[60:63], v[20:23], v[212:215]
v_mfma_f32_16x16x32_bf16 v[216:219], v[60:63], v[24:27], v[216:219]
v_mfma_f32_16x16x32_bf16 v[220:223], v[60:63], v[28:31], v[220:223]
ds_read_b64_tr_b16 v[60:61], v5 offset:51136
ds_read_b64_tr_b16 v[62:63], v5 offset:52928
s_waitcnt lgkmcnt(10)
s_mov_b32 m0, s49
v_mfma_f32_16x16x32_bf16 v[224:227], v[48:51], v[16:19], v[224:227]
buffer_load_dwordx4 v8, s[16:19], s33 offen lds
v_mfma_f32_16x16x32_bf16 v[228:231], v[48:51], v[20:23], v[228:231]
v_mfma_f32_16x16x32_bf16 v[232:235], v[48:51], v[24:27], v[232:235]
v_mfma_f32_16x16x32_bf16 v[236:239], v[48:51], v[28:31], v[236:239]
ds_read_b64_tr_b16 v[48:49], v5 offset:43872
ds_read_b64_tr_b16 v[50:51], v5 offset:45664
s_waitcnt lgkmcnt(10)
s_mov_b32 m0, s53
v_mfma_f32_16x16x32_bf16 v[240:243], v[52:55], v[16:19], v[240:243]
buffer_load_dwordx4 v9, s[20:23], s34 offen lds
v_mfma_f32_16x16x32_bf16 v[244:247], v[52:55], v[20:23], v[244:247]
v_mfma_f32_16x16x32_bf16 v[248:251], v[52:55], v[24:27], v[248:251]
v_mfma_f32_16x16x32_bf16 v[252:255], v[52:55], v[28:31], v[252:255]
ds_read_b64_tr_b16 v[52:53], v5 offset:51168
ds_read_b64_tr_b16 v[54:55], v5 offset:52960
s_add_u32 s32, s32, 64
s_add_u32 s33, s33, s36
s_add_u32 s34, s34, s37
s_waitcnt lgkmcnt(6)
v_mfma_f32_16x16x32_bf16 v[96:99], v[56:59], v[32:35], v[96:99]
v_mfma_f32_16x16x32_bf16 v[100:103], v[56:59], v[36:39], v[100:103]
v_mfma_f32_16x16x32_bf16 v[104:107], v[56:59], v[40:43], v[104:107]
v_mfma_f32_16x16x32_bf16 v[108:111], v[56:59], v[44:47], v[108:111]
ds_read_b64_tr_b16 v[56:57], v5 offset:43904
ds_read_b64_tr_b16 v[58:59], v5 offset:45696
s_waitcnt lgkmcnt(6)
v_mfma_f32_16x16x32_bf16 v[112:115], v[60:63], v[32:35], v[112:115]
v_mfma_f32_16x16x32_bf16 v[116:119], v[60:63], v[36:39], v[116:119]
v_mfma_f32_16x16x32_bf16 v[120:123], v[60:63], v[40:43], v[120:123]
v_mfma_f32_16x16x32_bf16 v[124:127], v[60:63], v[44:47], v[124:127]
ds_read_b64_tr_b16 v[60:61], v5 offset:51200
ds_read_b64_tr_b16 v[62:63], v5 offset:52992
s_waitcnt lgkmcnt(6)
v_mfma_f32_16x16x32_bf16 v[128:131], v[48:51], v[32:35], v[128:131]
v_mfma_f32_16x16x32_bf16 v[132:135], v[48:51], v[36:39], v[132:135]
v_mfma_f32_16x16x32_bf16 v[136:139], v[48:51], v[40:43], v[136:139]
v_mfma_f32_16x16x32_bf16 v[140:143], v[48:51], v[44:47], v[140:143]
ds_read_b64_tr_b16 v[48:49], v5 offset:43936
ds_read_b64_tr_b16 v[50:51], v5 offset:45728
s_waitcnt lgkmcnt(6)
v_mfma_f32_16x16x32_bf16 v[144:147], v[52:55], v[32:35], v[144:147]
v_mfma_f32_16x16x32_bf16 v[148:151], v[52:55], v[36:39], v[148:151]
v_mfma_f32_16x16x32_bf16 v[152:155], v[52:55], v[40:43], v[152:155]
v_mfma_f32_16x16x32_bf16 v[156:159], v[52:55], v[44:47], v[156:159]
ds_read_b64_tr_b16 v[52:53], v5 offset:51232
ds_read_b64_tr_b16 v[54:55], v5 offset:53024
s_waitcnt lgkmcnt(6)
v_mfma_f32_16x16x32_bf16 v[160:163], v[56:59], v[32:35], v[160:163]
v_mfma_f32_16x16x32_bf16 v[164:167], v[56:59], v[36:39], v[164:167]
v_mfma_f32_16x16x32_bf16 v[168:171], v[56:59], v[40:43], v[168:171]
v_mfma_f32_16x16x32_bf16 v[172:175], v[56:59], v[44:47], v[172:175]
ds_read_b64_tr_b16 v[56:57], v5 offset:43968
ds_read_b64_tr_b16 v[58:59], v5 offset:45760
s_waitcnt lgkmcnt(6)
v_mfma_f32_16x16x32_bf16 v[176:179], v[60:63], v[32:35], v[176:179]
v_mfma_f32_16x16x32_bf16 v[180:183], v[60:63], v[36:39], v[180:183]
v_mfma_f32_16x16x32_bf16 v[184:187], v[60:63], v[40:43], v[184:187]
v_mfma_f32_16x16x32_bf16 v[188:191], v[60:63], v[44:47], v[188:191]
ds_read_b64_tr_b16 v[60:61], v5 offset:51264
ds_read_b64_tr_b16 v[62:63], v5 offset:53056
s_waitcnt vmcnt(4)
s_barrier
ds_read_b128 v[16:19], v2 offset:0
ds_read_b128 v[20:23], v2 offset:1024
ds_read_b128 v[24:27], v2 offset:2048
ds_read_b128 v[28:31], v2 offset:3072
s_waitcnt lgkmcnt(10)
s_mov_b32 m0, s42
v_mfma_f32_16x16x32_bf16 v[192:195], v[48:51], v[32:35], v[192:195]
buffer_load_dwordx4 v6, s[12:15], s32 offen lds
v_mfma_f32_16x16x32_bf16 v[196:199], v[48:51], v[36:39], v[196:199]
v_mfma_f32_16x16x32_bf16 v[200:203], v[48:51], v[40:43], v[200:203]
v_mfma_f32_16x16x32_bf16 v[204:207], v[48:51], v[44:47], v[204:207]
ds_read_b64_tr_b16 v[48:49], v5 offset:64
ds_read_b64_tr_b16 v[50:51], v5 offset:1856
s_waitcnt lgkmcnt(10)
s_mov_b32 m0, s46
v_mfma_f32_16x16x32_bf16 v[208:211], v[52:55], v[32:35], v[208:211]
buffer_load_dwordx4 v7, s[12:15], s32 offen lds
v_mfma_f32_16x16x32_bf16 v[212:215], v[52:55], v[36:39], v[212:215]
v_mfma_f32_16x16x32_bf16 v[216:219], v[52:55], v[40:43], v[216:219]
v_mfma_f32_16x16x32_bf16 v[220:223], v[52:55], v[44:47], v[220:223]
ds_read_b64_tr_b16 v[52:53], v5 offset:7360
ds_read_b64_tr_b16 v[54:55], v5 offset:9152
s_waitcnt lgkmcnt(10)
s_mov_b32 m0, s50
v_mfma_f32_16x16x32_bf16 v[224:227], v[56:59], v[32:35], v[224:227]
buffer_load_dwordx4 v8, s[16:19], s33 offen lds
v_mfma_f32_16x16x32_bf16 v[228:231], v[56:59], v[36:39], v[228:231]
v_mfma_f32_16x16x32_bf16 v[232:235], v[56:59], v[40:43], v[232:235]
v_mfma_f32_16x16x32_bf16 v[236:239], v[56:59], v[44:47], v[236:239]
ds_read_b64_tr_b16 v[56:57], v5 offset:96
ds_read_b64_tr_b16 v[58:59], v5 offset:1888
s_waitcnt lgkmcnt(10)
s_mov_b32 m0, s54
v_mfma_f32_16x16x32_bf16 v[240:243], v[60:63], v[32:35], v[240:243]
buffer_load_dwordx4 v9, s[20:23], s34 offen lds
v_mfma_f32_16x16x32_bf16 v[244:247], v[60:63], v[36:39], v[244:247]
v_mfma_f32_16x16x32_bf16 v[248:251], v[60:63], v[40:43], v[248:251]
v_mfma_f32_16x16x32_bf16 v[252:255], v[60:63], v[44:47], v[252:255]
ds_read_b64_tr_b16 v[60:61], v5 offset:7392
ds_read_b64_tr_b16 v[62:63], v5 offset:9184
s_add_u32 s32, s32, 64
s_add_u32 s33, s33, s36
s_add_u32 s34, s34, s37
s_add_u32 s60, s60, 1
s_cmp_lt_u32 s60, 6
s_cbranch_scc1 L_k1_loop_5
s_lshl_b32 s62, s29, 3
s_lshl_b32 s63, s31, 1
s_add_u32 s62, s62, s63
v_and_b32 v12, 15, v1
v_bfe_u32 v13, v1, 4, 1
v_lshl_add_u32 v12, v13, 5, v12
v_lshlrev_b32 v12, 4, v12
v_lshrrev_b32 v13, 5, v1
s_mul_i32 s63, s62, 288
s_mul_i32 s64, s28, 7
s_add_u32 s63, s63, s64
s_lshl_b32 s63, s63, 10
s_add_u32 s63, s63, 16842752
v_lshl_add_u32 v91, v13, 8, v12
v_add_u32 v91, s63, v91
v_add_u32 v92, 294912, v91
s_mov_b32 s76, 0xbfb8aa3b
s_mov_b32 s77, 0xbfb8aa3b
s_mov_b32 s78, 0x3e8293ee
s_mov_b32 s79, 0x3e8293ee
s_mov_b32 s72, 1.0
s_mov_b32 s73, 1.0
s_mov_b32 s75, 4096
s_waitcnt lgkmcnt(6)
v_mfma_f32_16x16x32_bf16 v[96:99], v[48:51], v[16:19], v[96:99]
v_mfma_f32_16x16x32_bf16 v[100:103], v[48:51], v[20:23], v[100:103]
v_mfma_f32_16x16x32_bf16 v[104:107], v[48:51], v[24:27], v[104:107]
v_mfma_f32_16x16x32_bf16 v[108:111], v[48:51], v[28:31], v[108:111]
ds_read_b64_tr_b16 v[48:49], v5 offset:128
ds_read_b64_tr_b16 v[50:51], v5 offset:1920
s_waitcnt lgkmcnt(6)
v_mfma_f32_16x16x32_bf16 v[112:115], v[52:55], v[16:19], v[112:115]
v_mfma_f32_16x16x32_bf16 v[116:119], v[52:55], v[20:23], v[116:119]
v_mfma_f32_16x16x32_bf16 v[120:123], v[52:55], v[24:27], v[120:123]
v_mfma_f32_16x16x32_bf16 v[124:127], v[52:55], v[28:31], v[124:127]
ds_read_b64_tr_b16 v[52:53], v5 offset:7424
ds_read_b64_tr_b16 v[54:55], v5 offset:9216
s_waitcnt lgkmcnt(6)
v_mfma_f32_16x16x32_bf16 v[128:131], v[56:59], v[16:19], v[128:131]
v_mfma_f32_16x16x32_bf16 v[132:135], v[56:59], v[20:23], v[132:135]
v_mfma_f32_16x16x32_bf16 v[136:139], v[56:59], v[24:27], v[136:139]
v_mfma_f32_16x16x32_bf16 v[140:143], v[56:59], v[28:31], v[140:143]
ds_read_b64_tr_b16 v[56:57], v5 offset:160
ds_read_b64_tr_b16 v[58:59], v5 offset:1952
s_waitcnt lgkmcnt(6)
v_mfma_f32_16x16x32_bf16 v[144:147], v[60:63], v[16:19], v[144:147]
v_mfma_f32_16x16x32_bf16 v[148:151], v[60:63], v[20:23], v[148:151]
v_mfma_f32_16x16x32_bf16 v[152:155], v[60:63], v[24:27], v[152:155]
v_mfma_f32_16x16x32_bf16 v[156:159], v[60:63], v[28:31], v[156:159]
ds_read_b64_tr_b16 v[60:61], v5 offset:7456
ds_read_b64_tr_b16 v[62:63], v5 offset:9248
s_waitcnt lgkmcnt(6)
v_mfma_f32_16x16x32_bf16 v[160:163], v[48:51], v[16:19], v[160:163]
v_mfma_f32_16x16x32_bf16 v[164:167], v[48:51], v[20:23], v[164:167]
v_mfma_f32_16x16x32_bf16 v[168:171], v[48:51], v[24:27], v[168:171]
v_mfma_f32_16x16x32_bf16 v[172:175], v[48:51], v[28:31], v[172:175]
ds_read_b64_tr_b16 v[48:49], v5 offset:192
ds_read_b64_tr_b16 v[50:51], v5 offset:1984
s_waitcnt lgkmcnt(6)
v_mfma_f32_16x16x32_bf16 v[176:179], v[52:55], v[16:19], v[176:179]
v_mfma_f32_16x16x32_bf16 v[180:183], v[52:55], v[20:23], v[180:183]
v_mfma_f32_16x16x32_bf16 v[184:187], v[52:55], v[24:27], v[184:187]
v_mfma_f32_16x16x32_bf16 v[188:191], v[52:55], v[28:31], v[188:191]
ds_read_b64_tr_b16 v[52:53], v5 offset:7488
ds_read_b64_tr_b16 v[54:55], v5 offset:9280
s_waitcnt vmcnt(4)
s_barrier
s_waitcnt lgkmcnt(6)
s_mov_b32 m0, s43
v_mfma_f32_16x16x32_bf16 v[192:195], v[56:59], v[16:19], v[192:195]
buffer_load_dwordx4 v6, s[12:15], s32 offen lds
v_mfma_f32_16x16x32_bf16 v[196:199], v[56:59], v[20:23], v[196:199]
v_mfma_f32_16x16x32_bf16 v[200:203], v[56:59], v[24:27], v[200:203]
v_mfma_f32_16x16x32_bf16 v[204:207], v[56:59], v[28:31], v[204:207]
s_waitcnt lgkmcnt(4)
s_mov_b32 m0, s47
v_mfma_f32_16x16x32_bf16 v[208:211], v[60:63], v[16:19], v[208:211]
buffer_load_dwordx4 v7, s[12:15], s32 offen lds
v_mfma_f32_16x16x32_bf16 v[212:215], v[60:63], v[20:23], v[212:215]
v_mfma_f32_16x16x32_bf16 v[216:219], v[60:63], v[24:27], v[216:219]
v_mfma_f32_16x16x32_bf16 v[220:223], v[60:63], v[28:31], v[220:223]
s_waitcnt lgkmcnt(2)
s_mov_b32 m0, s51
v_mfma_f32_16x16x32_bf16 v[224:227], v[48:51], v[16:19], v[224:227]
buffer_load_dwordx4 v8, s[16:19], s33 offen lds
v_mfma_f32_16x16x32_bf16 v[228:231], v[48:51], v[20:23], v[228:231]
v_mfma_f32_16x16x32_bf16 v[232:235], v[48:51], v[24:27], v[232:235]
v_mfma_f32_16x16x32_bf16 v[236:239], v[48:51], v[28:31], v[236:239]
s_waitcnt lgkmcnt(0)
s_mov_b32 m0, s55
v_mfma_f32_16x16x32_bf16 v[240:243], v[52:55], v[16:19], v[240:243]
buffer_load_dwordx4 v9, s[20:23], s34 offen lds
v_mfma_f32_16x16x32_bf16 v[244:247], v[52:55], v[20:23], v[244:247]
v_mfma_f32_16x16x32_bf16 v[248:251], v[52:55], v[24:27], v[248:251]
v_mfma_f32_16x16x32_bf16 v[252:255], v[52:55], v[28:31], v[252:255]
s_add_u32 s32, s32, 64
s_add_u32 s33, s33, s36
s_add_u32 s34, s34, s37
ds_read_b128 v[16:19], v2 offset:16384
ds_read_b128 v[20:23], v2 offset:17408
ds_read_b128 v[24:27], v2 offset:18432
ds_read_b128 v[28:31], v2 offset:19456
ds_read_b64_tr_b16 v[48:49], v5 offset:14656
ds_read_b64_tr_b16 v[50:51], v5 offset:16448
ds_read_b64_tr_b16 v[52:53], v5 offset:21952
ds_read_b64_tr_b16 v[54:55], v5 offset:23744
s_waitcnt vmcnt(4)
s_barrier
ds_read_b128 v[32:35], v2 offset:32768
ds_read_b128 v[36:39], v2 offset:33792
ds_read_b128 v[40:43], v2 offset:34816
ds_read_b128 v[44:47], v2 offset:35840
ds_read_b64_tr_b16 v[56:57], v5 offset:29248
ds_read_b64_tr_b16 v[58:59], v5 offset:31040
ds_read_b64_tr_b16 v[60:61], v5 offset:36544
ds_read_b64_tr_b16 v[62:63], v5 offset:38336
s_waitcnt lgkmcnt(8)
v_mfma_f32_16x16x32_bf16 v[96:99], v[48:51], v[16:19], v[96:99]
v_mfma_f32_16x16x32_bf16 v[100:103], v[48:51], v[20:23], v[100:103]
v_mfma_f32_16x16x32_bf16 v[104:107], v[48:51], v[24:27], v[104:107]
v_mfma_f32_16x16x32_bf16 v[108:111], v[48:51], v[28:31], v[108:111]
v_mfma_f32_16x16x32_bf16 v[112:115], v[52:55], v[16:19], v[112:115]
v_mfma_f32_16x16x32_bf16 v[116:119], v[52:55], v[20:23], v[116:119]
v_mfma_f32_16x16x32_bf16 v[120:123], v[52:55], v[24:27], v[120:123]
v_mfma_f32_16x16x32_bf16 v[124:127], v[52:55], v[28:31], v[124:127]
s_waitcnt vmcnt(0)
s_barrier
ds_read_b128 v[16:19], v2 offset:49152
ds_read_b128 v[20:23], v2 offset:50176
ds_read_b128 v[24:27], v2 offset:51200
ds_read_b128 v[28:31], v2 offset:52224
ds_read_b64_tr_b16 v[48:49], v5 offset:43840
ds_read_b64_tr_b16 v[50:51], v5 offset:45632
ds_read_b64_tr_b16 v[52:53], v5 offset:51136
ds_read_b64_tr_b16 v[54:55], v5 offset:52928
s_waitcnt lgkmcnt(8)
v_mfma_f32_16x16x32_bf16 v[96:99], v[56:59], v[32:35], v[96:99]
v_mfma_f32_16x16x32_bf16 v[100:103], v[56:59], v[36:39], v[100:103]
v_mfma_f32_16x16x32_bf16 v[104:107], v[56:59], v[40:43], v[104:107]
v_mfma_f32_16x16x32_bf16 v[108:111], v[56:59], v[44:47], v[108:111]
v_mfma_f32_16x16x32_bf16 v[112:115], v[60:63], v[32:35], v[112:115]
v_mfma_f32_16x16x32_bf16 v[116:119], v[60:63], v[36:39], v[116:119]
v_mfma_f32_16x16x32_bf16 v[120:123], v[60:63], v[40:43], v[120:123]
v_mfma_f32_16x16x32_bf16 v[124:127], v[60:63], v[44:47], v[124:127]
ds_read_b128 v[32:35], v2 offset:16384
ds_read_b128 v[36:39], v2 offset:17408
ds_read_b128 v[40:43], v2 offset:18432
ds_read_b128 v[44:47], v2 offset:19456
ds_read_b64_tr_b16 v[56:57], v5 offset:14688
ds_read_b64_tr_b16 v[58:59], v5 offset:16480
ds_read_b64_tr_b16 v[60:61], v5 offset:21984
ds_read_b64_tr_b16 v[62:63], v5 offset:23776
s_waitcnt lgkmcnt(8)
v_mfma_f32_16x16x32_bf16 v[96:99], v[48:51], v[16:19], v[96:99]
v_mfma_f32_16x16x32_bf16 v[100:103], v[48:51], v[20:23], v[100:103]
v_mfma_f32_16x16x32_bf16 v[104:107], v[48:51], v[24:27], v[104:107]
v_mfma_f32_16x16x32_bf16 v[108:111], v[48:51], v[28:31], v[108:111]
v_mfma_f32_16x16x32_bf16 v[112:115], v[52:55], v[16:19], v[112:115]
v_mfma_f32_16x16x32_bf16 v[116:119], v[52:55], v[20:23], v[116:119]
v_mfma_f32_16x16x32_bf16 v[120:123], v[52:55], v[24:27], v[120:123]
v_mfma_f32_16x16x32_bf16 v[124:127], v[52:55], v[28:31], v[124:127]
ds_read_b128 v[16:19], v2 offset:32768
ds_read_b128 v[20:23], v2 offset:33792
ds_read_b128 v[24:27], v2 offset:34816
ds_read_b128 v[28:31], v2 offset:35840
ds_read_b64_tr_b16 v[48:49], v5 offset:29280
ds_read_b64_tr_b16 v[50:51], v5 offset:31072
ds_read_b64_tr_b16 v[52:53], v5 offset:36576
ds_read_b64_tr_b16 v[54:55], v5 offset:38368
s_waitcnt lgkmcnt(8)
v_mfma_f32_16x16x32_bf16 v[128:131], v[56:59], v[32:35], v[128:131]
v_mfma_f32_16x16x32_bf16 v[132:135], v[56:59], v[36:39], v[132:135]
v_mfma_f32_16x16x32_bf16 v[136:139], v[56:59], v[40:43], v[136:139]
v_mfma_f32_16x16x32_bf16 v[140:143], v[56:59], v[44:47], v[140:143]
v_pk_mul_f32 v[68:69], v[96:97], s[76:77]
v_pk_mul_f32 v[70:71], v[98:99], s[76:77]
v_pk_mul_f32 v[72:73], v[100:101], s[76:77]
v_pk_mul_f32 v[74:75], v[102:103], s[76:77]
v_mfma_f32_16x16x32_bf16 v[144:147], v[60:63], v[32:35], v[144:147]
v_pk_mul_f32 v[76:77], v[104:105], s[76:77]
v_pk_mul_f32 v[78:79], v[106:107], s[76:77]
v_pk_mul_f32 v[80:81], v[108:109], s[76:77]
v_pk_mul_f32 v[82:83], v[110:111], s[76:77]
v_mfma_f32_16x16x32_bf16 v[148:151], v[60:63], v[36:39], v[148:151]
v_exp_f32 v68, v68
v_exp_f32 v69, v69
v_exp_f32 v70, v70
v_exp_f32 v71, v71
v_mfma_f32_16x16x32_bf16 v[152:155], v[60:63], v[40:43], v[152:155]
v_exp_f32 v72, v72
v_exp_f32 v73, v73
v_exp_f32 v74, v74
v_exp_f32 v75, v75
v_mfma_f32_16x16x32_bf16 v[156:159], v[60:63], v[44:47], v[156:159]
v_exp_f32 v76, v76
v_exp_f32 v77, v77
v_exp_f32 v78, v78
v_exp_f32 v79, v79
ds_read_b128 v[32:35], v2 offset:49152
ds_read_b128 v[36:39], v2 offset:50176
ds_read_b128 v[40:43], v2 offset:51200
ds_read_b128 v[44:47], v2 offset:52224
ds_read_b64_tr_b16 v[56:57], v5 offset:43872
ds_read_b64_tr_b16 v[58:59], v5 offset:45664
ds_read_b64_tr_b16 v[60:61], v5 offset:51168
ds_read_b64_tr_b16 v[62:63], v5 offset:52960
s_waitcnt lgkmcnt(8)
v_mfma_f32_16x16x32_bf16 v[128:131], v[48:51], v[16:19], v[128:131]
v_exp_f32 v80, v80
v_exp_f32 v81, v81
v_exp_f32 v82, v82
v_exp_f32 v83, v83
v_mfma_f32_16x16x32_bf16 v[132:135], v[48:51], v[20:23], v[132:135]
v_pk_mul_f32 v[96:97], v[96:97], v[112:113]
v_pk_mul_f32 v[98:99], v[98:99], v[114:115]
v_pk_mul_f32 v[100:101], v[100:101], v[116:117]
v_pk_mul_f32 v[102:103], v[102:103], v[118:119]
v_mfma_f32_16x16x32_bf16 v[136:139], v[48:51], v[24:27], v[136:139]
v_pk_mul_f32 v[104:105], v[104:105], v[120:121]
v_pk_mul_f32 v[106:107], v[106:107], v[122:123]
v_pk_mul_f32 v[108:109], v[108:109], v[124:125]
v_pk_mul_f32 v[110:111], v[110:111], v[126:127]
v_mfma_f32_16x16x32_bf16 v[140:143], v[48:51], v[28:31], v[140:143]
v_pk_add_f32 v[68:69], v[68:69], s[72:73]
v_pk_add_f32 v[70:71], v[70:71], s[72:73]
v_pk_add_f32 v[72:73], v[72:73], s[72:73]
v_pk_add_f32 v[74:75], v[74:75], s[72:73]
v_mfma_f32_16x16x32_bf16 v[144:147], v[52:55], v[16:19], v[144:147]
v_pk_add_f32 v[76:77], v[76:77], s[72:73]
v_pk_add_f32 v[78:79], v[78:79], s[72:73]
v_pk_add_f32 v[80:81], v[80:81], s[72:73]
v_pk_add_f32 v[82:83], v[82:83], s[72:73]
v_mfma_f32_16x16x32_bf16 v[148:151], v[52:55], v[20:23], v[148:151]
v_rcp_f32 v68, v68
v_rcp_f32 v69, v69
v_rcp_f32 v70, v70
v_rcp_f32 v71, v71
v_mfma_f32_16x16x32_bf16 v[152:155], v[52:55], v[24:27], v[152:155]
v_rcp_f32 v72, v72
v_rcp_f32 v73, v73
v_rcp_f32 v74, v74
v_rcp_f32 v75, v75
v_mfma_f32_16x16x32_bf16 v[156:159], v[52:55], v[28:31], v[156:159]
v_rcp_f32 v76, v76
v_rcp_f32 v77, v77
v_rcp_f32 v78, v78
v_rcp_f32 v79, v79
ds_read_b128 v[16:19], v2 offset:16384
ds_read_b128 v[20:23], v2 offset:17408
ds_read_b128 v[24:27], v2 offset:18432
ds_read_b128 v[28:31], v2 offset:19456
ds_read_b64_tr_b16 v[48:49], v5 offset:14720
ds_read_b64_tr_b16 v[50:51], v5 offset:16512
ds_read_b64_tr_b16 v[52:53], v5 offset:22016
ds_read_b64_tr_b16 v[54:55], v5 offset:23808
s_waitcnt lgkmcnt(8)
v_mfma_f32_16x16x32_bf16 v[128:131], v[56:59], v[32:35], v[128:131]
v_rcp_f32 v80, v80
v_rcp_f32 v81, v81
v_rcp_f32 v82, v82
v_rcp_f32 v83, v83
v_mfma_f32_16x16x32_bf16 v[132:135], v[56:59], v[36:39], v[132:135]
s_mov_b32 s74, 2048
v_pk_mul_f32 v[96:97], v[96:97], v[68:69]
v_pk_mul_f32 v[98:99], v[98:99], v[70:71]
v_pk_mul_f32 v[100:101], v[100:101], v[72:73]
v_mfma_f32_16x16x32_bf16 v[136:139], v[56:59], v[40:43], v[136:139]
v_pk_mul_f32 v[102:103], v[102:103], v[74:75]
v_pk_mul_f32 v[104:105], v[104:105], v[76:77]
v_pk_mul_f32 v[106:107], v[106:107], v[78:79]
v_pk_mul_f32 v[108:109], v[108:109], v[80:81]
v_mfma_f32_16x16x32_bf16 v[140:143], v[56:59], v[44:47], v[140:143]
v_pk_mul_f32 v[110:111], v[110:111], v[82:83]
v_cvt_pk_bf16_f32 v112, v96, v97
v_cvt_pk_bf16_f32 v113, v98, v99
v_cvt_pk_bf16_f32 v114, v100, v101
v_mfma_f32_16x16x32_bf16 v[144:147], v[60:63], v[32:35], v[144:147]
v_cvt_pk_bf16_f32 v115, v102, v103
v_cvt_pk_bf16_f32 v116, v104, v105
v_cvt_pk_bf16_f32 v117, v106, v107
v_mfma_f32_16x16x32_bf16 v[148:151], v[60:63], v[36:39], v[148:151]
v_cvt_pk_bf16_f32 v118, v108, v109
v_cvt_pk_bf16_f32 v119, v110, v111
s_nop 1
v_mfma_f32_16x16x32_bf16 v[152:155], v[60:63], v[40:43], v[152:155]
v_permlane32_swap_b32 v112, v114
v_permlane32_swap_b32 v113, v115
v_permlane32_swap_b32 v116, v118
v_mfma_f32_16x16x32_bf16 v[156:159], v[60:63], v[44:47], v[156:159]
v_permlane32_swap_b32 v117, v119
buffer_store_dwordx4 v[112:115], v91, s[12:15], s74 offen sc1
buffer_store_dwordx4 v[116:119], v92, s[12:15], s74 offen sc1
ds_read_b128 v[32:35], v2 offset:32768
ds_read_b128 v[36:39], v2 offset:33792
ds_read_b128 v[40:43], v2 offset:34816
ds_read_b128 v[44:47], v2 offset:35840
ds_read_b64_tr_b16 v[56:57], v5 offset:29312
ds_read_b64_tr_b16 v[58:59], v5 offset:31104
ds_read_b64_tr_b16 v[60:61], v5 offset:36608
ds_read_b64_tr_b16 v[62:63], v5 offset:38400
s_waitcnt lgkmcnt(8)
v_mfma_f32_16x16x32_bf16 v[160:163], v[48:51], v[16:19], v[160:163]
v_mfma_f32_16x16x32_bf16 v[164:167], v[48:51], v[20:23], v[164:167]
v_mfma_f32_16x16x32_bf16 v[168:171], v[48:51], v[24:27], v[168:171]
v_mfma_f32_16x16x32_bf16 v[172:175], v[48:51], v[28:31], v[172:175]
v_pk_mul_f32 v[68:69], v[128:129], s[76:77]
v_pk_mul_f32 v[70:71], v[130:131], s[76:77]
v_pk_mul_f32 v[72:73], v[132:133], s[76:77]
v_pk_mul_f32 v[74:75], v[134:135], s[76:77]
v_mfma_f32_16x16x32_bf16 v[176:179], v[52:55], v[16:19], v[176:179]
v_pk_mul_f32 v[76:77], v[136:137], s[76:77]
v_pk_mul_f32 v[78:79], v[138:139], s[76:77]
v_pk_mul_f32 v[80:81], v[140:141], s[76:77]
v_pk_mul_f32 v[82:83], v[142:143], s[76:77]
v_mfma_f32_16x16x32_bf16 v[180:183], v[52:55], v[20:23], v[180:183]
v_exp_f32 v68, v68
v_exp_f32 v69, v69
v_exp_f32 v70, v70
v_exp_f32 v71, v71
v_mfma_f32_16x16x32_bf16 v[184:187], v[52:55], v[24:27], v[184:187]
v_exp_f32 v72, v72
v_exp_f32 v73, v73
v_exp_f32 v74, v74
v_exp_f32 v75, v75
v_mfma_f32_16x16x32_bf16 v[188:191], v[52:55], v[28:31], v[188:191]
v_exp_f32 v76, v76
v_exp_f32 v77, v77
v_exp_f32 v78, v78
v_exp_f32 v79, v79
ds_read_b128 v[16:19], v2 offset:49152
ds_read_b128 v[20:23], v2 offset:50176
ds_read_b128 v[24:27], v2 offset:51200
ds_read_b128 v[28:31], v2 offset:52224
ds_read_b64_tr_b16 v[48:49], v5 offset:43904
ds_read_b64_tr_b16 v[50:51], v5 offset:45696
ds_read_b64_tr_b16 v[52:53], v5 offset:51200
ds_read_b64_tr_b16 v[54:55], v5 offset:52992
s_waitcnt lgkmcnt(8)
v_mfma_f32_16x16x32_bf16 v[160:163], v[56:59], v[32:35], v[160:163]
v_exp_f32 v80, v80
v_exp_f32 v81, v81
v_exp_f32 v82, v82
v_exp_f32 v83, v83
v_mfma_f32_16x16x32_bf16 v[164:167], v[56:59], v[36:39], v[164:167]
v_pk_mul_f32 v[128:129], v[128:129], v[144:145]
v_pk_mul_f32 v[130:131], v[130:131], v[146:147]
v_pk_mul_f32 v[132:133], v[132:133], v[148:149]
v_pk_mul_f32 v[134:135], v[134:135], v[150:151]
v_mfma_f32_16x16x32_bf16 v[168:171], v[56:59], v[40:43], v[168:171]
v_pk_mul_f32 v[136:137], v[136:137], v[152:153]
v_pk_mul_f32 v[138:139], v[138:139], v[154:155]
v_pk_mul_f32 v[140:141], v[140:141], v[156:157]
v_pk_mul_f32 v[142:143], v[142:143], v[158:159]
v_mfma_f32_16x16x32_bf16 v[172:175], v[56:59], v[44:47], v[172:175]
v_pk_add_f32 v[68:69], v[68:69], s[72:73]
v_pk_add_f32 v[70:71], v[70:71], s[72:73]
v_pk_add_f32 v[72:73], v[72:73], s[72:73]
v_pk_add_f32 v[74:75], v[74:75], s[72:73]
v_mfma_f32_16x16x32_bf16 v[176:179], v[60:63], v[32:35], v[176:179]
v_pk_add_f32 v[76:77], v[76:77], s[72:73]
v_pk_add_f32 v[78:79], v[78:79], s[72:73]
v_pk_add_f32 v[80:81], v[80:81], s[72:73]
v_pk_add_f32 v[82:83], v[82:83], s[72:73]
v_mfma_f32_16x16x32_bf16 v[180:183], v[60:63], v[36:39], v[180:183]
v_rcp_f32 v68, v68
v_rcp_f32 v69, v69
v_rcp_f32 v70, v70
v_rcp_f32 v71, v71
v_mfma_f32_16x16x32_bf16 v[184:187], v[60:63], v[40:43], v[184:187]
v_rcp_f32 v72, v72
v_rcp_f32 v73, v73
v_rcp_f32 v74, v74
v_rcp_f32 v75, v75
v_mfma_f32_16x16x32_bf16 v[188:191], v[60:63], v[44:47], v[188:191]
v_rcp_f32 v76, v76
v_rcp_f32 v77, v77
v_rcp_f32 v78, v78
v_rcp_f32 v79, v79
ds_read_b128 v[32:35], v2 offset:16384
ds_read_b128 v[36:39], v2 offset:17408
ds_read_b128 v[40:43], v2 offset:18432
ds_read_b128 v[44:47], v2 offset:19456
ds_read_b64_tr_b16 v[56:57], v5 offset:14752
ds_read_b64_tr_b16 v[58:59], v5 offset:16544
ds_read_b64_tr_b16 v[60:61], v5 offset:22048
ds_read_b64_tr_b16 v[62:63], v5 offset:23840
s_waitcnt lgkmcnt(8)
v_mfma_f32_16x16x32_bf16 v[160:163], v[48:51], v[16:19], v[160:163]
v_rcp_f32 v80, v80
v_rcp_f32 v81, v81
v_rcp_f32 v82, v82
v_rcp_f32 v83, v83
v_mfma_f32_16x16x32_bf16 v[164:167], v[48:51], v[20:23], v[164:167]
s_mov_b32 s74, 3072
v_pk_mul_f32 v[128:129], v[128:129], v[68:69]
v_pk_mul_f32 v[130:131], v[130:131], v[70:71]
v_pk_mul_f32 v[132:133], v[132:133], v[72:73]
v_mfma_f32_16x16x32_bf16 v[168:171], v[48:51], v[24:27], v[168:171]
v_pk_mul_f32 v[134:135], v[134:135], v[74:75]
v_pk_mul_f32 v[136:137], v[136:137], v[76:77]
v_pk_mul_f32 v[138:139], v[138:139], v[78:79]
v_pk_mul_f32 v[140:141], v[140:141], v[80:81]
v_mfma_f32_16x16x32_bf16 v[172:175], v[48:51], v[28:31], v[172:175]
v_pk_mul_f32 v[142:143], v[142:143], v[82:83]
v_cvt_pk_bf16_f32 v144, v128, v129
v_cvt_pk_bf16_f32 v145, v130, v131
v_cvt_pk_bf16_f32 v146, v132, v133
v_mfma_f32_16x16x32_bf16 v[176:179], v[52:55], v[16:19], v[176:179]
v_cvt_pk_bf16_f32 v147, v134, v135
v_cvt_pk_bf16_f32 v148, v136, v137
v_cvt_pk_bf16_f32 v149, v138, v139
v_mfma_f32_16x16x32_bf16 v[180:183], v[52:55], v[20:23], v[180:183]
v_cvt_pk_bf16_f32 v150, v140, v141
v_cvt_pk_bf16_f32 v151, v142, v143
s_nop 1
v_mfma_f32_16x16x32_bf16 v[184:187], v[52:55], v[24:27], v[184:187]
v_permlane32_swap_b32 v144, v146
v_permlane32_swap_b32 v145, v147
v_permlane32_swap_b32 v148, v150
v_mfma_f32_16x16x32_bf16 v[188:191], v[52:55], v[28:31], v[188:191]
v_permlane32_swap_b32 v149, v151
buffer_store_dwordx4 v[144:147], v91, s[12:15], s74 offen sc1
buffer_store_dwordx4 v[148:151], v92, s[12:15], s74 offen sc1
ds_read_b128 v[16:19], v2 offset:32768
ds_read_b128 v[20:23], v2 offset:33792
ds_read_b128 v[24:27], v2 offset:34816
ds_read_b128 v[28:31], v2 offset:35840
ds_read_b64_tr_b16 v[48:49], v5 offset:29344
ds_read_b64_tr_b16 v[50:51], v5 offset:31136
ds_read_b64_tr_b16 v[52:53], v5 offset:36640
ds_read_b64_tr_b16 v[54:55], v5 offset:38432
s_waitcnt lgkmcnt(8)
v_mfma_f32_16x16x32_bf16 v[192:195], v[56:59], v[32:35], v[192:195]
v_mfma_f32_16x16x32_bf16 v[196:199], v[56:59], v[36:39], v[196:199]
v_mfma_f32_16x16x32_bf16 v[200:203], v[56:59], v[40:43], v[200:203]
v_mfma_f32_16x16x32_bf16 v[204:207], v[56:59], v[44:47], v[204:207]
v_pk_mul_f32 v[68:69], v[160:161], s[76:77]
v_pk_mul_f32 v[70:71], v[162:163], s[76:77]
v_pk_mul_f32 v[72:73], v[164:165], s[76:77]
v_pk_mul_f32 v[74:75], v[166:167], s[76:77]
v_mfma_f32_16x16x32_bf16 v[208:211], v[60:63], v[32:35], v[208:211]
v_pk_mul_f32 v[76:77], v[168:169], s[76:77]
v_pk_mul_f32 v[78:79], v[170:171], s[76:77]
v_pk_mul_f32 v[80:81], v[172:173], s[76:77]
v_pk_mul_f32 v[82:83], v[174:175], s[76:77]
v_mfma_f32_16x16x32_bf16 v[212:215], v[60:63], v[36:39], v[212:215]
v_exp_f32 v68, v68
v_exp_f32 v69, v69
v_exp_f32 v70, v70
v_exp_f32 v71, v71
v_mfma_f32_16x16x32_bf16 v[216:219], v[60:63], v[40:43], v[216:219]
v_exp_f32 v72, v72
v_exp_f32 v73, v73
v_exp_f32 v74, v74
v_exp_f32 v75, v75
v_mfma_f32_16x16x32_bf16 v[220:223], v[60:63], v[44:47], v[220:223]
v_exp_f32 v76, v76
v_exp_f32 v77, v77
v_exp_f32 v78, v78
v_exp_f32 v79, v79
ds_read_b128 v[32:35], v2 offset:49152
ds_read_b128 v[36:39], v2 offset:50176
ds_read_b128 v[40:43], v2 offset:51200
ds_read_b128 v[44:47], v2 offset:52224
ds_read_b64_tr_b16 v[56:57], v5 offset:43936
ds_read_b64_tr_b16 v[58:59], v5 offset:45728
ds_read_b64_tr_b16 v[60:61], v5 offset:51232
ds_read_b64_tr_b16 v[62:63], v5 offset:53024
s_waitcnt lgkmcnt(8)
v_mfma_f32_16x16x32_bf16 v[192:195], v[48:51], v[16:19], v[192:195]
v_exp_f32 v80, v80
v_exp_f32 v81, v81
v_exp_f32 v82, v82
v_exp_f32 v83, v83
v_mfma_f32_16x16x32_bf16 v[196:199], v[48:51], v[20:23], v[196:199]
v_pk_mul_f32 v[160:161], v[160:161], v[176:177]
v_pk_mul_f32 v[162:163], v[162:163], v[178:179]
v_pk_mul_f32 v[164:165], v[164:165], v[180:181]
v_pk_mul_f32 v[166:167], v[166:167], v[182:183]
v_mfma_f32_16x16x32_bf16 v[200:203], v[48:51], v[24:27], v[200:203]
v_pk_mul_f32 v[168:169], v[168:169], v[184:185]
v_pk_mul_f32 v[170:171], v[170:171], v[186:187]
v_pk_mul_f32 v[172:173], v[172:173], v[188:189]
v_pk_mul_f32 v[174:175], v[174:175], v[190:191]
v_mfma_f32_16x16x32_bf16 v[204:207], v[48:51], v[28:31], v[204:207]
v_pk_add_f32 v[68:69], v[68:69], s[72:73]
v_pk_add_f32 v[70:71], v[70:71], s[72:73]
v_pk_add_f32 v[72:73], v[72:73], s[72:73]
v_pk_add_f32 v[74:75], v[74:75], s[72:73]
v_mfma_f32_16x16x32_bf16 v[208:211], v[52:55], v[16:19], v[208:211]
v_pk_add_f32 v[76:77], v[76:77], s[72:73]
v_pk_add_f32 v[78:79], v[78:79], s[72:73]
v_pk_add_f32 v[80:81], v[80:81], s[72:73]
v_pk_add_f32 v[82:83], v[82:83], s[72:73]
v_mfma_f32_16x16x32_bf16 v[212:215], v[52:55], v[20:23], v[212:215]
v_rcp_f32 v68, v68
v_rcp_f32 v69, v69
v_rcp_f32 v70, v70
v_rcp_f32 v71, v71
v_mfma_f32_16x16x32_bf16 v[216:219], v[52:55], v[24:27], v[216:219]
v_rcp_f32 v72, v72
v_rcp_f32 v73, v73
v_rcp_f32 v74, v74
v_rcp_f32 v75, v75
v_mfma_f32_16x16x32_bf16 v[220:223], v[52:55], v[28:31], v[220:223]
v_rcp_f32 v76, v76
v_rcp_f32 v77, v77
v_rcp_f32 v78, v78
v_rcp_f32 v79, v79
ds_read_b128 v[16:19], v2 offset:16384
ds_read_b128 v[20:23], v2 offset:17408
ds_read_b128 v[24:27], v2 offset:18432
ds_read_b128 v[28:31], v2 offset:19456
ds_read_b64_tr_b16 v[48:49], v5 offset:14784
ds_read_b64_tr_b16 v[50:51], v5 offset:16576
ds_read_b64_tr_b16 v[52:53], v5 offset:22080
ds_read_b64_tr_b16 v[54:55], v5 offset:23872
s_waitcnt lgkmcnt(8)
v_mfma_f32_16x16x32_bf16 v[192:195], v[56:59], v[32:35], v[192:195]
v_rcp_f32 v80, v80
v_rcp_f32 v81, v81
v_rcp_f32 v82, v82
v_rcp_f32 v83, v83
v_mfma_f32_16x16x32_bf16 v[196:199], v[56:59], v[36:39], v[196:199]
s_mov_b32 s74, 4096
v_pk_mul_f32 v[160:161], v[160:161], v[68:69]
v_pk_mul_f32 v[162:163], v[162:163], v[70:71]
v_pk_mul_f32 v[164:165], v[164:165], v[72:73]
v_mfma_f32_16x16x32_bf16 v[200:203], v[56:59], v[40:43], v[200:203]
v_pk_mul_f32 v[166:167], v[166:167], v[74:75]
v_pk_mul_f32 v[168:169], v[168:169], v[76:77]
v_pk_mul_f32 v[170:171], v[170:171], v[78:79]
v_pk_mul_f32 v[172:173], v[172:173], v[80:81]
v_mfma_f32_16x16x32_bf16 v[204:207], v[56:59], v[44:47], v[204:207]
v_pk_mul_f32 v[174:175], v[174:175], v[82:83]
v_cvt_pk_bf16_f32 v176, v160, v161
v_cvt_pk_bf16_f32 v177, v162, v163
v_cvt_pk_bf16_f32 v178, v164, v165
v_mfma_f32_16x16x32_bf16 v[208:211], v[60:63], v[32:35], v[208:211]
v_cvt_pk_bf16_f32 v179, v166, v167
v_cvt_pk_bf16_f32 v180, v168, v169
v_cvt_pk_bf16_f32 v181, v170, v171
v_mfma_f32_16x16x32_bf16 v[212:215], v[60:63], v[36:39], v[212:215]
v_cvt_pk_bf16_f32 v182, v172, v173
v_cvt_pk_bf16_f32 v183, v174, v175
s_nop 1
v_mfma_f32_16x16x32_bf16 v[216:219], v[60:63], v[40:43], v[216:219]
v_permlane32_swap_b32 v176, v178
v_permlane32_swap_b32 v177, v179
v_permlane32_swap_b32 v180, v182
v_mfma_f32_16x16x32_bf16 v[220:223], v[60:63], v[44:47], v[220:223]
v_permlane32_swap_b32 v181, v183
buffer_store_dwordx4 v[176:179], v91, s[12:15], s74 offen sc1
buffer_store_dwordx4 v[180:183], v92, s[12:15], s74 offen sc1
ds_read_b128 v[32:35], v2 offset:32768
ds_read_b128 v[36:39], v2 offset:33792
ds_read_b128 v[40:43], v2 offset:34816
ds_read_b128 v[44:47], v2 offset:35840
ds_read_b64_tr_b16 v[56:57], v5 offset:29376
ds_read_b64_tr_b16 v[58:59], v5 offset:31168
ds_read_b64_tr_b16 v[60:61], v5 offset:36672
ds_read_b64_tr_b16 v[62:63], v5 offset:38464
s_waitcnt lgkmcnt(8)
v_mfma_f32_16x16x32_bf16 v[224:227], v[48:51], v[16:19], v[224:227]
v_mfma_f32_16x16x32_bf16 v[228:231], v[48:51], v[20:23], v[228:231]
v_mfma_f32_16x16x32_bf16 v[232:235], v[48:51], v[24:27], v[232:235]
v_mfma_f32_16x16x32_bf16 v[236:239], v[48:51], v[28:31], v[236:239]
v_pk_mul_f32 v[68:69], v[192:193], s[76:77]
v_pk_mul_f32 v[70:71], v[194:195], s[76:77]
v_pk_mul_f32 v[72:73], v[196:197], s[76:77]
v_pk_mul_f32 v[74:75], v[198:199], s[76:77]
v_mfma_f32_16x16x32_bf16 v[240:243], v[52:55], v[16:19], v[240:243]
v_pk_mul_f32 v[76:77], v[200:201], s[76:77]
v_pk_mul_f32 v[78:79], v[202:203], s[76:77]
v_pk_mul_f32 v[80:81], v[204:205], s[76:77]
v_pk_mul_f32 v[82:83], v[206:207], s[76:77]
v_mfma_f32_16x16x32_bf16 v[244:247], v[52:55], v[20:23], v[244:247]
v_exp_f32 v68, v68
v_exp_f32 v69, v69
v_exp_f32 v70, v70
v_exp_f32 v71, v71
v_mfma_f32_16x16x32_bf16 v[248:251], v[52:55], v[24:27], v[248:251]
v_exp_f32 v72, v72
v_exp_f32 v73, v73
v_exp_f32 v74, v74
v_exp_f32 v75, v75
v_mfma_f32_16x16x32_bf16 v[252:255], v[52:55], v[28:31], v[252:255]
v_exp_f32 v76, v76
v_exp_f32 v77, v77
v_exp_f32 v78, v78
v_exp_f32 v79, v79
ds_read_b128 v[16:19], v2 offset:49152
ds_read_b128 v[20:23], v2 offset:50176
ds_read_b128 v[24:27], v2 offset:51200
ds_read_b128 v[28:31], v2 offset:52224
ds_read_b64_tr_b16 v[48:49], v5 offset:43968
ds_read_b64_tr_b16 v[50:51], v5 offset:45760
ds_read_b64_tr_b16 v[52:53], v5 offset:51264
ds_read_b64_tr_b16 v[54:55], v5 offset:53056
s_waitcnt lgkmcnt(8)
v_mfma_f32_16x16x32_bf16 v[224:227], v[56:59], v[32:35], v[224:227]
v_exp_f32 v80, v80
v_exp_f32 v81, v81
v_exp_f32 v82, v82
v_exp_f32 v83, v83
v_mfma_f32_16x16x32_bf16 v[228:231], v[56:59], v[36:39], v[228:231]
v_pk_mul_f32 v[192:193], v[192:193], v[208:209]
v_pk_mul_f32 v[194:195], v[194:195], v[210:211]
v_pk_mul_f32 v[196:197], v[196:197], v[212:213]
v_pk_mul_f32 v[198:199], v[198:199], v[214:215]
v_mfma_f32_16x16x32_bf16 v[232:235], v[56:59], v[40:43], v[232:235]
v_pk_mul_f32 v[200:201], v[200:201], v[216:217]
v_pk_mul_f32 v[202:203], v[202:203], v[218:219]
v_pk_mul_f32 v[204:205], v[204:205], v[220:221]
v_pk_mul_f32 v[206:207], v[206:207], v[222:223]
v_mfma_f32_16x16x32_bf16 v[236:239], v[56:59], v[44:47], v[236:239]
v_pk_add_f32 v[68:69], v[68:69], s[72:73]
v_pk_add_f32 v[70:71], v[70:71], s[72:73]
v_pk_add_f32 v[72:73], v[72:73], s[72:73]
v_pk_add_f32 v[74:75], v[74:75], s[72:73]
v_mfma_f32_16x16x32_bf16 v[240:243], v[60:63], v[32:35], v[240:243]
v_pk_add_f32 v[76:77], v[76:77], s[72:73]
v_pk_add_f32 v[78:79], v[78:79], s[72:73]
v_pk_add_f32 v[80:81], v[80:81], s[72:73]
v_pk_add_f32 v[82:83], v[82:83], s[72:73]
v_mfma_f32_16x16x32_bf16 v[244:247], v[60:63], v[36:39], v[244:247]
v_rcp_f32 v68, v68
v_rcp_f32 v69, v69
v_rcp_f32 v70, v70
v_rcp_f32 v71, v71
v_mfma_f32_16x16x32_bf16 v[248:251], v[60:63], v[40:43], v[248:251]
v_rcp_f32 v72, v72
v_rcp_f32 v73, v73
v_rcp_f32 v74, v74
v_rcp_f32 v75, v75
v_mfma_f32_16x16x32_bf16 v[252:255], v[60:63], v[44:47], v[252:255]
v_rcp_f32 v76, v76
v_rcp_f32 v77, v77
v_rcp_f32 v78, v78
v_rcp_f32 v79, v79
s_waitcnt lgkmcnt(0)
v_mfma_f32_16x16x32_bf16 v[224:227], v[48:51], v[16:19], v[224:227]
v_rcp_f32 v80, v80
v_rcp_f32 v81, v81
v_rcp_f32 v82, v82
v_rcp_f32 v83, v83
v_mfma_f32_16x16x32_bf16 v[228:231], v[48:51], v[20:23], v[228:231]
s_mov_b32 s74, 5120
v_pk_mul_f32 v[192:193], v[192:193], v[68:69]
v_pk_mul_f32 v[194:195], v[194:195], v[70:71]
v_pk_mul_f32 v[196:197], v[196:197], v[72:73]
v_mfma_f32_16x16x32_bf16 v[232:235], v[48:51], v[24:27], v[232:235]
v_pk_mul_f32 v[198:199], v[198:199], v[74:75]
v_pk_mul_f32 v[200:201], v[200:201], v[76:77]
v_pk_mul_f32 v[202:203], v[202:203], v[78:79]
v_pk_mul_f32 v[204:205], v[204:205], v[80:81]
v_mfma_f32_16x16x32_bf16 v[236:239], v[48:51], v[28:31], v[236:239]
v_pk_mul_f32 v[206:207], v[206:207], v[82:83]
v_cvt_pk_bf16_f32 v208, v192, v193
v_cvt_pk_bf16_f32 v209, v194, v195
v_cvt_pk_bf16_f32 v210, v196, v197
v_mfma_f32_16x16x32_bf16 v[240:243], v[52:55], v[16:19], v[240:243]
v_cvt_pk_bf16_f32 v211, v198, v199
v_cvt_pk_bf16_f32 v212, v200, v201
v_cvt_pk_bf16_f32 v213, v202, v203
v_mfma_f32_16x16x32_bf16 v[244:247], v[52:55], v[20:23], v[244:247]
v_cvt_pk_bf16_f32 v214, v204, v205
v_cvt_pk_bf16_f32 v215, v206, v207
s_nop 1
v_mfma_f32_16x16x32_bf16 v[248:251], v[52:55], v[24:27], v[248:251]
v_permlane32_swap_b32 v208, v210
v_permlane32_swap_b32 v209, v211
v_permlane32_swap_b32 v212, v214
v_mfma_f32_16x16x32_bf16 v[252:255], v[52:55], v[28:31], v[252:255]
v_permlane32_swap_b32 v213, v215
buffer_store_dwordx4 v[208:211], v91, s[12:15], s74 offen sc1
buffer_store_dwordx4 v[212:215], v92, s[12:15], s74 offen sc1
s_nop 15
v_pk_mul_f32 v[68:69], v[224:225], s[76:77]
v_pk_mul_f32 v[70:71], v[226:227], s[76:77]
v_pk_mul_f32 v[72:73], v[228:229], s[76:77]
v_pk_mul_f32 v[74:75], v[230:231], s[76:77]
v_pk_mul_f32 v[76:77], v[232:233], s[76:77]
v_pk_mul_f32 v[78:79], v[234:235], s[76:77]
v_pk_mul_f32 v[80:81], v[236:237], s[76:77]
v_pk_mul_f32 v[82:83], v[238:239], s[76:77]
v_exp_f32 v68, v68
v_exp_f32 v69, v69
v_exp_f32 v70, v70
v_exp_f32 v71, v71
v_exp_f32 v72, v72
v_exp_f32 v73, v73
v_exp_f32 v74, v74
v_exp_f32 v75, v75
v_exp_f32 v76, v76
v_exp_f32 v77, v77
v_exp_f32 v78, v78
v_exp_f32 v79, v79
v_exp_f32 v80, v80
v_exp_f32 v81, v81
v_exp_f32 v82, v82
v_exp_f32 v83, v83
v_pk_mul_f32 v[224:225], v[224:225], v[240:241]
v_pk_mul_f32 v[226:227], v[226:227], v[242:243]
v_pk_mul_f32 v[228:229], v[228:229], v[244:245]
v_pk_mul_f32 v[230:231], v[230:231], v[246:247]
v_pk_mul_f32 v[232:233], v[232:233], v[248:249]
v_pk_mul_f32 v[234:235], v[234:235], v[250:251]
v_pk_mul_f32 v[236:237], v[236:237], v[252:253]
v_pk_mul_f32 v[238:239], v[238:239], v[254:255]
v_pk_add_f32 v[68:69], v[68:69], s[72:73]
v_pk_add_f32 v[70:71], v[70:71], s[72:73]
v_pk_add_f32 v[72:73], v[72:73], s[72:73]
v_pk_add_f32 v[74:75], v[74:75], s[72:73]
v_pk_add_f32 v[76:77], v[76:77], s[72:73]
v_pk_add_f32 v[78:79], v[78:79], s[72:73]
v_pk_add_f32 v[80:81], v[80:81], s[72:73]
v_pk_add_f32 v[82:83], v[82:83], s[72:73]
v_rcp_f32 v68, v68
v_rcp_f32 v69, v69
v_rcp_f32 v70, v70
v_rcp_f32 v71, v71
v_rcp_f32 v72, v72
v_rcp_f32 v73, v73
v_rcp_f32 v74, v74
v_rcp_f32 v75, v75
v_rcp_f32 v76, v76
v_rcp_f32 v77, v77
v_rcp_f32 v78, v78
v_rcp_f32 v79, v79
v_rcp_f32 v80, v80
v_rcp_f32 v81, v81
v_rcp_f32 v82, v82
v_rcp_f32 v83, v83
s_mov_b32 s74, 6144
v_pk_mul_f32 v[224:225], v[224:225], v[68:69]
v_pk_mul_f32 v[226:227], v[226:227], v[70:71]
v_pk_mul_f32 v[228:229], v[228:229], v[72:73]
v_pk_mul_f32 v[230:231], v[230:231], v[74:75]
v_pk_mul_f32 v[232:233], v[232:233], v[76:77]
v_pk_mul_f32 v[234:235], v[234:235], v[78:79]
v_pk_mul_f32 v[236:237], v[236:237], v[80:81]
v_pk_mul_f32 v[238:239], v[238:239], v[82:83]
v_cvt_pk_bf16_f32 v240, v224, v225
v_cvt_pk_bf16_f32 v241, v226, v227
v_cvt_pk_bf16_f32 v242, v228, v229
v_cvt_pk_bf16_f32 v243, v230, v231
v_cvt_pk_bf16_f32 v244, v232, v233
v_cvt_pk_bf16_f32 v245, v234, v235
v_cvt_pk_bf16_f32 v246, v236, v237
v_cvt_pk_bf16_f32 v247, v238, v239
s_nop 1
v_permlane32_swap_b32 v240, v242
v_permlane32_swap_b32 v241, v243
v_permlane32_swap_b32 v244, v246
v_permlane32_swap_b32 v245, v247
buffer_store_dwordx4 v[240:243], v91, s[12:15], s74 offen sc1
buffer_store_dwordx4 v[244:247], v92, s[12:15], s74 offen sc1
s_endpgm
L_k1_done:
s_endpgm
.globl attn_kernel
.p2align 8
.type attn_kernel,@function
attn_kernel:
s_cmp_ge_u32 s2, 512
s_cbranch_scc1 L_k2_done
s_cmp_ge_u32 s2, 256
s_cbranch_scc1 L_k2_down
s_load_dwordx2 s[4:5], s[0:1], 72
s_load_dwordx2 s[48:49], s[0:1], 16
s_and_b32 s12, s2, 31
s_lshr_b32 s13, s2, 5
v_and_b32 v1, 63, v0
v_lshrrev_b32 v4, 6, v0
s_nop 0
v_readfirstlane_b32 s14, v4
s_nop 3
v_lshlrev_b32 v2, 4, v1
s_lshl_b32 s25, s12, 18
s_add_u32 s25, s25, 8388608
s_lshl_b32 s16, s14, 12
s_add_u32 s18, s25, s16
v_add_u32 v3, s18, v2
s_mov_b32 s15, 0
s_mov_b32 s24, 0x71800000
s_lshl_b32 s18, s12, 6
s_lshl_b32 s19, s13, 3
s_lshl_b32 s20, s14, 1
s_add_u32 s19, s19, s20
s_add_u32 s18, s18, s19
s_lshl_b32 s18, s18, 11
s_add_u32 s18, s18, 4194304
v_add_u32 v4, s18, v2
s_mul_i32 s19, s19, 288
s_lshl_b32 s20, s12, 1
s_add_u32 s19, s19, s20
s_lshl_b32 s19, s19, 10
s_add_u32 s19, s19, 16777216
v_add_u32 v182, s19, v2
v_mov_b32 v104, 0
v_mov_b32 v105, 0
v_mov_b32 v106, 0
v_mov_b32 v107, 0
v_mov_b32 v108, 0
v_mov_b32 v109, 0
v_mov_b32 v110, 0
v_mov_b32 v111, 0
v_mov_b32 v112, 0
v_mov_b32 v113, 0
v_mov_b32 v114, 0
v_mov_b32 v115, 0
v_mov_b32 v116, 0
v_mov_b32 v117, 0
v_mov_b32 v118, 0
v_mov_b32 v119, 0
v_mov_b32 v120, 0
v_mov_b32 v121, 0
v_mov_b32 v122, 0
v_mov_b32 v123, 0
v_mov_b32 v124, 0
v_mov_b32 v125, 0
v_mov_b32 v126, 0
v_mov_b32 v127, 0
v_mov_b32 v128, 0
v_mov_b32 v129, 0
v_mov_b32 v130, 0
v_mov_b32 v131, 0
v_mov_b32 v132, 0
v_mov_b32 v133, 0
v_mov_b32 v134, 0
v_mov_b32 v135, 0
v_mov_b32 v168, 0
v_mov_b32 v169, 0
v_mov_b32 v170, 0
v_mov_b32 v171, 0
v_mov_b32 v172, 0
v_mov_b32 v173, 0
v_mov_b32 v174, 0
v_mov_b32 v175, 0
v_and_b32 v5, 31, v1
v_cmp_eq_u32 vcc, 0, v5
v_cmp_eq_u32 s[20:21], 17, v5
s_nop 1
s_or_b64 vcc, vcc, s[20:21]
v_mov_b32 v5, 0x3f803f80
s_nop 1
v_cndmask_b32 v176, 0, v5, vcc
v_cndmask_b32 v177, 0, v5, vcc
v_cndmask_b32 v178, 0, v5, vcc
v_cndmask_b32 v179, 0, v5, vcc
s_waitcnt lgkmcnt(0)
s_mov_b32 s8, s4
s_and_b32 s9, s5, 0xffff
s_mov_b32 s10, 268435456
s_mov_b32 s11, 0x00020000
s_add_u32 m0, s16, 0
s_nop 0
buffer_load_dwordx4 v3, s[8:11], s15 offen offset:0 lds
buffer_load_dwordx4 v3, s[8:11], s15 offen offset:1024 lds
buffer_load_dwordx4 v3, s[8:11], s15 offen offset:2048 lds
buffer_load_dwordx4 v3, s[8:11], s15 offen offset:3072 lds
s_add_u32 s15, s15, 16384
buffer_load_dwordx4 v[8:11], v4, s[8:11], 0 offen offset:0
buffer_load_dwordx4 v[12:15], v4, s[8:11], 0 offen offset:1024
buffer_load_dwordx4 v[16:19], v4, s[8:11], 0 offen offset:2048
buffer_load_dwordx4 v[20:23], v4, s[8:11], 0 offen offset:3072
s_add_u32 m0, s16, 16384
s_nop 0
buffer_load_dwordx4 v3, s[8:11], s15 offen offset:0 lds
buffer_load_dwordx4 v3, s[8:11], s15 offen offset:1024 lds
buffer_load_dwordx4 v3, s[8:11], s15 offen offset:2048 lds
buffer_load_dwordx4 v3, s[8:11], s15 offen offset:3072 lds
s_add_u32 s15, s15, 16384
s_mov_b32 s52, s48
s_and_b32 s53, s49, 0xffff
s_mov_b32 s54, 2097152
s_mov_b32 s55, 0x00020000
s_lshl_b32 s48, s2, 2
s_add_u32 s48, s48, s14
s_lshl_b32 s48, s48, 11
s_waitcnt vmcnt(4)
s_barrier
ds_read_b128 v[24:27], v2 offset:0
ds_read_b128 v[28:31], v2 offset:1024
ds_read_b128 v[40:43], v2 offset:2048
ds_read_b128 v[44:47], v2 offset:3072
s_add_u32 m0, s16, 32768
s_nop 0
buffer_load_dwordx4 v3, s[8:11], s15 offen offset:0 lds
buffer_load_dwordx4 v3, s[8:11], s15 offen offset:1024 lds
buffer_load_dwordx4 v3, s[8:11], s15 offen offset:2048 lds
buffer_load_dwordx4 v3, s[8:11], s15 offen offset:3072 lds
s_add_u32 s15, s15, 16384
s_waitcnt lgkmcnt(0)
v_mfma_f32_32x32x16_bf16 v[56:71], v[24:27], v[8:11], 0
v_mfma_f32_32x32x16_bf16 v[56:71], v[28:31], v[12:15], v[56:71]
v_mfma_f32_32x32x16_bf16 v[72:87], v[24:27], v[16:19], 0
v_mfma_f32_32x32x16_bf16 v[72:87], v[28:31], v[20:23], v[72:87]
s_nop 15
v_max3_f32 v181, v56, v57, v58
v_max3_f32 v181, v181, v59, v60
v_max3_f32 v181, v181, v61, v62
v_max3_f32 v181, v181, v63, v64
v_max3_f32 v181, v181, v65, v66
v_max3_f32 v181, v181, v67, v68
v_max3_f32 v181, v181, v69, v70
v_max_f32 v181, v181, v71
v_mov_b32 v4, v181
s_nop 1
v_permlane32_swap_b32 v181, v4
s_nop 1
v_max_f32 v181, v181, v4
v_sub_f32 v136, 0, v181
v_sub_f32 v137, 0, v181
v_sub_f32 v138, 0, v181
v_sub_f32 v139, 0, v181
v_sub_f32 v140, 0, v181
v_sub_f32 v141, 0, v181
v_sub_f32 v142, 0, v181
v_sub_f32 v143, 0, v181
v_sub_f32 v144, 0, v181
v_sub_f32 v145, 0, v181
v_sub_f32 v146, 0, v181
v_sub_f32 v147, 0, v181
v_sub_f32 v148, 0, v181
v_sub_f32 v149, 0, v181
v_sub_f32 v150, 0, v181
v_sub_f32 v151, 0, v181
v_sub_f32 v56, v56, v181
v_sub_f32 v57, v57, v181
v_sub_f32 v58, v58, v181
v_sub_f32 v59, v59, v181
v_sub_f32 v60, v60, v181
v_sub_f32 v61, v61, v181
v_sub_f32 v62, v62, v181
v_sub_f32 v63, v63, v181
v_sub_f32 v64, v64, v181
v_sub_f32 v65, v65, v181
v_sub_f32 v66, v66, v181
v_sub_f32 v67, v67, v181
v_sub_f32 v68, v68, v181
v_sub_f32 v69, v69, v181
v_sub_f32 v70, v70, v181
v_sub_f32 v71, v71, v181
v_max3_f32 v181, v72, v73, v74
v_max3_f32 v181, v181, v75, v76
v_max3_f32 v181, v181, v77, v78
v_max3_f32 v181, v181, v79, v80
v_max3_f32 v181, v181, v81, v82
v_max3_f32 v181, v181, v83, v84
v_max3_f32 v181, v181, v85, v86
v_max_f32 v181, v181, v87
v_mov_b32 v4, v181
s_nop 1
v_permlane32_swap_b32 v181, v4
s_nop 1
v_max_f32 v181, v181, v4
v_sub_f32 v152, 0, v181
v_sub_f32 v153, 0, v181
v_sub_f32 v154, 0, v181
v_sub_f32 v155, 0, v181
v_sub_f32 v156, 0, v181
v_sub_f32 v157, 0, v181
v_sub_f32 v158, 0, v181
v_sub_f32 v159, 0, v181
v_sub_f32 v160, 0, v181
v_sub_f32 v161, 0, v181
v_sub_f32 v162, 0, v181
v_sub_f32 v163, 0, v181
v_sub_f32 v164, 0, v181
v_sub_f32 v165, 0, v181
v_sub_f32 v166, 0, v181
v_sub_f32 v167, 0, v181
v_sub_f32 v72, v72, v181
v_sub_f32 v73, v73, v181
v_sub_f32 v74, v74, v181
v_sub_f32 v75, v75, v181
v_sub_f32 v76, v76, v181
v_sub_f32 v77, v77, v181
v_sub_f32 v78, v78, v181
v_sub_f32 v79, v79, v181
v_sub_f32 v80, v80, v181
v_sub_f32 v81, v81, v181
v_sub_f32 v82, v82, v181
v_sub_f32 v83, v83, v181
v_sub_f32 v84, v84, v181
v_sub_f32 v85, v85, v181
v_sub_f32 v86, v86, v181
v_sub_f32 v87, v87, v181
v_exp_f32 v56, v56
v_exp_f32 v57, v57
ds_read_b128 v[32:35], v2 offset:4096
ds_read_b128 v[36:39], v2 offset:5120
v_exp_f32 v58, v58
v_exp_f32 v59, v59
v_exp_f32 v60, v60
v_exp_f32 v61, v61
v_exp_f32 v62, v62
v_exp_f32 v63, v63
v_cvt_pk_bf16_f32 v88, v56, v57
v_cvt_pk_bf16_f32 v89, v58, v59
v_exp_f32 v64, v64
v_exp_f32 v65, v65
v_exp_f32 v66, v66
v_exp_f32 v67, v67
v_cvt_pk_bf16_f32 v90, v60, v61
v_cvt_pk_bf16_f32 v91, v62, v63
v_exp_f32 v68, v68
v_exp_f32 v69, v69
v_exp_f32 v70, v70
v_exp_f32 v71, v71
v_cvt_pk_bf16_f32 v92, v64, v65
v_cvt_pk_bf16_f32 v93, v66, v67
v_cvt_pk_bf16_f32 v94, v68, v69
v_cvt_pk_bf16_f32 v95, v70, v71
s_waitcnt lgkmcnt(0)
v_mfma_f32_32x32x16_bf16 v[56:71], v[32:35], v[8:11], v[136:151]
v_exp_f32 v72, v72
v_exp_f32 v73, v73
v_exp_f32 v74, v74
v_exp_f32 v75, v75
v_mfma_f32_32x32x16_bf16 v[56:71], v[36:39], v[12:15], v[56:71]
v_exp_f32 v76, v76
v_exp_f32 v77, v77
v_exp_f32 v78, v78
v_exp_f32 v79, v79
v_mfma_f32_32x32x16_bf16 v[104:119], v[40:43], v[88:91], v[104:119]
v_cvt_pk_bf16_f32 v96, v72, v73
v_cvt_pk_bf16_f32 v97, v74, v75
v_exp_f32 v80, v80
v_exp_f32 v81, v81
v_mfma_f32_16x16x32_bf16 v[168:171], v[176:179], v[88:91], v[168:171]
v_exp_f32 v82, v82
v_exp_f32 v83, v83
v_mfma_f32_32x32x16_bf16 v[104:119], v[44:47], v[92:95], v[104:119]
v_cvt_pk_bf16_f32 v98, v76, v77
v_cvt_pk_bf16_f32 v99, v78, v79
v_exp_f32 v84, v84
v_exp_f32 v85, v85
v_mfma_f32_16x16x32_bf16 v[168:171], v[176:179], v[92:95], v[168:171]
v_exp_f32 v86, v86
v_exp_f32 v87, v87
v_cvt_pk_bf16_f32 v100, v80, v81
v_cvt_pk_bf16_f32 v101, v82, v83
v_cvt_pk_bf16_f32 v102, v84, v85
v_cvt_pk_bf16_f32 v103, v86, v87
v_mfma_f32_32x32x16_bf16 v[72:87], v[32:35], v[16:19], v[152:167]
v_exp_f32 v56, v56
v_exp_f32 v57, v57
ds_read_b128 v[24:27], v2 offset:8192
ds_read_b128 v[28:31], v2 offset:9216
ds_read_b128 v[48:51], v2 offset:6144
ds_read_b128 v[52:55], v2 offset:7168
v_exp_f32 v58, v58
v_exp_f32 v59, v59
v_mfma_f32_32x32x16_bf16 v[72:87], v[36:39], v[20:23], v[72:87]
v_exp_f32 v60, v60
v_exp_f32 v61, v61
v_exp_f32 v62, v62
v_exp_f32 v63, v63
v_mfma_f32_32x32x16_bf16 v[120:135], v[40:43], v[96:99], v[120:135]
v_cvt_pk_bf16_f32 v88, v56, v57
v_cvt_pk_bf16_f32 v89, v58, v59
v_exp_f32 v64, v64
v_exp_f32 v65, v65
v_mfma_f32_16x16x32_bf16 v[172:175], v[176:179], v[96:99], v[172:175]
v_exp_f32 v66, v66
v_exp_f32 v67, v67
v_mfma_f32_32x32x16_bf16 v[120:135], v[44:47], v[100:103], v[120:135]
v_cvt_pk_bf16_f32 v90, v60, v61
v_cvt_pk_bf16_f32 v91, v62, v63
v_exp_f32 v68, v68
v_exp_f32 v69, v69
v_mfma_f32_16x16x32_bf16 v[172:175], v[176:179], v[100:103], v[172:175]
v_exp_f32 v70, v70
v_exp_f32 v71, v71
v_cvt_pk_bf16_f32 v92, v64, v65
v_cvt_pk_bf16_f32 v93, v66, v67
v_cvt_pk_bf16_f32 v94, v68, v69
v_cvt_pk_bf16_f32 v95, v70, v71
s_waitcnt lgkmcnt(0)
v_mfma_f32_32x32x16_bf16 v[56:71], v[24:27], v[8:11], v[136:151]
v_exp_f32 v72, v72
v_exp_f32 v73, v73
v_exp_f32 v74, v74
v_exp_f32 v75, v75
v_mfma_f32_32x32x16_bf16 v[56:71], v[28:31], v[12:15], v[56:71]
v_exp_f32 v76, v76
v_exp_f32 v77, v77
v_exp_f32 v78, v78
v_exp_f32 v79, v79
v_mfma_f32_32x32x16_bf16 v[104:119], v[48:51], v[88:91], v[104:119]
v_cvt_pk_bf16_f32 v96, v72, v73
v_cvt_pk_bf16_f32 v97, v74, v75
v_exp_f32 v80, v80
v_exp_f32 v81, v81
v_mfma_f32_16x16x32_bf16 v[168:171], v[176:179], v[88:91], v[168:171]
v_exp_f32 v82, v82
v_exp_f32 v83, v83
v_mfma_f32_32x32x16_bf16 v[104:119], v[52:55], v[92:95], v[104:119]
v_cvt_pk_bf16_f32 v98, v76, v77
v_cvt_pk_bf16_f32 v99, v78, v79
v_exp_f32 v84, v84
v_exp_f32 v85, v85
v_mfma_f32_16x16x32_bf16 v[168:171], v[176:179], v[92:95], v[168:171]
v_exp_f32 v86, v86
v_exp_f32 v87, v87
v_cvt_pk_bf16_f32 v100, v80, v81
v_cvt_pk_bf16_f32 v101, v82, v83
v_cvt_pk_bf16_f32 v102, v84, v85
v_cvt_pk_bf16_f32 v103, v86, v87
v_mfma_f32_32x32x16_bf16 v[72:87], v[24:27], v[16:19], v[152:167]
v_exp_f32 v56, v56
v_exp_f32 v57, v57
ds_read_b128 v[32:35], v2 offset:12288
ds_read_b128 v[36:39], v2 offset:13312
ds_read_b128 v[40:43], v2 offset:10240
ds_read_b128 v[44:47], v2 offset:11264
v_exp_f32 v58, v58
v_exp_f32 v59, v59
v_mfma_f32_32x32x16_bf16 v[72:87], v[28:31], v[20:23], v[72:87]
v_exp_f32 v60, v60
v_exp_f32 v61, v61
v_exp_f32 v62, v62
v_exp_f32 v63, v63
v_mfma_f32_32x32x16_bf16 v[120:135], v[48:51], v[96:99], v[120:135]
v_cvt_pk_bf16_f32 v88, v56, v57
v_cvt_pk_bf16_f32 v89, v58, v59
v_exp_f32 v64, v64
v_exp_f32 v65, v65
v_mfma_f32_16x16x32_bf16 v[172:175], v[176:179], v[96:99], v[172:175]
v_exp_f32 v66, v66
v_exp_f32 v67, v67
v_mfma_f32_32x32x16_bf16 v[120:135], v[52:55], v[100:103], v[120:135]
v_cvt_pk_bf16_f32 v90, v60, v61
v_cvt_pk_bf16_f32 v91, v62, v63
v_exp_f32 v68, v68
v_exp_f32 v69, v69
v_mfma_f32_16x16x32_bf16 v[172:175], v[176:179], v[100:103], v[172:175]
v_exp_f32 v70, v70
v_exp_f32 v71, v71
v_cvt_pk_bf16_f32 v92, v64, v65
v_cvt_pk_bf16_f32 v93, v66, v67
v_cvt_pk_bf16_f32 v94, v68, v69
v_cvt_pk_bf16_f32 v95, v70, v71
s_waitcnt lgkmcnt(0)
v_mfma_f32_32x32x16_bf16 v[56:71], v[32:35], v[8:11], v[136:151]
v_exp_f32 v72, v72
v_exp_f32 v73, v73
v_exp_f32 v74, v74
v_exp_f32 v75, v75
v_mfma_f32_32x32x16_bf16 v[56:71], v[36:39], v[12:15], v[56:71]
v_exp_f32 v76, v76
v_exp_f32 v77, v77
v_exp_f32 v78, v78
v_exp_f32 v79, v79
v_mfma_f32_32x32x16_bf16 v[104:119], v[40:43], v[88:91], v[104:119]
v_cvt_pk_bf16_f32 v96, v72, v73
v_cvt_pk_bf16_f32 v97, v74, v75
v_exp_f32 v80, v80
v_exp_f32 v81, v81
v_mfma_f32_16x16x32_bf16 v[168:171], v[176:179], v[88:91], v[168:171]
v_exp_f32 v82, v82
v_exp_f32 v83, v83
v_mfma_f32_32x32x16_bf16 v[104:119], v[44:47], v[92:95], v[104:119]
v_cvt_pk_bf16_f32 v98, v76, v77
v_cvt_pk_bf16_f32 v99, v78, v79
v_exp_f32 v84, v84
v_exp_f32 v85, v85
v_mfma_f32_16x16x32_bf16 v[168:171], v[176:179], v[92:95], v[168:171]
v_exp_f32 v86, v86
v_exp_f32 v87, v87
v_cvt_pk_bf16_f32 v100, v80, v81
v_cvt_pk_bf16_f32 v101, v82, v83
v_cvt_pk_bf16_f32 v102, v84, v85
v_cvt_pk_bf16_f32 v103, v86, v87
s_waitcnt vmcnt(4)
s_barrier
v_mfma_f32_32x32x16_bf16 v[72:87], v[32:35], v[16:19], v[152:167]
v_exp_f32 v56, v56
v_exp_f32 v57, v57
ds_read_b128 v[24:27], v2 offset:16384
ds_read_b128 v[28:31], v2 offset:17408
ds_read_b128 v[48:51], v2 offset:14336
ds_read_b128 v[52:55], v2 offset:15360
v_exp_f32 v58, v58
v_exp_f32 v59, v59
v_mfma_f32_32x32x16_bf16 v[72:87], v[36:39], v[20:23], v[72:87]
v_exp_f32 v60, v60
v_exp_f32 v61, v61
v_exp_f32 v62, v62
v_exp_f32 v63, v63
v_mfma_f32_32x32x16_bf16 v[120:135], v[40:43], v[96:99], v[120:135]
v_cvt_pk_bf16_f32 v88, v56, v57
v_cvt_pk_bf16_f32 v89, v58, v59
v_exp_f32 v64, v64
s_add_u32 m0, s16, 49152
s_nop 0
buffer_load_dwordx4 v3, s[8:11], s15 offen offset:0 lds
buffer_load_dwordx4 v3, s[8:11], s15 offen offset:1024 lds
buffer_load_dwordx4 v3, s[8:11], s15 offen offset:2048 lds
buffer_load_dwordx4 v3, s[8:11], s15 offen offset:3072 lds
s_add_u32 s15, s15, 16384
v_exp_f32 v65, v65
v_mfma_f32_16x16x32_bf16 v[172:175], v[176:179], v[96:99], v[172:175]
v_exp_f32 v66, v66
v_exp_f32 v67, v67
v_mfma_f32_32x32x16_bf16 v[120:135], v[44:47], v[100:103], v[120:135]
v_cvt_pk_bf16_f32 v90, v60, v61
v_cvt_pk_bf16_f32 v91, v62, v63
v_exp_f32 v68, v68
v_exp_f32 v69, v69
v_mfma_f32_16x16x32_bf16 v[172:175], v[176:179], v[100:103], v[172:175]
v_exp_f32 v70, v70
v_exp_f32 v71, v71
v_cvt_pk_bf16_f32 v92, v64, v65
v_cvt_pk_bf16_f32 v93, v66, v67
v_cvt_pk_bf16_f32 v94, v68, v69
v_cvt_pk_bf16_f32 v95, v70, v71
s_waitcnt lgkmcnt(0)
v_mfma_f32_32x32x16_bf16 v[56:71], v[24:27], v[8:11], v[136:151]
v_exp_f32 v72, v72
v_exp_f32 v73, v73
v_exp_f32 v74, v74
v_exp_f32 v75, v75
v_mfma_f32_32x32x16_bf16 v[56:71], v[28:31], v[12:15], v[56:71]
v_exp_f32 v76, v76
v_exp_f32 v77, v77
v_exp_f32 v78, v78
v_exp_f32 v79, v79
v_mfma_f32_32x32x16_bf16 v[104:119], v[48:51], v[88:91], v[104:119]
v_cvt_pk_bf16_f32 v96, v72, v73
v_cvt_pk_bf16_f32 v97, v74, v75
v_exp_f32 v80, v80
v_exp_f32 v81, v81
v_mfma_f32_16x16x32_bf16 v[168:171], v[176:179], v[88:91], v[168:171]
v_exp_f32 v82, v82
v_exp_f32 v83, v83
v_mfma_f32_32x32x16_bf16 v[104:119], v[52:55], v[92:95], v[104:119]
v_cvt_pk_bf16_f32 v98, v76, v77
v_cvt_pk_bf16_f32 v99, v78, v79
v_exp_f32 v84, v84
v_exp_f32 v85, v85
v_mfma_f32_16x16x32_bf16 v[168:171], v[176:179], v[92:95], v[168:171]
v_exp_f32 v86, v86
v_exp_f32 v87, v87
v_cvt_pk_bf16_f32 v100, v80, v81
v_cvt_pk_bf16_f32 v101, v82, v83
v_cvt_pk_bf16_f32 v102, v84, v85
v_cvt_pk_bf16_f32 v103, v86, v87
v_mfma_f32_32x32x16_bf16 v[72:87], v[24:27], v[16:19], v[152:167]
v_exp_f32 v56, v56
v_exp_f32 v57, v57
ds_read_b128 v[32:35], v2 offset:20480
ds_read_b128 v[36:39], v2 offset:21504
ds_read_b128 v[40:43], v2 offset:18432
ds_read_b128 v[44:47], v2 offset:19456
v_exp_f32 v58, v58
v_exp_f32 v59, v59
v_mfma_f32_32x32x16_bf16 v[72:87], v[28:31], v[20:23], v[72:87]
v_exp_f32 v60, v60
v_exp_f32 v61, v61
v_exp_f32 v62, v62
v_exp_f32 v63, v63
v_mfma_f32_32x32x16_bf16 v[120:135], v[48:51], v[96:99], v[120:135]
v_cvt_pk_bf16_f32 v88, v56, v57
v_cvt_pk_bf16_f32 v89, v58, v59
v_exp_f32 v64, v64
v_exp_f32 v65, v65
v_mfma_f32_16x16x32_bf16 v[172:175], v[176:179], v[96:99], v[172:175]
v_exp_f32 v66, v66
v_exp_f32 v67, v67
v_mfma_f32_32x32x16_bf16 v[120:135], v[52:55], v[100:103], v[120:135]
v_cvt_pk_bf16_f32 v90, v60, v61
v_cvt_pk_bf16_f32 v91, v62, v63
v_exp_f32 v68, v68
v_exp_f32 v69, v69
v_mfma_f32_16x16x32_bf16 v[172:175], v[176:179], v[100:103], v[172:175]
v_exp_f32 v70, v70
v_exp_f32 v71, v71
v_cvt_pk_bf16_f32 v92, v64, v65
v_cvt_pk_bf16_f32 v93, v66, v67
v_cvt_pk_bf16_f32 v94, v68, v69
v_cvt_pk_bf16_f32 v95, v70, v71
s_waitcnt lgkmcnt(0)
v_mfma_f32_32x32x16_bf16 v[56:71], v[32:35], v[8:11], v[136:151]
v_exp_f32 v72, v72
v_exp_f32 v73, v73
v_exp_f32 v74, v74
v_exp_f32 v75, v75
v_mfma_f32_32x32x16_bf16 v[56:71], v[36:39], v[12:15], v[56:71]
v_exp_f32 v76, v76
v_exp_f32 v77, v77
v_exp_f32 v78, v78
v_exp_f32 v79, v79
v_mfma_f32_32x32x16_bf16 v[104:119], v[40:43], v[88:91], v[104:119]
v_cvt_pk_bf16_f32 v96, v72, v73
v_cvt_pk_bf16_f32 v97, v74, v75
v_exp_f32 v80, v80
v_exp_f32 v81, v81
v_mfma_f32_16x16x32_bf16 v[168:171], v[176:179], v[88:91], v[168:171]
v_exp_f32 v82, v82
v_exp_f32 v83, v83
v_mfma_f32_32x32x16_bf16 v[104:119], v[44:47], v[92:95], v[104:119]
v_cvt_pk_bf16_f32 v98, v76, v77
v_cvt_pk_bf16_f32 v99, v78, v79
v_exp_f32 v84, v84
v_exp_f32 v85, v85
v_mfma_f32_16x16x32_bf16 v[168:171], v[176:179], v[92:95], v[168:171]
v_exp_f32 v86, v86
v_exp_f32 v87, v87
v_cvt_pk_bf16_f32 v100, v80, v81
v_cvt_pk_bf16_f32 v101, v82, v83
v_cvt_pk_bf16_f32 v102, v84, v85
v_cvt_pk_bf16_f32 v103, v86, v87
v_mfma_f32_32x32x16_bf16 v[72:87], v[32:35], v[16:19], v[152:167]
v_exp_f32 v56, v56
v_exp_f32 v57, v57
ds_read_b128 v[24:27], v2 offset:24576
ds_read_b128 v[28:31], v2 offset:25600
ds_read_b128 v[48:51], v2 offset:22528
ds_read_b128 v[52:55], v2 offset:23552
v_exp_f32 v58, v58
v_exp_f32 v59, v59
v_mfma_f32_32x32x16_bf16 v[72:87], v[36:39], v[20:23], v[72:87]
v_exp_f32 v60, v60
v_exp_f32 v61, v61
v_exp_f32 v62, v62
v_exp_f32 v63, v63
v_mfma_f32_32x32x16_bf16 v[120:135], v[40:43], v[96:99], v[120:135]
v_cvt_pk_bf16_f32 v88, v56, v57
v_cvt_pk_bf16_f32 v89, v58, v59
v_exp_f32 v64, v64
v_exp_f32 v65, v65
v_mfma_f32_16x16x32_bf16 v[172:175], v[176:179], v[96:99], v[172:175]
v_exp_f32 v66, v66
v_exp_f32 v67, v67
v_mfma_f32_32x32x16_bf16 v[120:135], v[44:47], v[100:103], v[120:135]
v_cvt_pk_bf16_f32 v90, v60, v61
v_cvt_pk_bf16_f32 v91, v62, v63
v_exp_f32 v68, v68
v_exp_f32 v69, v69
v_mfma_f32_16x16x32_bf16 v[172:175], v[176:179], v[100:103], v[172:175]
v_exp_f32 v70, v70
v_exp_f32 v71, v71
v_cvt_pk_bf16_f32 v92, v64, v65
v_cvt_pk_bf16_f32 v93, v66, v67
v_cvt_pk_bf16_f32 v94, v68, v69
v_cvt_pk_bf16_f32 v95, v70, v71
s_waitcnt lgkmcnt(0)
v_mfma_f32_32x32x16_bf16 v[56:71], v[24:27], v[8:11], v[136:151]
v_exp_f32 v72, v72
v_exp_f32 v73, v73
v_exp_f32 v74, v74
v_exp_f32 v75, v75
v_mfma_f32_32x32x16_bf16 v[56:71], v[28:31], v[12:15], v[56:71]
v_exp_f32 v76, v76
v_exp_f32 v77, v77
v_exp_f32 v78, v78
v_exp_f32 v79, v79
v_mfma_f32_32x32x16_bf16 v[104:119], v[48:51], v[88:91], v[104:119]
v_cvt_pk_bf16_f32 v96, v72, v73
v_cvt_pk_bf16_f32 v97, v74, v75
v_exp_f32 v80, v80
v_exp_f32 v81, v81
v_mfma_f32_16x16x32_bf16 v[168:171], v[176:179], v[88:91], v[168:171]
v_exp_f32 v82, v82
v_exp_f32 v83, v83
v_mfma_f32_32x32x16_bf16 v[104:119], v[52:55], v[92:95], v[104:119]
v_cvt_pk_bf16_f32 v98, v76, v77
v_cvt_pk_bf16_f32 v99, v78, v79
v_exp_f32 v84, v84
v_exp_f32 v85, v85
v_mfma_f32_16x16x32_bf16 v[168:171], v[176:179], v[92:95], v[168:171]
v_exp_f32 v86, v86
v_exp_f32 v87, v87
v_cvt_pk_bf16_f32 v100, v80, v81
v_cvt_pk_bf16_f32 v101, v82, v83
v_cvt_pk_bf16_f32 v102, v84, v85
v_cvt_pk_bf16_f32 v103, v86, v87
v_mfma_f32_32x32x16_bf16 v[72:87], v[24:27], v[16:19], v[152:167]
v_exp_f32 v56, v56
v_exp_f32 v57, v57
ds_read_b128 v[32:35], v2 offset:28672
ds_read_b128 v[36:39], v2 offset:29696
ds_read_b128 v[40:43], v2 offset:26624
ds_read_b128 v[44:47], v2 offset:27648
v_exp_f32 v58, v58
v_exp_f32 v59, v59
v_mfma_f32_32x32x16_bf16 v[72:87], v[28:31], v[20:23], v[72:87]
v_exp_f32 v60, v60
v_exp_f32 v61, v61
v_exp_f32 v62, v62
v_exp_f32 v63, v63
v_mfma_f32_32x32x16_bf16 v[120:135], v[48:51], v[96:99], v[120:135]
v_cvt_pk_bf16_f32 v88, v56, v57
v_cvt_pk_bf16_f32 v89, v58, v59
v_exp_f32 v64, v64
v_exp_f32 v65, v65
v_mfma_f32_16x16x32_bf16 v[172:175], v[176:179], v[96:99], v[172:175]
v_exp_f32 v66, v66
v_exp_f32 v67, v67
v_mfma_f32_32x32x16_bf16 v[120:135], v[52:55], v[100:103], v[120:135]
v_cvt_pk_bf16_f32 v90, v60, v61
v_cvt_pk_bf16_f32 v91, v62, v63
v_exp_f32 v68, v68
v_exp_f32 v69, v69
v_mfma_f32_16x16x32_bf16 v[172:175], v[176:179], v[100:103], v[172:175]
v_exp_f32 v70, v70
v_exp_f32 v71, v71
v_cvt_pk_bf16_f32 v92, v64, v65
v_cvt_pk_bf16_f32 v93, v66, v67
v_cvt_pk_bf16_f32 v94, v68, v69
v_cvt_pk_bf16_f32 v95, v70, v71
s_waitcnt lgkmcnt(0)
v_mfma_f32_32x32x16_bf16 v[56:71], v[32:35], v[8:11], v[136:151]
v_exp_f32 v72, v72
v_exp_f32 v73, v73
v_exp_f32 v74, v74
v_exp_f32 v75, v75
v_mfma_f32_32x32x16_bf16 v[56:71], v[36:39], v[12:15], v[56:71]
v_exp_f32 v76, v76
v_exp_f32 v77, v77
v_exp_f32 v78, v78
v_exp_f32 v79, v79
v_mfma_f32_32x32x16_bf16 v[104:119], v[40:43], v[88:91], v[104:119]
v_cvt_pk_bf16_f32 v96, v72, v73
v_cvt_pk_bf16_f32 v97, v74, v75
v_exp_f32 v80, v80
v_exp_f32 v81, v81
v_mfma_f32_16x16x32_bf16 v[168:171], v[176:179], v[88:91], v[168:171]
v_exp_f32 v82, v82
v_exp_f32 v83, v83
v_mfma_f32_32x32x16_bf16 v[104:119], v[44:47], v[92:95], v[104:119]
v_cvt_pk_bf16_f32 v98, v76, v77
v_cvt_pk_bf16_f32 v99, v78, v79
v_exp_f32 v84, v84
v_exp_f32 v85, v85
v_mfma_f32_16x16x32_bf16 v[168:171], v[176:179], v[92:95], v[168:171]
v_exp_f32 v86, v86
v_exp_f32 v87, v87
v_cvt_pk_bf16_f32 v100, v80, v81
v_cvt_pk_bf16_f32 v101, v82, v83
v_cvt_pk_bf16_f32 v102, v84, v85
v_cvt_pk_bf16_f32 v103, v86, v87
s_waitcnt vmcnt(4)
s_barrier
v_mfma_f32_32x32x16_bf16 v[72:87], v[32:35], v[16:19], v[152:167]
v_exp_f32 v56, v56
v_exp_f32 v57, v57
ds_read_b128 v[24:27], v2 offset:32768
ds_read_b128 v[28:31], v2 offset:33792
ds_read_b128 v[48:51], v2 offset:30720
ds_read_b128 v[52:55], v2 offset:31744
v_exp_f32 v58, v58
v_exp_f32 v59, v59
v_mfma_f32_32x32x16_bf16 v[72:87], v[36:39], v[20:23], v[72:87]
v_exp_f32 v60, v60
v_exp_f32 v61, v61
v_exp_f32 v62, v62
v_exp_f32 v63, v63
v_mfma_f32_32x32x16_bf16 v[120:135], v[40:43], v[96:99], v[120:135]
v_cvt_pk_bf16_f32 v88, v56, v57
v_cvt_pk_bf16_f32 v89, v58, v59
v_exp_f32 v64, v64
s_add_u32 m0, s16, 0
s_nop 0
buffer_load_dwordx4 v3, s[8:11], s15 offen offset:0 lds
buffer_load_dwordx4 v3, s[8:11], s15 offen offset:1024 lds
buffer_load_dwordx4 v3, s[8:11], s15 offen offset:2048 lds
buffer_load_dwordx4 v3, s[8:11], s15 offen offset:3072 lds
s_add_u32 s15, s15, 16384
v_exp_f32 v65, v65
v_mfma_f32_16x16x32_bf16 v[172:175], v[176:179], v[96:99], v[172:175]
v_exp_f32 v66, v66
v_exp_f32 v67, v67
v_mfma_f32_32x32x16_bf16 v[120:135], v[44:47], v[100:103], v[120:135]
v_cvt_pk_bf16_f32 v90, v60, v61
v_cvt_pk_bf16_f32 v91, v62, v63
v_exp_f32 v68, v68
v_exp_f32 v69, v69
v_mfma_f32_16x16x32_bf16 v[172:175], v[176:179], v[100:103], v[172:175]
v_exp_f32 v70, v70
v_exp_f32 v71, v71
v_cvt_pk_bf16_f32 v92, v64, v65
v_cvt_pk_bf16_f32 v93, v66, v67
v_cvt_pk_bf16_f32 v94, v68, v69
v_cvt_pk_bf16_f32 v95, v70, v71
s_waitcnt lgkmcnt(0)
v_mfma_f32_32x32x16_bf16 v[56:71], v[24:27], v[8:11], v[136:151]
v_exp_f32 v72, v72
v_exp_f32 v73, v73
v_exp_f32 v74, v74
v_exp_f32 v75, v75
v_mfma_f32_32x32x16_bf16 v[56:71], v[28:31], v[12:15], v[56:71]
v_exp_f32 v76, v76
v_exp_f32 v77, v77
v_exp_f32 v78, v78
v_exp_f32 v79, v79
v_mfma_f32_32x32x16_bf16 v[104:119], v[48:51], v[88:91], v[104:119]
v_cvt_pk_bf16_f32 v96, v72, v73
v_cvt_pk_bf16_f32 v97, v74, v75
v_exp_f32 v80, v80
v_exp_f32 v81, v81
v_mfma_f32_16x16x32_bf16 v[168:171], v[176:179], v[88:91], v[168:171]
v_exp_f32 v82, v82
v_exp_f32 v83, v83
v_mfma_f32_32x32x16_bf16 v[104:119], v[52:55], v[92:95], v[104:119]
v_cvt_pk_bf16_f32 v98, v76, v77
v_cvt_pk_bf16_f32 v99, v78, v79
v_exp_f32 v84, v84
v_exp_f32 v85, v85
v_mfma_f32_16x16x32_bf16 v[168:171], v[176:179], v[92:95], v[168:171]
v_exp_f32 v86, v86
v_exp_f32 v87, v87
v_cvt_pk_bf16_f32 v100, v80, v81
v_cvt_pk_bf16_f32 v101, v82, v83
v_cvt_pk_bf16_f32 v102, v84, v85
v_cvt_pk_bf16_f32 v103, v86, v87
v_mfma_f32_32x32x16_bf16 v[72:87], v[24:27], v[16:19], v[152:167]
v_exp_f32 v56, v56
v_exp_f32 v57, v57
ds_read_b128 v[32:35], v2 offset:36864
ds_read_b128 v[36:39], v2 offset:37888
ds_read_b128 v[40:43], v2 offset:34816
ds_read_b128 v[44:47], v2 offset:35840
v_exp_f32 v58, v58
v_exp_f32 v59, v59
v_mfma_f32_32x32x16_bf16 v[72:87], v[28:31], v[20:23], v[72:87]
v_exp_f32 v60, v60
v_exp_f32 v61, v61
v_exp_f32 v62, v62
v_exp_f32 v63, v63
v_mfma_f32_32x32x16_bf16 v[120:135], v[48:51], v[96:99], v[120:135]
v_cvt_pk_bf16_f32 v88, v56, v57
v_cvt_pk_bf16_f32 v89, v58, v59
v_exp_f32 v64, v64
v_exp_f32 v65, v65
v_mfma_f32_16x16x32_bf16 v[172:175], v[176:179], v[96:99], v[172:175]
v_exp_f32 v66, v66
v_exp_f32 v67, v67
v_mfma_f32_32x32x16_bf16 v[120:135], v[52:55], v[100:103], v[120:135]
v_cvt_pk_bf16_f32 v90, v60, v61
v_cvt_pk_bf16_f32 v91, v62, v63
v_exp_f32 v68, v68
v_exp_f32 v69, v69
v_mfma_f32_16x16x32_bf16 v[172:175], v[176:179], v[100:103], v[172:175]
v_exp_f32 v70, v70
v_exp_f32 v71, v71
v_cvt_pk_bf16_f32 v92, v64, v65
v_cvt_pk_bf16_f32 v93, v66, v67
v_cvt_pk_bf16_f32 v94, v68, v69
v_cvt_pk_bf16_f32 v95, v70, v71
s_waitcnt lgkmcnt(0)
v_mfma_f32_32x32x16_bf16 v[56:71], v[32:35], v[8:11], v[136:151]
v_exp_f32 v72, v72
v_exp_f32 v73, v73
v_exp_f32 v74, v74
v_exp_f32 v75, v75
v_mfma_f32_32x32x16_bf16 v[56:71], v[36:39], v[12:15], v[56:71]
v_exp_f32 v76, v76
v_exp_f32 v77, v77
v_exp_f32 v78, v78
v_exp_f32 v79, v79
v_mfma_f32_32x32x16_bf16 v[104:119], v[40:43], v[88:91], v[104:119]
v_cvt_pk_bf16_f32 v96, v72, v73
v_cvt_pk_bf16_f32 v97, v74, v75
v_exp_f32 v80, v80
v_exp_f32 v81, v81
v_mfma_f32_16x16x32_bf16 v[168:171], v[176:179], v[88:91], v[168:171]
v_exp_f32 v82, v82
v_exp_f32 v83, v83
v_mfma_f32_32x32x16_bf16 v[104:119], v[44:47], v[92:95], v[104:119]
v_cvt_pk_bf16_f32 v98, v76, v77
v_cvt_pk_bf16_f32 v99, v78, v79
v_exp_f32 v84, v84
v_exp_f32 v85, v85
v_mfma_f32_16x16x32_bf16 v[168:171], v[176:179], v[92:95], v[168:171]
v_exp_f32 v86, v86
v_exp_f32 v87, v87
v_cvt_pk_bf16_f32 v100, v80, v81
v_cvt_pk_bf16_f32 v101, v82, v83
v_cvt_pk_bf16_f32 v102, v84, v85
v_cvt_pk_bf16_f32 v103, v86, v87
v_mfma_f32_32x32x16_bf16 v[72:87], v[32:35], v[16:19], v[152:167]
v_exp_f32 v56, v56
v_exp_f32 v57, v57
ds_read_b128 v[24:27], v2 offset:40960
ds_read_b128 v[28:31], v2 offset:41984
ds_read_b128 v[48:51], v2 offset:38912
ds_read_b128 v[52:55], v2 offset:39936
v_exp_f32 v58, v58
v_exp_f32 v59, v59
v_mfma_f32_32x32x16_bf16 v[72:87], v[36:39], v[20:23], v[72:87]
v_exp_f32 v60, v60
v_exp_f32 v61, v61
v_exp_f32 v62, v62
v_exp_f32 v63, v63
v_mfma_f32_32x32x16_bf16 v[120:135], v[40:43], v[96:99], v[120:135]
v_cvt_pk_bf16_f32 v88, v56, v57
v_cvt_pk_bf16_f32 v89, v58, v59
v_exp_f32 v64, v64
v_exp_f32 v65, v65
v_mfma_f32_16x16x32_bf16 v[172:175], v[176:179], v[96:99], v[172:175]
v_exp_f32 v66, v66
v_exp_f32 v67, v67
v_mfma_f32_32x32x16_bf16 v[120:135], v[44:47], v[100:103], v[120:135]
v_cvt_pk_bf16_f32 v90, v60, v61
v_cvt_pk_bf16_f32 v91, v62, v63
v_exp_f32 v68, v68
v_exp_f32 v69, v69
v_mfma_f32_16x16x32_bf16 v[172:175], v[176:179], v[100:103], v[172:175]
v_exp_f32 v70, v70
v_exp_f32 v71, v71
v_cvt_pk_bf16_f32 v92, v64, v65
v_cvt_pk_bf16_f32 v93, v66, v67
v_cvt_pk_bf16_f32 v94, v68, v69
v_cvt_pk_bf16_f32 v95, v70, v71
s_waitcnt lgkmcnt(0)
v_mfma_f32_32x32x16_bf16 v[56:71], v[24:27], v[8:11], v[136:151]
v_exp_f32 v72, v72
v_exp_f32 v73, v73
v_exp_f32 v74, v74
v_exp_f32 v75, v75
v_mfma_f32_32x32x16_bf16 v[56:71], v[28:31], v[12:15], v[56:71]
v_exp_f32 v76, v76
v_exp_f32 v77, v77
v_exp_f32 v78, v78
v_exp_f32 v79, v79
v_mfma_f32_32x32x16_bf16 v[104:119], v[48:51], v[88:91], v[104:119]
v_cvt_pk_bf16_f32 v96, v72, v73
v_cvt_pk_bf16_f32 v97, v74, v75
v_exp_f32 v80, v80
v_exp_f32 v81, v81
v_mfma_f32_16x16x32_bf16 v[168:171], v[176:179], v[88:91], v[168:171]
v_exp_f32 v82, v82
v_exp_f32 v83, v83
v_mfma_f32_32x32x16_bf16 v[104:119], v[52:55], v[92:95], v[104:119]
v_cvt_pk_bf16_f32 v98, v76, v77
v_cvt_pk_bf16_f32 v99, v78, v79
v_exp_f32 v84, v84
v_exp_f32 v85, v85
v_mfma_f32_16x16x32_bf16 v[168:171], v[176:179], v[92:95], v[168:171]
v_exp_f32 v86, v86
v_exp_f32 v87, v87
v_cvt_pk_bf16_f32 v100, v80, v81
v_cvt_pk_bf16_f32 v101, v82, v83
v_cvt_pk_bf16_f32 v102, v84, v85
v_cvt_pk_bf16_f32 v103, v86, v87
v_mfma_f32_32x32x16_bf16 v[72:87], v[24:27], v[16:19], v[152:167]
v_exp_f32 v56, v56
v_exp_f32 v57, v57
ds_read_b128 v[32:35], v2 offset:45056
ds_read_b128 v[36:39], v2 offset:46080
ds_read_b128 v[40:43], v2 offset:43008
ds_read_b128 v[44:47], v2 offset:44032
v_exp_f32 v58, v58
v_exp_f32 v59, v59
v_mfma_f32_32x32x16_bf16 v[72:87], v[28:31], v[20:23], v[72:87]
v_exp_f32 v60, v60
v_exp_f32 v61, v61
v_exp_f32 v62, v62
v_exp_f32 v63, v63
v_mfma_f32_32x32x16_bf16 v[120:135], v[48:51], v[96:99], v[120:135]
v_cvt_pk_bf16_f32 v88, v56, v57
v_cvt_pk_bf16_f32 v89, v58, v59
v_exp_f32 v64, v64
v_exp_f32 v65, v65
v_mfma_f32_16x16x32_bf16 v[172:175], v[176:179], v[96:99], v[172:175]
v_exp_f32 v66, v66
v_exp_f32 v67, v67
v_mfma_f32_32x32x16_bf16 v[120:135], v[52:55], v[100:103], v[120:135]
v_cvt_pk_bf16_f32 v90, v60, v61
v_cvt_pk_bf16_f32 v91, v62, v63
v_exp_f32 v68, v68
v_exp_f32 v69, v69
v_mfma_f32_16x16x32_bf16 v[172:175], v[176:179], v[100:103], v[172:175]
v_exp_f32 v70, v70
v_exp_f32 v71, v71
v_cvt_pk_bf16_f32 v92, v64, v65
v_cvt_pk_bf16_f32 v93, v66, v67
v_cvt_pk_bf16_f32 v94, v68, v69
v_cvt_pk_bf16_f32 v95, v70, v71
s_waitcnt lgkmcnt(0)
v_mfma_f32_32x32x16_bf16 v[56:71], v[32:35], v[8:11], v[136:151]
v_exp_f32 v72, v72
v_exp_f32 v73, v73
v_exp_f32 v74, v74
v_exp_f32 v75, v75
v_mfma_f32_32x32x16_bf16 v[56:71], v[36:39], v[12:15], v[56:71]
v_exp_f32 v76, v76
v_exp_f32 v77, v77
v_exp_f32 v78, v78
v_exp_f32 v79, v79
v_mfma_f32_32x32x16_bf16 v[104:119], v[40:43], v[88:91], v[104:119]
v_cvt_pk_bf16_f32 v96, v72, v73
v_cvt_pk_bf16_f32 v97, v74, v75
v_exp_f32 v80, v80
v_exp_f32 v81, v81
v_mfma_f32_16x16x32_bf16 v[168:171], v[176:179], v[88:91], v[168:171]
v_exp_f32 v82, v82
v_exp_f32 v83, v83
v_mfma_f32_32x32x16_bf16 v[104:119], v[44:47], v[92:95], v[104:119]
v_cvt_pk_bf16_f32 v98, v76, v77
v_cvt_pk_bf16_f32 v99, v78, v79
v_exp_f32 v84, v84
v_exp_f32 v85, v85
v_mfma_f32_16x16x32_bf16 v[168:171], v[176:179], v[92:95], v[168:171]
v_exp_f32 v86, v86
v_exp_f32 v87, v87
v_cvt_pk_bf16_f32 v100, v80, v81
v_cvt_pk_bf16_f32 v101, v82, v83
v_cvt_pk_bf16_f32 v102, v84, v85
v_cvt_pk_bf16_f32 v103, v86, v87
s_waitcnt vmcnt(4)
s_barrier
v_mfma_f32_32x32x16_bf16 v[72:87], v[32:35], v[16:19], v[152:167]
v_exp_f32 v56, v56
v_exp_f32 v57, v57
ds_read_b128 v[24:27], v2 offset:49152
ds_read_b128 v[28:31], v2 offset:50176
ds_read_b128 v[48:51], v2 offset:47104
ds_read_b128 v[52:55], v2 offset:48128
v_exp_f32 v58, v58
v_exp_f32 v59, v59
v_mfma_f32_32x32x16_bf16 v[72:87], v[36:39], v[20:23], v[72:87]
v_exp_f32 v60, v60
v_exp_f32 v61, v61
v_exp_f32 v62, v62
v_exp_f32 v63, v63
v_mfma_f32_32x32x16_bf16 v[120:135], v[40:43], v[96:99], v[120:135]
v_cvt_pk_bf16_f32 v88, v56, v57
v_cvt_pk_bf16_f32 v89, v58, v59
v_exp_f32 v64, v64
s_add_u32 m0, s16, 16384
s_nop 0
buffer_load_dwordx4 v3, s[8:11], s15 offen offset:0 lds
buffer_load_dwordx4 v3, s[8:11], s15 offen offset:1024 lds
buffer_load_dwordx4 v3, s[8:11], s15 offen offset:2048 lds
buffer_load_dwordx4 v3, s[8:11], s15 offen offset:3072 lds
s_add_u32 s15, s15, 16384
v_exp_f32 v65, v65
v_mfma_f32_16x16x32_bf16 v[172:175], v[176:179], v[96:99], v[172:175]
v_exp_f32 v66, v66
v_exp_f32 v67, v67
v_mfma_f32_32x32x16_bf16 v[120:135], v[44:47], v[100:103], v[120:135]
v_cvt_pk_bf16_f32 v90, v60, v61
v_cvt_pk_bf16_f32 v91, v62, v63
v_exp_f32 v68, v68
v_exp_f32 v69, v69
v_mfma_f32_16x16x32_bf16 v[172:175], v[176:179], v[100:103], v[172:175]
v_exp_f32 v70, v70
v_exp_f32 v71, v71
v_cvt_pk_bf16_f32 v92, v64, v65
v_cvt_pk_bf16_f32 v93, v66, v67
v_cvt_pk_bf16_f32 v94, v68, v69
v_cvt_pk_bf16_f32 v95, v70, v71
s_waitcnt lgkmcnt(0)
v_mfma_f32_32x32x16_bf16 v[56:71], v[24:27], v[8:11], v[136:151]
v_exp_f32 v72, v72
v_exp_f32 v73, v73
v_exp_f32 v74, v74
v_exp_f32 v75, v75
v_mfma_f32_32x32x16_bf16 v[56:71], v[28:31], v[12:15], v[56:71]
v_exp_f32 v76, v76
v_exp_f32 v77, v77
v_exp_f32 v78, v78
v_exp_f32 v79, v79
v_mfma_f32_32x32x16_bf16 v[104:119], v[48:51], v[88:91], v[104:119]
v_cvt_pk_bf16_f32 v96, v72, v73
v_cvt_pk_bf16_f32 v97, v74, v75
v_exp_f32 v80, v80
v_exp_f32 v81, v81
v_mfma_f32_16x16x32_bf16 v[168:171], v[176:179], v[88:91], v[168:171]
v_exp_f32 v82, v82
v_exp_f32 v83, v83
v_mfma_f32_32x32x16_bf16 v[104:119], v[52:55], v[92:95], v[104:119]
v_cvt_pk_bf16_f32 v98, v76, v77
v_cvt_pk_bf16_f32 v99, v78, v79
v_exp_f32 v84, v84
v_exp_f32 v85, v85
v_mfma_f32_16x16x32_bf16 v[168:171], v[176:179], v[92:95], v[168:171]
v_exp_f32 v86, v86
v_exp_f32 v87, v87
v_cvt_pk_bf16_f32 v100, v80, v81
v_cvt_pk_bf16_f32 v101, v82, v83
v_cvt_pk_bf16_f32 v102, v84, v85
v_cvt_pk_bf16_f32 v103, v86, v87
v_mfma_f32_32x32x16_bf16 v[72:87], v[24:27], v[16:19], v[152:167]
v_exp_f32 v56, v56
v_exp_f32 v57, v57
ds_read_b128 v[32:35], v2 offset:53248
ds_read_b128 v[36:39], v2 offset:54272
ds_read_b128 v[40:43], v2 offset:51200
ds_read_b128 v[44:47], v2 offset:52224
v_exp_f32 v58, v58
v_exp_f32 v59, v59
v_mfma_f32_32x32x16_bf16 v[72:87], v[28:31], v[20:23], v[72:87]
v_exp_f32 v60, v60
v_exp_f32 v61, v61
v_exp_f32 v62, v62
v_exp_f32 v63, v63
v_mfma_f32_32x32x16_bf16 v[120:135], v[48:51], v[96:99], v[120:135]
v_cvt_pk_bf16_f32 v88, v56, v57
v_cvt_pk_bf16_f32 v89, v58, v59
v_exp_f32 v64, v64
v_exp_f32 v65, v65
v_mfma_f32_16x16x32_bf16 v[172:175], v[176:179], v[96:99], v[172:175]
v_exp_f32 v66, v66
v_exp_f32 v67, v67
v_mfma_f32_32x32x16_bf16 v[120:135], v[52:55], v[100:103], v[120:135]
v_cvt_pk_bf16_f32 v90, v60, v61
v_cvt_pk_bf16_f32 v91, v62, v63
v_exp_f32 v68, v68
v_exp_f32 v69, v69
v_mfma_f32_16x16x32_bf16 v[172:175], v[176:179], v[100:103], v[172:175]
v_exp_f32 v70, v70
v_exp_f32 v71, v71
v_cvt_pk_bf16_f32 v92, v64, v65
v_cvt_pk_bf16_f32 v93, v66, v67
v_cvt_pk_bf16_f32 v94, v68, v69
v_cvt_pk_bf16_f32 v95, v70, v71
s_waitcnt lgkmcnt(0)
v_mfma_f32_32x32x16_bf16 v[56:71], v[32:35], v[8:11], v[136:151]
v_exp_f32 v72, v72
v_exp_f32 v73, v73
v_exp_f32 v74, v74
v_exp_f32 v75, v75
v_mfma_f32_32x32x16_bf16 v[56:71], v[36:39], v[12:15], v[56:71]
v_exp_f32 v76, v76
v_exp_f32 v77, v77
v_exp_f32 v78, v78
v_exp_f32 v79, v79
v_mfma_f32_32x32x16_bf16 v[104:119], v[40:43], v[88:91], v[104:119]
v_cvt_pk_bf16_f32 v96, v72, v73
v_cvt_pk_bf16_f32 v97, v74, v75
v_exp_f32 v80, v80
v_exp_f32 v81, v81
v_mfma_f32_16x16x32_bf16 v[168:171], v[176:179], v[88:91], v[168:171]
v_exp_f32 v82, v82
v_exp_f32 v83, v83
v_mfma_f32_32x32x16_bf16 v[104:119], v[44:47], v[92:95], v[104:119]
v_cvt_pk_bf16_f32 v98, v76, v77
v_cvt_pk_bf16_f32 v99, v78, v79
v_exp_f32 v84, v84
v_exp_f32 v85, v85
v_mfma_f32_16x16x32_bf16 v[168:171], v[176:179], v[92:95], v[168:171]
v_exp_f32 v86, v86
v_exp_f32 v87, v87
v_cvt_pk_bf16_f32 v100, v80, v81
v_cvt_pk_bf16_f32 v101, v82, v83
v_cvt_pk_bf16_f32 v102, v84, v85
v_cvt_pk_bf16_f32 v103, v86, v87
v_mfma_f32_32x32x16_bf16 v[72:87], v[32:35], v[16:19], v[152:167]
v_exp_f32 v56, v56
v_exp_f32 v57, v57
ds_read_b128 v[24:27], v2 offset:57344
ds_read_b128 v[28:31], v2 offset:58368
ds_read_b128 v[48:51], v2 offset:55296
ds_read_b128 v[52:55], v2 offset:56320
v_exp_f32 v58, v58
v_exp_f32 v59, v59
v_mfma_f32_32x32x16_bf16 v[72:87], v[36:39], v[20:23], v[72:87]
v_exp_f32 v60, v60
v_exp_f32 v61, v61
v_exp_f32 v62, v62
v_exp_f32 v63, v63
v_mfma_f32_32x32x16_bf16 v[120:135], v[40:43], v[96:99], v[120:135]
v_cvt_pk_bf16_f32 v88, v56, v57
v_cvt_pk_bf16_f32 v89, v58, v59
v_exp_f32 v64, v64
v_exp_f32 v65, v65
v_mfma_f32_16x16x32_bf16 v[172:175], v[176:179], v[96:99], v[172:175]
v_exp_f32 v66, v66
v_exp_f32 v67, v67
v_mfma_f32_32x32x16_bf16 v[120:135], v[44:47], v[100:103], v[120:135]
v_cvt_pk_bf16_f32 v90, v60, v61
v_cvt_pk_bf16_f32 v91, v62, v63
v_exp_f32 v68, v68
v_exp_f32 v69, v69
v_mfma_f32_16x16x32_bf16 v[172:175], v[176:179], v[100:103], v[172:175]
v_exp_f32 v70, v70
v_exp_f32 v71, v71
v_cvt_pk_bf16_f32 v92, v64, v65
v_cvt_pk_bf16_f32 v93, v66, v67
v_cvt_pk_bf16_f32 v94, v68, v69
v_cvt_pk_bf16_f32 v95, v70, v71
s_waitcnt lgkmcnt(0)
v_mfma_f32_32x32x16_bf16 v[56:71], v[24:27], v[8:11], v[136:151]
v_exp_f32 v72, v72
v_exp_f32 v73, v73
v_exp_f32 v74, v74
v_exp_f32 v75, v75
v_mfma_f32_32x32x16_bf16 v[56:71], v[28:31], v[12:15], v[56:71]
v_exp_f32 v76, v76
v_exp_f32 v77, v77
v_exp_f32 v78, v78
v_exp_f32 v79, v79
v_mfma_f32_32x32x16_bf16 v[104:119], v[48:51], v[88:91], v[104:119]
v_cvt_pk_bf16_f32 v96, v72, v73
v_cvt_pk_bf16_f32 v97, v74, v75
v_exp_f32 v80, v80
v_exp_f32 v81, v81
v_mfma_f32_16x16x32_bf16 v[168:171], v[176:179], v[88:91], v[168:171]
v_exp_f32 v82, v82
v_exp_f32 v83, v83
v_mfma_f32_32x32x16_bf16 v[104:119], v[52:55], v[92:95], v[104:119]
v_cvt_pk_bf16_f32 v98, v76, v77
v_cvt_pk_bf16_f32 v99, v78, v79
v_exp_f32 v84, v84
v_exp_f32 v85, v85
v_mfma_f32_16x16x32_bf16 v[168:171], v[176:179], v[92:95], v[168:171]
v_exp_f32 v86, v86
v_exp_f32 v87, v87
v_cvt_pk_bf16_f32 v100, v80, v81
v_cvt_pk_bf16_f32 v101, v82, v83
v_cvt_pk_bf16_f32 v102, v84, v85
v_cvt_pk_bf16_f32 v103, v86, v87
v_mfma_f32_32x32x16_bf16 v[72:87], v[24:27], v[16:19], v[152:167]
v_exp_f32 v56, v56
v_exp_f32 v57, v57
ds_read_b128 v[32:35], v2 offset:61440
ds_read_b128 v[36:39], v2 offset:62464
ds_read_b128 v[40:43], v2 offset:59392
ds_read_b128 v[44:47], v2 offset:60416
v_exp_f32 v58, v58
v_exp_f32 v59, v59
v_mfma_f32_32x32x16_bf16 v[72:87], v[28:31], v[20:23], v[72:87]
v_exp_f32 v60, v60
v_exp_f32 v61, v61
v_exp_f32 v62, v62
v_exp_f32 v63, v63
v_mfma_f32_32x32x16_bf16 v[120:135], v[48:51], v[96:99], v[120:135]
v_cvt_pk_bf16_f32 v88, v56, v57
v_cvt_pk_bf16_f32 v89, v58, v59
v_exp_f32 v64, v64
v_exp_f32 v65, v65
v_mfma_f32_16x16x32_bf16 v[172:175], v[176:179], v[96:99], v[172:175]
v_exp_f32 v66, v66
v_exp_f32 v67, v67
v_mfma_f32_32x32x16_bf16 v[120:135], v[52:55], v[100:103], v[120:135]
v_cvt_pk_bf16_f32 v90, v60, v61
v_cvt_pk_bf16_f32 v91, v62, v63
v_exp_f32 v68, v68
v_exp_f32 v69, v69
v_mfma_f32_16x16x32_bf16 v[172:175], v[176:179], v[100:103], v[172:175]
v_exp_f32 v70, v70
v_exp_f32 v71, v71
v_cvt_pk_bf16_f32 v92, v64, v65
v_cvt_pk_bf16_f32 v93, v66, v67
v_cvt_pk_bf16_f32 v94, v68, v69
v_cvt_pk_bf16_f32 v95, v70, v71
s_waitcnt lgkmcnt(0)
v_mfma_f32_32x32x16_bf16 v[56:71], v[32:35], v[8:11], v[136:151]
v_exp_f32 v72, v72
v_exp_f32 v73, v73
v_exp_f32 v74, v74
v_exp_f32 v75, v75
v_mfma_f32_32x32x16_bf16 v[56:71], v[36:39], v[12:15], v[56:71]
v_exp_f32 v76, v76
v_exp_f32 v77, v77
v_exp_f32 v78, v78
v_exp_f32 v79, v79
v_mfma_f32_32x32x16_bf16 v[104:119], v[40:43], v[88:91], v[104:119]
v_cvt_pk_bf16_f32 v96, v72, v73
v_cvt_pk_bf16_f32 v97, v74, v75
v_exp_f32 v80, v80
v_exp_f32 v81, v81
v_mfma_f32_16x16x32_bf16 v[168:171], v[176:179], v[88:91], v[168:171]
v_exp_f32 v82, v82
v_exp_f32 v83, v83
v_mfma_f32_32x32x16_bf16 v[104:119], v[44:47], v[92:95], v[104:119]
v_cvt_pk_bf16_f32 v98, v76, v77
v_cvt_pk_bf16_f32 v99, v78, v79
v_exp_f32 v84, v84
v_exp_f32 v85, v85
v_mfma_f32_16x16x32_bf16 v[168:171], v[176:179], v[92:95], v[168:171]
v_exp_f32 v86, v86
v_exp_f32 v87, v87
v_cvt_pk_bf16_f32 v100, v80, v81
v_cvt_pk_bf16_f32 v101, v82, v83
v_cvt_pk_bf16_f32 v102, v84, v85
v_cvt_pk_bf16_f32 v103, v86, v87
s_waitcnt vmcnt(4)
s_barrier
v_mfma_f32_32x32x16_bf16 v[72:87], v[32:35], v[16:19], v[152:167]
v_exp_f32 v56, v56
v_exp_f32 v57, v57
ds_read_b128 v[24:27], v2 offset:0
ds_read_b128 v[28:31], v2 offset:1024
ds_read_b128 v[48:51], v2 offset:63488
ds_read_b128 v[52:55], v2 offset:64512
v_exp_f32 v58, v58
v_exp_f32 v59, v59
v_mfma_f32_32x32x16_bf16 v[72:87], v[36:39], v[20:23], v[72:87]
v_exp_f32 v60, v60
v_exp_f32 v61, v61
v_exp_f32 v62, v62
v_exp_f32 v63, v63
v_mfma_f32_32x32x16_bf16 v[120:135], v[40:43], v[96:99], v[120:135]
v_cvt_pk_bf16_f32 v88, v56, v57
v_cvt_pk_bf16_f32 v89, v58, v59
v_exp_f32 v64, v64
s_add_u32 m0, s16, 32768
s_nop 0
buffer_load_dwordx4 v3, s[8:11], s15 offen offset:0 lds
buffer_load_dwordx4 v3, s[8:11], s15 offen offset:1024 lds
buffer_load_dwordx4 v3, s[8:11], s15 offen offset:2048 lds
buffer_load_dwordx4 v3, s[8:11], s15 offen offset:3072 lds
s_add_u32 s15, s15, 16384
v_exp_f32 v65, v65
v_mfma_f32_16x16x32_bf16 v[172:175], v[176:179], v[96:99], v[172:175]
v_exp_f32 v66, v66
v_exp_f32 v67, v67
v_mfma_f32_32x32x16_bf16 v[120:135], v[44:47], v[100:103], v[120:135]
v_cvt_pk_bf16_f32 v90, v60, v61
v_cvt_pk_bf16_f32 v91, v62, v63
v_exp_f32 v68, v68
v_exp_f32 v69, v69
v_mfma_f32_16x16x32_bf16 v[172:175], v[176:179], v[100:103], v[172:175]
v_exp_f32 v70, v70
v_exp_f32 v71, v71
v_cvt_pk_bf16_f32 v92, v64, v65
v_cvt_pk_bf16_f32 v93, v66, v67
v_cvt_pk_bf16_f32 v94, v68, v69
v_cvt_pk_bf16_f32 v95, v70, v71
s_waitcnt lgkmcnt(0)
v_mfma_f32_32x32x16_bf16 v[56:71], v[24:27], v[8:11], v[136:151]
v_exp_f32 v72, v72
v_exp_f32 v73, v73
v_exp_f32 v74, v74
v_exp_f32 v75, v75
v_mfma_f32_32x32x16_bf16 v[56:71], v[28:31], v[12:15], v[56:71]
v_exp_f32 v76, v76
v_exp_f32 v77, v77
v_exp_f32 v78, v78
v_exp_f32 v79, v79
v_mfma_f32_32x32x16_bf16 v[104:119], v[48:51], v[88:91], v[104:119]
v_cvt_pk_bf16_f32 v96, v72, v73
v_cvt_pk_bf16_f32 v97, v74, v75
v_exp_f32 v80, v80
v_exp_f32 v81, v81
v_mfma_f32_16x16x32_bf16 v[168:171], v[176:179], v[88:91], v[168:171]
v_exp_f32 v82, v82
v_exp_f32 v83, v83
v_mfma_f32_32x32x16_bf16 v[104:119], v[52:55], v[92:95], v[104:119]
v_cvt_pk_bf16_f32 v98, v76, v77
v_cvt_pk_bf16_f32 v99, v78, v79
v_exp_f32 v84, v84
v_exp_f32 v85, v85
v_mfma_f32_16x16x32_bf16 v[168:171], v[176:179], v[92:95], v[168:171]
v_exp_f32 v86, v86
v_exp_f32 v87, v87
v_cvt_pk_bf16_f32 v100, v80, v81
v_cvt_pk_bf16_f32 v101, v82, v83
v_cvt_pk_bf16_f32 v102, v84, v85
v_cvt_pk_bf16_f32 v103, v86, v87
v_mfma_f32_32x32x16_bf16 v[72:87], v[24:27], v[16:19], v[152:167]
v_exp_f32 v56, v56
v_exp_f32 v57, v57
ds_read_b128 v[32:35], v2 offset:4096
ds_read_b128 v[36:39], v2 offset:5120
ds_read_b128 v[40:43], v2 offset:2048
ds_read_b128 v[44:47], v2 offset:3072
v_exp_f32 v58, v58
v_exp_f32 v59, v59
v_mfma_f32_32x32x16_bf16 v[72:87], v[28:31], v[20:23], v[72:87]
v_exp_f32 v60, v60
v_exp_f32 v61, v61
v_exp_f32 v62, v62
v_exp_f32 v63, v63
v_mfma_f32_32x32x16_bf16 v[120:135], v[48:51], v[96:99], v[120:135]
v_cvt_pk_bf16_f32 v88, v56, v57
v_cvt_pk_bf16_f32 v89, v58, v59
v_exp_f32 v64, v64
v_exp_f32 v65, v65
v_mfma_f32_16x16x32_bf16 v[172:175], v[176:179], v[96:99], v[172:175]
v_exp_f32 v66, v66
v_exp_f32 v67, v67
v_mfma_f32_32x32x16_bf16 v[120:135], v[52:55], v[100:103], v[120:135]
v_cvt_pk_bf16_f32 v90, v60, v61
v_cvt_pk_bf16_f32 v91, v62, v63
v_exp_f32 v68, v68
v_exp_f32 v69, v69
v_mfma_f32_16x16x32_bf16 v[172:175], v[176:179], v[100:103], v[172:175]
v_exp_f32 v70, v70
v_exp_f32 v71, v71
v_cvt_pk_bf16_f32 v92, v64, v65
v_cvt_pk_bf16_f32 v93, v66, v67
v_cvt_pk_bf16_f32 v94, v68, v69
v_cvt_pk_bf16_f32 v95, v70, v71
s_waitcnt lgkmcnt(0)
v_mfma_f32_32x32x16_bf16 v[56:71], v[32:35], v[8:11], v[136:151]
v_exp_f32 v72, v72
v_exp_f32 v73, v73
v_exp_f32 v74, v74
v_exp_f32 v75, v75
v_mfma_f32_32x32x16_bf16 v[56:71], v[36:39], v[12:15], v[56:71]
v_exp_f32 v76, v76
v_exp_f32 v77, v77
v_exp_f32 v78, v78
v_exp_f32 v79, v79
v_mfma_f32_32x32x16_bf16 v[104:119], v[40:43], v[88:91], v[104:119]
v_cvt_pk_bf16_f32 v96, v72, v73
v_cvt_pk_bf16_f32 v97, v74, v75
v_exp_f32 v80, v80
v_exp_f32 v81, v81
v_mfma_f32_16x16x32_bf16 v[168:171], v[176:179], v[88:91], v[168:171]
v_exp_f32 v82, v82
v_exp_f32 v83, v83
v_mfma_f32_32x32x16_bf16 v[104:119], v[44:47], v[92:95], v[104:119]
v_cvt_pk_bf16_f32 v98, v76, v77
v_cvt_pk_bf16_f32 v99, v78, v79
v_exp_f32 v84, v84
v_exp_f32 v85, v85
v_mfma_f32_16x16x32_bf16 v[168:171], v[176:179], v[92:95], v[168:171]
v_exp_f32 v86, v86
v_exp_f32 v87, v87
v_cvt_pk_bf16_f32 v100, v80, v81
v_cvt_pk_bf16_f32 v101, v82, v83
v_cvt_pk_bf16_f32 v102, v84, v85
v_cvt_pk_bf16_f32 v103, v86, v87
v_mfma_f32_32x32x16_bf16 v[72:87], v[32:35], v[16:19], v[152:167]
v_exp_f32 v56, v56
v_exp_f32 v57, v57
ds_read_b128 v[24:27], v2 offset:8192
ds_read_b128 v[28:31], v2 offset:9216
ds_read_b128 v[48:51], v2 offset:6144
ds_read_b128 v[52:55], v2 offset:7168
v_exp_f32 v58, v58
v_exp_f32 v59, v59
v_mfma_f32_32x32x16_bf16 v[72:87], v[36:39], v[20:23], v[72:87]
v_exp_f32 v60, v60
v_exp_f32 v61, v61
v_exp_f32 v62, v62
v_exp_f32 v63, v63
v_mfma_f32_32x32x16_bf16 v[120:135], v[40:43], v[96:99], v[120:135]
v_cvt_pk_bf16_f32 v88, v56, v57
v_cvt_pk_bf16_f32 v89, v58, v59
v_exp_f32 v64, v64
v_exp_f32 v65, v65
v_mfma_f32_16x16x32_bf16 v[172:175], v[176:179], v[96:99], v[172:175]
v_exp_f32 v66, v66
v_exp_f32 v67, v67
v_mfma_f32_32x32x16_bf16 v[120:135], v[44:47], v[100:103], v[120:135]
v_cvt_pk_bf16_f32 v90, v60, v61
v_cvt_pk_bf16_f32 v91, v62, v63
v_exp_f32 v68, v68
v_exp_f32 v69, v69
v_mfma_f32_16x16x32_bf16 v[172:175], v[176:179], v[100:103], v[172:175]
v_exp_f32 v70, v70
v_exp_f32 v71, v71
v_cvt_pk_bf16_f32 v92, v64, v65
v_cvt_pk_bf16_f32 v93, v66, v67
v_cvt_pk_bf16_f32 v94, v68, v69
v_cvt_pk_bf16_f32 v95, v70, v71
s_waitcnt lgkmcnt(0)
v_mfma_f32_32x32x16_bf16 v[56:71], v[24:27], v[8:11], v[136:151]
v_exp_f32 v72, v72
v_exp_f32 v73, v73
v_exp_f32 v74, v74
v_exp_f32 v75, v75
v_mfma_f32_32x32x16_bf16 v[56:71], v[28:31], v[12:15], v[56:71]
v_exp_f32 v76, v76
v_exp_f32 v77, v77
v_exp_f32 v78, v78
v_exp_f32 v79, v79
v_mfma_f32_32x32x16_bf16 v[104:119], v[48:51], v[88:91], v[104:119]
v_cvt_pk_bf16_f32 v96, v72, v73
v_cvt_pk_bf16_f32 v97, v74, v75
v_exp_f32 v80, v80
v_exp_f32 v81, v81
v_mfma_f32_16x16x32_bf16 v[168:171], v[176:179], v[88:91], v[168:171]
v_exp_f32 v82, v82
v_exp_f32 v83, v83
v_mfma_f32_32x32x16_bf16 v[104:119], v[52:55], v[92:95], v[104:119]
v_cvt_pk_bf16_f32 v98, v76, v77
v_cvt_pk_bf16_f32 v99, v78, v79
v_exp_f32 v84, v84
v_exp_f32 v85, v85
v_mfma_f32_16x16x32_bf16 v[168:171], v[176:179], v[92:95], v[168:171]
v_exp_f32 v86, v86
v_exp_f32 v87, v87
v_cvt_pk_bf16_f32 v100, v80, v81
v_cvt_pk_bf16_f32 v101, v82, v83
v_cvt_pk_bf16_f32 v102, v84, v85
v_cvt_pk_bf16_f32 v103, v86, v87
v_mfma_f32_32x32x16_bf16 v[72:87], v[24:27], v[16:19], v[152:167]
v_exp_f32 v56, v56
v_exp_f32 v57, v57
ds_read_b128 v[32:35], v2 offset:12288
ds_read_b128 v[36:39], v2 offset:13312
ds_read_b128 v[40:43], v2 offset:10240
ds_read_b128 v[44:47], v2 offset:11264
v_exp_f32 v58, v58
v_exp_f32 v59, v59
v_mfma_f32_32x32x16_bf16 v[72:87], v[28:31], v[20:23], v[72:87]
v_exp_f32 v60, v60
v_exp_f32 v61, v61
v_exp_f32 v62, v62
v_exp_f32 v63, v63
v_mfma_f32_32x32x16_bf16 v[120:135], v[48:51], v[96:99], v[120:135]
v_cvt_pk_bf16_f32 v88, v56, v57
v_cvt_pk_bf16_f32 v89, v58, v59
v_exp_f32 v64, v64
v_exp_f32 v65, v65
v_mfma_f32_16x16x32_bf16 v[172:175], v[176:179], v[96:99], v[172:175]
v_exp_f32 v66, v66
v_exp_f32 v67, v67
v_mfma_f32_32x32x16_bf16 v[120:135], v[52:55], v[100:103], v[120:135]
v_cvt_pk_bf16_f32 v90, v60, v61
v_cvt_pk_bf16_f32 v91, v62, v63
v_exp_f32 v68, v68
v_exp_f32 v69, v69
v_mfma_f32_16x16x32_bf16 v[172:175], v[176:179], v[100:103], v[172:175]
v_exp_f32 v70, v70
v_exp_f32 v71, v71
v_cvt_pk_bf16_f32 v92, v64, v65
v_cvt_pk_bf16_f32 v93, v66, v67
v_cvt_pk_bf16_f32 v94, v68, v69
v_cvt_pk_bf16_f32 v95, v70, v71
s_waitcnt lgkmcnt(0)
v_mfma_f32_32x32x16_bf16 v[56:71], v[32:35], v[8:11], v[136:151]
v_exp_f32 v72, v72
v_exp_f32 v73, v73
v_exp_f32 v74, v74
v_exp_f32 v75, v75
v_mfma_f32_32x32x16_bf16 v[56:71], v[36:39], v[12:15], v[56:71]
v_exp_f32 v76, v76
v_exp_f32 v77, v77
v_exp_f32 v78, v78
v_exp_f32 v79, v79
v_mfma_f32_32x32x16_bf16 v[104:119], v[40:43], v[88:91], v[104:119]
v_cvt_pk_bf16_f32 v96, v72, v73
v_cvt_pk_bf16_f32 v97, v74, v75
v_exp_f32 v80, v80
v_exp_f32 v81, v81
v_mfma_f32_16x16x32_bf16 v[168:171], v[176:179], v[88:91], v[168:171]
v_exp_f32 v82, v82
v_exp_f32 v83, v83
v_mfma_f32_32x32x16_bf16 v[104:119], v[44:47], v[92:95], v[104:119]
v_cvt_pk_bf16_f32 v98, v76, v77
v_cvt_pk_bf16_f32 v99, v78, v79
v_exp_f32 v84, v84
v_exp_f32 v85, v85
v_mfma_f32_16x16x32_bf16 v[168:171], v[176:179], v[92:95], v[168:171]
v_exp_f32 v86, v86
v_exp_f32 v87, v87
v_cvt_pk_bf16_f32 v100, v80, v81
v_cvt_pk_bf16_f32 v101, v82, v83
v_cvt_pk_bf16_f32 v102, v84, v85
v_cvt_pk_bf16_f32 v103, v86, v87
s_waitcnt vmcnt(4)
s_barrier
v_mfma_f32_32x32x16_bf16 v[72:87], v[32:35], v[16:19], v[152:167]
v_exp_f32 v56, v56
v_exp_f32 v57, v57
ds_read_b128 v[24:27], v2 offset:16384
ds_read_b128 v[28:31], v2 offset:17408
ds_read_b128 v[48:51], v2 offset:14336
ds_read_b128 v[52:55], v2 offset:15360
v_exp_f32 v58, v58
v_exp_f32 v59, v59
v_mfma_f32_32x32x16_bf16 v[72:87], v[36:39], v[20:23], v[72:87]
v_exp_f32 v60, v60
v_exp_f32 v61, v61
v_exp_f32 v62, v62
v_exp_f32 v63, v63
v_mfma_f32_32x32x16_bf16 v[120:135], v[40:43], v[96:99], v[120:135]
v_cvt_pk_bf16_f32 v88, v56, v57
v_cvt_pk_bf16_f32 v89, v58, v59
v_exp_f32 v64, v64
s_add_u32 m0, s16, 49152
s_nop 0
buffer_load_dwordx4 v3, s[8:11], s15 offen offset:0 lds
buffer_load_dwordx4 v3, s[8:11], s15 offen offset:1024 lds
buffer_load_dwordx4 v3, s[8:11], s15 offen offset:2048 lds
buffer_load_dwordx4 v3, s[8:11], s15 offen offset:3072 lds
s_add_u32 s15, s15, 16384
v_exp_f32 v65, v65
v_mfma_f32_16x16x32_bf16 v[172:175], v[176:179], v[96:99], v[172:175]
v_exp_f32 v66, v66
v_exp_f32 v67, v67
v_mfma_f32_32x32x16_bf16 v[120:135], v[44:47], v[100:103], v[120:135]
v_cvt_pk_bf16_f32 v90, v60, v61
v_cvt_pk_bf16_f32 v91, v62, v63
v_exp_f32 v68, v68
v_exp_f32 v69, v69
v_mfma_f32_16x16x32_bf16 v[172:175], v[176:179], v[100:103], v[172:175]
v_exp_f32 v70, v70
v_exp_f32 v71, v71
v_cvt_pk_bf16_f32 v92, v64, v65
v_cvt_pk_bf16_f32 v93, v66, v67
v_cvt_pk_bf16_f32 v94, v68, v69
v_cvt_pk_bf16_f32 v95, v70, v71
s_waitcnt lgkmcnt(0)
v_mfma_f32_32x32x16_bf16 v[56:71], v[24:27], v[8:11], v[136:151]
v_exp_f32 v72, v72
v_exp_f32 v73, v73
v_exp_f32 v74, v74
v_exp_f32 v75, v75
v_mfma_f32_32x32x16_bf16 v[56:71], v[28:31], v[12:15], v[56:71]
v_exp_f32 v76, v76
v_exp_f32 v77, v77
v_exp_f32 v78, v78
v_exp_f32 v79, v79
v_mfma_f32_32x32x16_bf16 v[104:119], v[48:51], v[88:91], v[104:119]
v_cvt_pk_bf16_f32 v96, v72, v73
v_cvt_pk_bf16_f32 v97, v74, v75
v_exp_f32 v80, v80
v_exp_f32 v81, v81
v_mfma_f32_16x16x32_bf16 v[168:171], v[176:179], v[88:91], v[168:171]
v_exp_f32 v82, v82
v_exp_f32 v83, v83
v_mfma_f32_32x32x16_bf16 v[104:119], v[52:55], v[92:95], v[104:119]
v_cvt_pk_bf16_f32 v98, v76, v77
v_cvt_pk_bf16_f32 v99, v78, v79
v_exp_f32 v84, v84
v_exp_f32 v85, v85
v_mfma_f32_16x16x32_bf16 v[168:171], v[176:179], v[92:95], v[168:171]
v_exp_f32 v86, v86
v_exp_f32 v87, v87
v_cvt_pk_bf16_f32 v100, v80, v81
v_cvt_pk_bf16_f32 v101, v82, v83
v_cvt_pk_bf16_f32 v102, v84, v85
v_cvt_pk_bf16_f32 v103, v86, v87
v_mfma_f32_32x32x16_bf16 v[72:87], v[24:27], v[16:19], v[152:167]
v_exp_f32 v56, v56
v_exp_f32 v57, v57
ds_read_b128 v[32:35], v2 offset:20480
ds_read_b128 v[36:39], v2 offset:21504
ds_read_b128 v[40:43], v2 offset:18432
ds_read_b128 v[44:47], v2 offset:19456
v_exp_f32 v58, v58
v_exp_f32 v59, v59
v_mfma_f32_32x32x16_bf16 v[72:87], v[28:31], v[20:23], v[72:87]
v_exp_f32 v60, v60
v_exp_f32 v61, v61
v_exp_f32 v62, v62
v_exp_f32 v63, v63
v_mfma_f32_32x32x16_bf16 v[120:135], v[48:51], v[96:99], v[120:135]
v_cvt_pk_bf16_f32 v88, v56, v57
v_cvt_pk_bf16_f32 v89, v58, v59
v_exp_f32 v64, v64
v_exp_f32 v65, v65
v_mfma_f32_16x16x32_bf16 v[172:175], v[176:179], v[96:99], v[172:175]
v_exp_f32 v66, v66
v_exp_f32 v67, v67
v_mfma_f32_32x32x16_bf16 v[120:135], v[52:55], v[100:103], v[120:135]
v_cvt_pk_bf16_f32 v90, v60, v61
v_cvt_pk_bf16_f32 v91, v62, v63
v_exp_f32 v68, v68
v_exp_f32 v69, v69
v_mfma_f32_16x16x32_bf16 v[172:175], v[176:179], v[100:103], v[172:175]
v_exp_f32 v70, v70
v_exp_f32 v71, v71
v_cvt_pk_bf16_f32 v92, v64, v65
v_cvt_pk_bf16_f32 v93, v66, v67
v_cvt_pk_bf16_f32 v94, v68, v69
v_cvt_pk_bf16_f32 v95, v70, v71
s_waitcnt lgkmcnt(0)
v_mfma_f32_32x32x16_bf16 v[56:71], v[32:35], v[8:11], v[136:151]
v_exp_f32 v72, v72
v_exp_f32 v73, v73
v_exp_f32 v74, v74
v_exp_f32 v75, v75
v_mfma_f32_32x32x16_bf16 v[56:71], v[36:39], v[12:15], v[56:71]
v_exp_f32 v76, v76
v_exp_f32 v77, v77
v_exp_f32 v78, v78
v_exp_f32 v79, v79
v_mfma_f32_32x32x16_bf16 v[104:119], v[40:43], v[88:91], v[104:119]
v_cvt_pk_bf16_f32 v96, v72, v73
v_cvt_pk_bf16_f32 v97, v74, v75
v_exp_f32 v80, v80
v_exp_f32 v81, v81
v_mfma_f32_16x16x32_bf16 v[168:171], v[176:179], v[88:91], v[168:171]
v_exp_f32 v82, v82
v_exp_f32 v83, v83
v_mfma_f32_32x32x16_bf16 v[104:119], v[44:47], v[92:95], v[104:119]
v_cvt_pk_bf16_f32 v98, v76, v77
v_cvt_pk_bf16_f32 v99, v78, v79
v_exp_f32 v84, v84
v_exp_f32 v85, v85
v_mfma_f32_16x16x32_bf16 v[168:171], v[176:179], v[92:95], v[168:171]
v_exp_f32 v86, v86
v_exp_f32 v87, v87
v_cvt_pk_bf16_f32 v100, v80, v81
v_cvt_pk_bf16_f32 v101, v82, v83
v_cvt_pk_bf16_f32 v102, v84, v85
v_cvt_pk_bf16_f32 v103, v86, v87
v_mfma_f32_32x32x16_bf16 v[72:87], v[32:35], v[16:19], v[152:167]
v_exp_f32 v56, v56
v_exp_f32 v57, v57
ds_read_b128 v[24:27], v2 offset:24576
ds_read_b128 v[28:31], v2 offset:25600
ds_read_b128 v[48:51], v2 offset:22528
ds_read_b128 v[52:55], v2 offset:23552
v_exp_f32 v58, v58
v_exp_f32 v59, v59
v_mfma_f32_32x32x16_bf16 v[72:87], v[36:39], v[20:23], v[72:87]
v_exp_f32 v60, v60
v_exp_f32 v61, v61
v_exp_f32 v62, v62
v_exp_f32 v63, v63
v_mfma_f32_32x32x16_bf16 v[120:135], v[40:43], v[96:99], v[120:135]
v_cvt_pk_bf16_f32 v88, v56, v57
v_cvt_pk_bf16_f32 v89, v58, v59
v_exp_f32 v64, v64
v_exp_f32 v65, v65
v_mfma_f32_16x16x32_bf16 v[172:175], v[176:179], v[96:99], v[172:175]
v_exp_f32 v66, v66
v_exp_f32 v67, v67
v_mfma_f32_32x32x16_bf16 v[120:135], v[44:47], v[100:103], v[120:135]
v_cvt_pk_bf16_f32 v90, v60, v61
v_cvt_pk_bf16_f32 v91, v62, v63
v_exp_f32 v68, v68
v_exp_f32 v69, v69
v_mfma_f32_16x16x32_bf16 v[172:175], v[176:179], v[100:103], v[172:175]
v_exp_f32 v70, v70
v_exp_f32 v71, v71
v_cvt_pk_bf16_f32 v92, v64, v65
v_cvt_pk_bf16_f32 v93, v66, v67
v_cvt_pk_bf16_f32 v94, v68, v69
v_cvt_pk_bf16_f32 v95, v70, v71
s_waitcnt lgkmcnt(0)
v_mfma_f32_32x32x16_bf16 v[56:71], v[24:27], v[8:11], v[136:151]
v_exp_f32 v72, v72
v_exp_f32 v73, v73
v_exp_f32 v74, v74
v_exp_f32 v75, v75
v_mfma_f32_32x32x16_bf16 v[56:71], v[28:31], v[12:15], v[56:71]
v_exp_f32 v76, v76
v_exp_f32 v77, v77
v_exp_f32 v78, v78
v_exp_f32 v79, v79
v_mfma_f32_32x32x16_bf16 v[104:119], v[48:51], v[88:91], v[104:119]
v_cvt_pk_bf16_f32 v96, v72, v73
v_cvt_pk_bf16_f32 v97, v74, v75
v_exp_f32 v80, v80
v_exp_f32 v81, v81
v_mfma_f32_16x16x32_bf16 v[168:171], v[176:179], v[88:91], v[168:171]
v_exp_f32 v82, v82
v_exp_f32 v83, v83
v_mfma_f32_32x32x16_bf16 v[104:119], v[52:55], v[92:95], v[104:119]
v_cvt_pk_bf16_f32 v98, v76, v77
v_cvt_pk_bf16_f32 v99, v78, v79
v_exp_f32 v84, v84
v_exp_f32 v85, v85
v_mfma_f32_16x16x32_bf16 v[168:171], v[176:179], v[92:95], v[168:171]
v_exp_f32 v86, v86
v_exp_f32 v87, v87
v_cvt_pk_bf16_f32 v100, v80, v81
v_cvt_pk_bf16_f32 v101, v82, v83
v_cvt_pk_bf16_f32 v102, v84, v85
v_cvt_pk_bf16_f32 v103, v86, v87
v_mfma_f32_32x32x16_bf16 v[72:87], v[24:27], v[16:19], v[152:167]
v_exp_f32 v56, v56
v_exp_f32 v57, v57
ds_read_b128 v[32:35], v2 offset:28672
ds_read_b128 v[36:39], v2 offset:29696
ds_read_b128 v[40:43], v2 offset:26624
ds_read_b128 v[44:47], v2 offset:27648
v_exp_f32 v58, v58
v_exp_f32 v59, v59
v_mfma_f32_32x32x16_bf16 v[72:87], v[28:31], v[20:23], v[72:87]
v_exp_f32 v60, v60
v_exp_f32 v61, v61
v_exp_f32 v62, v62
v_exp_f32 v63, v63
v_mfma_f32_32x32x16_bf16 v[120:135], v[48:51], v[96:99], v[120:135]
v_cvt_pk_bf16_f32 v88, v56, v57
v_cvt_pk_bf16_f32 v89, v58, v59
v_exp_f32 v64, v64
v_exp_f32 v65, v65
v_mfma_f32_16x16x32_bf16 v[172:175], v[176:179], v[96:99], v[172:175]
v_exp_f32 v66, v66
v_exp_f32 v67, v67
v_mfma_f32_32x32x16_bf16 v[120:135], v[52:55], v[100:103], v[120:135]
v_cvt_pk_bf16_f32 v90, v60, v61
v_cvt_pk_bf16_f32 v91, v62, v63
v_exp_f32 v68, v68
v_exp_f32 v69, v69
v_mfma_f32_16x16x32_bf16 v[172:175], v[176:179], v[100:103], v[172:175]
v_exp_f32 v70, v70
v_exp_f32 v71, v71
v_cvt_pk_bf16_f32 v92, v64, v65
v_cvt_pk_bf16_f32 v93, v66, v67
v_cvt_pk_bf16_f32 v94, v68, v69
v_cvt_pk_bf16_f32 v95, v70, v71
s_waitcnt lgkmcnt(0)
v_mfma_f32_32x32x16_bf16 v[56:71], v[32:35], v[8:11], v[136:151]
v_exp_f32 v72, v72
v_exp_f32 v73, v73
v_exp_f32 v74, v74
v_exp_f32 v75, v75
v_mfma_f32_32x32x16_bf16 v[56:71], v[36:39], v[12:15], v[56:71]
v_exp_f32 v76, v76
v_exp_f32 v77, v77
v_exp_f32 v78, v78
v_exp_f32 v79, v79
v_mfma_f32_32x32x16_bf16 v[104:119], v[40:43], v[88:91], v[104:119]
v_cvt_pk_bf16_f32 v96, v72, v73
v_cvt_pk_bf16_f32 v97, v74, v75
v_exp_f32 v80, v80
v_exp_f32 v81, v81
v_mfma_f32_16x16x32_bf16 v[168:171], v[176:179], v[88:91], v[168:171]
v_exp_f32 v82, v82
v_exp_f32 v83, v83
v_mfma_f32_32x32x16_bf16 v[104:119], v[44:47], v[92:95], v[104:119]
v_cvt_pk_bf16_f32 v98, v76, v77
v_cvt_pk_bf16_f32 v99, v78, v79
v_exp_f32 v84, v84
v_exp_f32 v85, v85
v_mfma_f32_16x16x32_bf16 v[168:171], v[176:179], v[92:95], v[168:171]
v_exp_f32 v86, v86
v_exp_f32 v87, v87
v_cvt_pk_bf16_f32 v100, v80, v81
v_cvt_pk_bf16_f32 v101, v82, v83
v_cvt_pk_bf16_f32 v102, v84, v85
v_cvt_pk_bf16_f32 v103, v86, v87
s_waitcnt vmcnt(4)
s_barrier
v_mfma_f32_32x32x16_bf16 v[72:87], v[32:35], v[16:19], v[152:167]
v_exp_f32 v56, v56
v_exp_f32 v57, v57
ds_read_b128 v[24:27], v2 offset:32768
ds_read_b128 v[28:31], v2 offset:33792
ds_read_b128 v[48:51], v2 offset:30720
ds_read_b128 v[52:55], v2 offset:31744
v_exp_f32 v58, v58
v_exp_f32 v59, v59
v_mfma_f32_32x32x16_bf16 v[72:87], v[36:39], v[20:23], v[72:87]
v_exp_f32 v60, v60
v_exp_f32 v61, v61
v_exp_f32 v62, v62
v_exp_f32 v63, v63
v_mfma_f32_32x32x16_bf16 v[120:135], v[40:43], v[96:99], v[120:135]
v_cvt_pk_bf16_f32 v88, v56, v57
v_cvt_pk_bf16_f32 v89, v58, v59
v_exp_f32 v64, v64
s_add_u32 m0, s16, 0
s_nop 0
buffer_load_dwordx4 v3, s[8:11], s15 offen offset:0 lds
buffer_load_dwordx4 v3, s[8:11], s15 offen offset:1024 lds
buffer_load_dwordx4 v3, s[8:11], s15 offen offset:2048 lds
buffer_load_dwordx4 v3, s[8:11], s15 offen offset:3072 lds
s_add_u32 s15, s15, 16384
v_exp_f32 v65, v65
v_mfma_f32_16x16x32_bf16 v[172:175], v[176:179], v[96:99], v[172:175]
v_exp_f32 v66, v66
v_exp_f32 v67, v67
v_mfma_f32_32x32x16_bf16 v[120:135], v[44:47], v[100:103], v[120:135]
v_cvt_pk_bf16_f32 v90, v60, v61
v_cvt_pk_bf16_f32 v91, v62, v63
v_exp_f32 v68, v68
v_exp_f32 v69, v69
v_mfma_f32_16x16x32_bf16 v[172:175], v[176:179], v[100:103], v[172:175]
v_exp_f32 v70, v70
v_exp_f32 v71, v71
v_cvt_pk_bf16_f32 v92, v64, v65
v_cvt_pk_bf16_f32 v93, v66, v67
v_cvt_pk_bf16_f32 v94, v68, v69
v_cvt_pk_bf16_f32 v95, v70, v71
s_waitcnt lgkmcnt(0)
v_mfma_f32_32x32x16_bf16 v[56:71], v[24:27], v[8:11], v[136:151]
v_exp_f32 v72, v72
v_exp_f32 v73, v73
v_exp_f32 v74, v74
v_exp_f32 v75, v75
v_mfma_f32_32x32x16_bf16 v[56:71], v[28:31], v[12:15], v[56:71]
v_exp_f32 v76, v76
v_exp_f32 v77, v77
v_exp_f32 v78, v78
v_exp_f32 v79, v79
v_mfma_f32_32x32x16_bf16 v[104:119], v[48:51], v[88:91], v[104:119]
v_cvt_pk_bf16_f32 v96, v72, v73
v_cvt_pk_bf16_f32 v97, v74, v75
v_exp_f32 v80, v80
v_exp_f32 v81, v81
v_mfma_f32_16x16x32_bf16 v[168:171], v[176:179], v[88:91], v[168:171]
v_exp_f32 v82, v82
v_exp_f32 v83, v83
v_mfma_f32_32x32x16_bf16 v[104:119], v[52:55], v[92:95], v[104:119]
v_cvt_pk_bf16_f32 v98, v76, v77
v_cvt_pk_bf16_f32 v99, v78, v79
v_exp_f32 v84, v84
v_exp_f32 v85, v85
v_mfma_f32_16x16x32_bf16 v[168:171], v[176:179], v[92:95], v[168:171]
v_exp_f32 v86, v86
v_exp_f32 v87, v87
v_cvt_pk_bf16_f32 v100, v80, v81
v_cvt_pk_bf16_f32 v101, v82, v83
v_cvt_pk_bf16_f32 v102, v84, v85
v_cvt_pk_bf16_f32 v103, v86, v87
v_mfma_f32_32x32x16_bf16 v[72:87], v[24:27], v[16:19], v[152:167]
v_exp_f32 v56, v56
v_exp_f32 v57, v57
ds_read_b128 v[32:35], v2 offset:36864
ds_read_b128 v[36:39], v2 offset:37888
ds_read_b128 v[40:43], v2 offset:34816
ds_read_b128 v[44:47], v2 offset:35840
v_exp_f32 v58, v58
v_exp_f32 v59, v59
v_mfma_f32_32x32x16_bf16 v[72:87], v[28:31], v[20:23], v[72:87]
v_exp_f32 v60, v60
v_exp_f32 v61, v61
v_exp_f32 v62, v62
v_exp_f32 v63, v63
v_mfma_f32_32x32x16_bf16 v[120:135], v[48:51], v[96:99], v[120:135]
v_cvt_pk_bf16_f32 v88, v56, v57
v_cvt_pk_bf16_f32 v89, v58, v59
v_exp_f32 v64, v64
v_exp_f32 v65, v65
v_mfma_f32_16x16x32_bf16 v[172:175], v[176:179], v[96:99], v[172:175]
v_exp_f32 v66, v66
v_exp_f32 v67, v67
v_mfma_f32_32x32x16_bf16 v[120:135], v[52:55], v[100:103], v[120:135]
v_cvt_pk_bf16_f32 v90, v60, v61
v_cvt_pk_bf16_f32 v91, v62, v63
v_exp_f32 v68, v68
v_exp_f32 v69, v69
v_mfma_f32_16x16x32_bf16 v[172:175], v[176:179], v[100:103], v[172:175]
v_exp_f32 v70, v70
v_exp_f32 v71, v71
v_cvt_pk_bf16_f32 v92, v64, v65
v_cvt_pk_bf16_f32 v93, v66, v67
v_cvt_pk_bf16_f32 v94, v68, v69
v_cvt_pk_bf16_f32 v95, v70, v71
s_waitcnt lgkmcnt(0)
v_mfma_f32_32x32x16_bf16 v[56:71], v[32:35], v[8:11], v[136:151]
v_exp_f32 v72, v72
v_exp_f32 v73, v73
v_exp_f32 v74, v74
v_exp_f32 v75, v75
v_mfma_f32_32x32x16_bf16 v[56:71], v[36:39], v[12:15], v[56:71]
v_exp_f32 v76, v76
v_exp_f32 v77, v77
v_exp_f32 v78, v78
v_exp_f32 v79, v79
v_mfma_f32_32x32x16_bf16 v[104:119], v[40:43], v[88:91], v[104:119]
v_cvt_pk_bf16_f32 v96, v72, v73
v_cvt_pk_bf16_f32 v97, v74, v75
v_exp_f32 v80, v80
v_exp_f32 v81, v81
v_mfma_f32_16x16x32_bf16 v[168:171], v[176:179], v[88:91], v[168:171]
v_exp_f32 v82, v82
v_exp_f32 v83, v83
v_mfma_f32_32x32x16_bf16 v[104:119], v[44:47], v[92:95], v[104:119]
v_cvt_pk_bf16_f32 v98, v76, v77
v_cvt_pk_bf16_f32 v99, v78, v79
v_exp_f32 v84, v84
v_exp_f32 v85, v85
v_mfma_f32_16x16x32_bf16 v[168:171], v[176:179], v[92:95], v[168:171]
v_exp_f32 v86, v86
v_exp_f32 v87, v87
v_cvt_pk_bf16_f32 v100, v80, v81
v_cvt_pk_bf16_f32 v101, v82, v83
v_cvt_pk_bf16_f32 v102, v84, v85
v_cvt_pk_bf16_f32 v103, v86, v87
v_mfma_f32_32x32x16_bf16 v[72:87], v[32:35], v[16:19], v[152:167]
v_exp_f32 v56, v56
v_exp_f32 v57, v57
ds_read_b128 v[24:27], v2 offset:40960
ds_read_b128 v[28:31], v2 offset:41984
ds_read_b128 v[48:51], v2 offset:38912
ds_read_b128 v[52:55], v2 offset:39936
v_exp_f32 v58, v58
v_exp_f32 v59, v59
v_mfma_f32_32x32x16_bf16 v[72:87], v[36:39], v[20:23], v[72:87]
v_exp_f32 v60, v60
v_exp_f32 v61, v61
v_exp_f32 v62, v62
v_exp_f32 v63, v63
v_mfma_f32_32x32x16_bf16 v[120:135], v[40:43], v[96:99], v[120:135]
v_cvt_pk_bf16_f32 v88, v56, v57
v_cvt_pk_bf16_f32 v89, v58, v59
v_exp_f32 v64, v64
v_exp_f32 v65, v65
v_mfma_f32_16x16x32_bf16 v[172:175], v[176:179], v[96:99], v[172:175]
v_exp_f32 v66, v66
v_exp_f32 v67, v67
v_mfma_f32_32x32x16_bf16 v[120:135], v[44:47], v[100:103], v[120:135]
v_cvt_pk_bf16_f32 v90, v60, v61
v_cvt_pk_bf16_f32 v91, v62, v63
v_exp_f32 v68, v68
v_exp_f32 v69, v69
v_mfma_f32_16x16x32_bf16 v[172:175], v[176:179], v[100:103], v[172:175]
v_exp_f32 v70, v70
v_exp_f32 v71, v71
v_cvt_pk_bf16_f32 v92, v64, v65
v_cvt_pk_bf16_f32 v93, v66, v67
v_cvt_pk_bf16_f32 v94, v68, v69
v_cvt_pk_bf16_f32 v95, v70, v71
s_waitcnt lgkmcnt(0)
v_mfma_f32_32x32x16_bf16 v[56:71], v[24:27], v[8:11], v[136:151]
v_exp_f32 v72, v72
v_exp_f32 v73, v73
v_exp_f32 v74, v74
v_exp_f32 v75, v75
v_mfma_f32_32x32x16_bf16 v[56:71], v[28:31], v[12:15], v[56:71]
v_exp_f32 v76, v76
v_exp_f32 v77, v77
v_exp_f32 v78, v78
v_exp_f32 v79, v79
v_mfma_f32_32x32x16_bf16 v[104:119], v[48:51], v[88:91], v[104:119]
v_cvt_pk_bf16_f32 v96, v72, v73
v_cvt_pk_bf16_f32 v97, v74, v75
v_exp_f32 v80, v80
v_exp_f32 v81, v81
v_mfma_f32_16x16x32_bf16 v[168:171], v[176:179], v[88:91], v[168:171]
v_exp_f32 v82, v82
v_exp_f32 v83, v83
v_mfma_f32_32x32x16_bf16 v[104:119], v[52:55], v[92:95], v[104:119]
v_cvt_pk_bf16_f32 v98, v76, v77
v_cvt_pk_bf16_f32 v99, v78, v79
v_exp_f32 v84, v84
v_exp_f32 v85, v85
v_mfma_f32_16x16x32_bf16 v[168:171], v[176:179], v[92:95], v[168:171]
v_exp_f32 v86, v86
v_exp_f32 v87, v87
v_cvt_pk_bf16_f32 v100, v80, v81
v_cvt_pk_bf16_f32 v101, v82, v83
v_cvt_pk_bf16_f32 v102, v84, v85
v_cvt_pk_bf16_f32 v103, v86, v87
v_mfma_f32_32x32x16_bf16 v[72:87], v[24:27], v[16:19], v[152:167]
v_exp_f32 v56, v56
v_exp_f32 v57, v57
ds_read_b128 v[32:35], v2 offset:45056
ds_read_b128 v[36:39], v2 offset:46080
ds_read_b128 v[40:43], v2 offset:43008
ds_read_b128 v[44:47], v2 offset:44032
v_exp_f32 v58, v58
v_exp_f32 v59, v59
v_mfma_f32_32x32x16_bf16 v[72:87], v[28:31], v[20:23], v[72:87]
v_exp_f32 v60, v60
v_exp_f32 v61, v61
v_exp_f32 v62, v62
v_exp_f32 v63, v63
v_mfma_f32_32x32x16_bf16 v[120:135], v[48:51], v[96:99], v[120:135]
v_cvt_pk_bf16_f32 v88, v56, v57
v_cvt_pk_bf16_f32 v89, v58, v59
v_exp_f32 v64, v64
v_exp_f32 v65, v65
v_mfma_f32_16x16x32_bf16 v[172:175], v[176:179], v[96:99], v[172:175]
v_exp_f32 v66, v66
v_exp_f32 v67, v67
v_mfma_f32_32x32x16_bf16 v[120:135], v[52:55], v[100:103], v[120:135]
v_cvt_pk_bf16_f32 v90, v60, v61
v_cvt_pk_bf16_f32 v91, v62, v63
v_exp_f32 v68, v68
v_exp_f32 v69, v69
v_mfma_f32_16x16x32_bf16 v[172:175], v[176:179], v[100:103], v[172:175]
v_exp_f32 v70, v70
v_exp_f32 v71, v71
v_cvt_pk_bf16_f32 v92, v64, v65
v_cvt_pk_bf16_f32 v93, v66, v67
v_cvt_pk_bf16_f32 v94, v68, v69
v_cvt_pk_bf16_f32 v95, v70, v71
s_waitcnt lgkmcnt(0)
v_mfma_f32_32x32x16_bf16 v[56:71], v[32:35], v[8:11], v[136:151]
v_exp_f32 v72, v72
v_exp_f32 v73, v73
v_exp_f32 v74, v74
v_exp_f32 v75, v75
v_mfma_f32_32x32x16_bf16 v[56:71], v[36:39], v[12:15], v[56:71]
v_exp_f32 v76, v76
v_exp_f32 v77, v77
v_exp_f32 v78, v78
v_exp_f32 v79, v79
v_mfma_f32_32x32x16_bf16 v[104:119], v[40:43], v[88:91], v[104:119]
v_cvt_pk_bf16_f32 v96, v72, v73
v_cvt_pk_bf16_f32 v97, v74, v75
v_exp_f32 v80, v80
v_exp_f32 v81, v81
v_mfma_f32_16x16x32_bf16 v[168:171], v[176:179], v[88:91], v[168:171]
v_exp_f32 v82, v82
v_exp_f32 v83, v83
v_mfma_f32_32x32x16_bf16 v[104:119], v[44:47], v[92:95], v[104:119]
v_cvt_pk_bf16_f32 v98, v76, v77
v_cvt_pk_bf16_f32 v99, v78, v79
v_exp_f32 v84, v84
v_exp_f32 v85, v85
v_mfma_f32_16x16x32_bf16 v[168:171], v[176:179], v[92:95], v[168:171]
v_exp_f32 v86, v86
v_exp_f32 v87, v87
v_cvt_pk_bf16_f32 v100, v80, v81
v_cvt_pk_bf16_f32 v101, v82, v83
v_cvt_pk_bf16_f32 v102, v84, v85
v_cvt_pk_bf16_f32 v103, v86, v87
s_waitcnt vmcnt(4)
s_barrier
v_mfma_f32_32x32x16_bf16 v[72:87], v[32:35], v[16:19], v[152:167]
v_exp_f32 v56, v56
v_exp_f32 v57, v57
ds_read_b128 v[24:27], v2 offset:49152
ds_read_b128 v[28:31], v2 offset:50176
ds_read_b128 v[48:51], v2 offset:47104
ds_read_b128 v[52:55], v2 offset:48128
v_exp_f32 v58, v58
v_exp_f32 v59, v59
v_mfma_f32_32x32x16_bf16 v[72:87], v[36:39], v[20:23], v[72:87]
v_exp_f32 v60, v60
v_exp_f32 v61, v61
v_exp_f32 v62, v62
v_exp_f32 v63, v63
v_mfma_f32_32x32x16_bf16 v[120:135], v[40:43], v[96:99], v[120:135]
v_cvt_pk_bf16_f32 v88, v56, v57
v_cvt_pk_bf16_f32 v89, v58, v59
v_exp_f32 v64, v64
s_add_u32 m0, s16, 16384
s_nop 0
buffer_load_dwordx4 v3, s[8:11], s15 offen offset:0 lds
buffer_load_dwordx4 v3, s[8:11], s15 offen offset:1024 lds
buffer_load_dwordx4 v3, s[8:11], s15 offen offset:2048 lds
buffer_load_dwordx4 v3, s[8:11], s15 offen offset:3072 lds
s_add_u32 s15, s15, 16384
v_exp_f32 v65, v65
v_mfma_f32_16x16x32_bf16 v[172:175], v[176:179], v[96:99], v[172:175]
v_exp_f32 v66, v66
v_exp_f32 v67, v67
v_mfma_f32_32x32x16_bf16 v[120:135], v[44:47], v[100:103], v[120:135]
v_cvt_pk_bf16_f32 v90, v60, v61
v_cvt_pk_bf16_f32 v91, v62, v63
v_exp_f32 v68, v68
v_exp_f32 v69, v69
v_mfma_f32_16x16x32_bf16 v[172:175], v[176:179], v[100:103], v[172:175]
v_exp_f32 v70, v70
v_exp_f32 v71, v71
v_cvt_pk_bf16_f32 v92, v64, v65
v_cvt_pk_bf16_f32 v93, v66, v67
v_cvt_pk_bf16_f32 v94, v68, v69
v_cvt_pk_bf16_f32 v95, v70, v71
s_waitcnt lgkmcnt(0)
v_mfma_f32_32x32x16_bf16 v[56:71], v[24:27], v[8:11], v[136:151]
v_exp_f32 v72, v72
v_exp_f32 v73, v73
v_exp_f32 v74, v74
v_exp_f32 v75, v75
v_mfma_f32_32x32x16_bf16 v[56:71], v[28:31], v[12:15], v[56:71]
v_exp_f32 v76, v76
v_exp_f32 v77, v77
v_exp_f32 v78, v78
v_exp_f32 v79, v79
v_mfma_f32_32x32x16_bf16 v[104:119], v[48:51], v[88:91], v[104:119]
v_cvt_pk_bf16_f32 v96, v72, v73
v_cvt_pk_bf16_f32 v97, v74, v75
v_exp_f32 v80, v80
v_exp_f32 v81, v81
v_mfma_f32_16x16x32_bf16 v[168:171], v[176:179], v[88:91], v[168:171]
v_exp_f32 v82, v82
v_exp_f32 v83, v83
v_mfma_f32_32x32x16_bf16 v[104:119], v[52:55], v[92:95], v[104:119]
v_cvt_pk_bf16_f32 v98, v76, v77
v_cvt_pk_bf16_f32 v99, v78, v79
v_exp_f32 v84, v84
v_exp_f32 v85, v85
v_mfma_f32_16x16x32_bf16 v[168:171], v[176:179], v[92:95], v[168:171]
v_exp_f32 v86, v86
v_exp_f32 v87, v87
v_cvt_pk_bf16_f32 v100, v80, v81
v_cvt_pk_bf16_f32 v101, v82, v83
v_cvt_pk_bf16_f32 v102, v84, v85
v_cvt_pk_bf16_f32 v103, v86, v87
v_mfma_f32_32x32x16_bf16 v[72:87], v[24:27], v[16:19], v[152:167]
v_exp_f32 v56, v56
v_exp_f32 v57, v57
ds_read_b128 v[32:35], v2 offset:53248
ds_read_b128 v[36:39], v2 offset:54272
ds_read_b128 v[40:43], v2 offset:51200
ds_read_b128 v[44:47], v2 offset:52224
v_exp_f32 v58, v58
v_exp_f32 v59, v59
v_mfma_f32_32x32x16_bf16 v[72:87], v[28:31], v[20:23], v[72:87]
v_exp_f32 v60, v60
v_exp_f32 v61, v61
v_exp_f32 v62, v62
v_exp_f32 v63, v63
v_mfma_f32_32x32x16_bf16 v[120:135], v[48:51], v[96:99], v[120:135]
v_cvt_pk_bf16_f32 v88, v56, v57
v_cvt_pk_bf16_f32 v89, v58, v59
v_exp_f32 v64, v64
v_exp_f32 v65, v65
v_mfma_f32_16x16x32_bf16 v[172:175], v[176:179], v[96:99], v[172:175]
v_exp_f32 v66, v66
v_exp_f32 v67, v67
v_mfma_f32_32x32x16_bf16 v[120:135], v[52:55], v[100:103], v[120:135]
v_cvt_pk_bf16_f32 v90, v60, v61
v_cvt_pk_bf16_f32 v91, v62, v63
v_exp_f32 v68, v68
v_exp_f32 v69, v69
v_mfma_f32_16x16x32_bf16 v[172:175], v[176:179], v[100:103], v[172:175]
v_exp_f32 v70, v70
v_exp_f32 v71, v71
v_cvt_pk_bf16_f32 v92, v64, v65
v_cvt_pk_bf16_f32 v93, v66, v67
v_cvt_pk_bf16_f32 v94, v68, v69
v_cvt_pk_bf16_f32 v95, v70, v71
s_waitcnt lgkmcnt(0)
v_mfma_f32_32x32x16_bf16 v[56:71], v[32:35], v[8:11], v[136:151]
v_exp_f32 v72, v72
v_exp_f32 v73, v73
v_exp_f32 v74, v74
v_exp_f32 v75, v75
v_mfma_f32_32x32x16_bf16 v[56:71], v[36:39], v[12:15], v[56:71]
v_exp_f32 v76, v76
v_exp_f32 v77, v77
v_exp_f32 v78, v78
v_exp_f32 v79, v79
v_mfma_f32_32x32x16_bf16 v[104:119], v[40:43], v[88:91], v[104:119]
v_cvt_pk_bf16_f32 v96, v72, v73
v_cvt_pk_bf16_f32 v97, v74, v75
v_exp_f32 v80, v80
v_exp_f32 v81, v81
v_mfma_f32_16x16x32_bf16 v[168:171], v[176:179], v[88:91], v[168:171]
v_exp_f32 v82, v82
v_exp_f32 v83, v83
v_mfma_f32_32x32x16_bf16 v[104:119], v[44:47], v[92:95], v[104:119]
v_cvt_pk_bf16_f32 v98, v76, v77
v_cvt_pk_bf16_f32 v99, v78, v79
v_exp_f32 v84, v84
v_exp_f32 v85, v85
v_mfma_f32_16x16x32_bf16 v[168:171], v[176:179], v[92:95], v[168:171]
v_exp_f32 v86, v86
v_exp_f32 v87, v87
v_cvt_pk_bf16_f32 v100, v80, v81
v_cvt_pk_bf16_f32 v101, v82, v83
v_cvt_pk_bf16_f32 v102, v84, v85
v_cvt_pk_bf16_f32 v103, v86, v87
v_mfma_f32_32x32x16_bf16 v[72:87], v[32:35], v[16:19], v[152:167]
v_exp_f32 v56, v56
v_exp_f32 v57, v57
ds_read_b128 v[24:27], v2 offset:57344
ds_read_b128 v[28:31], v2 offset:58368
ds_read_b128 v[48:51], v2 offset:55296
ds_read_b128 v[52:55], v2 offset:56320
v_exp_f32 v58, v58
v_exp_f32 v59, v59
v_mfma_f32_32x32x16_bf16 v[72:87], v[36:39], v[20:23], v[72:87]
v_exp_f32 v60, v60
v_exp_f32 v61, v61
v_exp_f32 v62, v62
v_exp_f32 v63, v63
v_mfma_f32_32x32x16_bf16 v[120:135], v[40:43], v[96:99], v[120:135]
v_cvt_pk_bf16_f32 v88, v56, v57
v_cvt_pk_bf16_f32 v89, v58, v59
v_exp_f32 v64, v64
v_exp_f32 v65, v65
v_mfma_f32_16x16x32_bf16 v[172:175], v[176:179], v[96:99], v[172:175]
v_exp_f32 v66, v66
v_exp_f32 v67, v67
v_mfma_f32_32x32x16_bf16 v[120:135], v[44:47], v[100:103], v[120:135]
v_cvt_pk_bf16_f32 v90, v60, v61
v_cvt_pk_bf16_f32 v91, v62, v63
v_exp_f32 v68, v68
v_exp_f32 v69, v69
v_mfma_f32_16x16x32_bf16 v[172:175], v[176:179], v[100:103], v[172:175]
v_exp_f32 v70, v70
v_exp_f32 v71, v71
v_cvt_pk_bf16_f32 v92, v64, v65
v_cvt_pk_bf16_f32 v93, v66, v67
v_cvt_pk_bf16_f32 v94, v68, v69
v_cvt_pk_bf16_f32 v95, v70, v71
s_waitcnt lgkmcnt(0)
v_mfma_f32_32x32x16_bf16 v[56:71], v[24:27], v[8:11], v[136:151]
v_exp_f32 v72, v72
v_exp_f32 v73, v73
v_exp_f32 v74, v74
v_exp_f32 v75, v75
v_mfma_f32_32x32x16_bf16 v[56:71], v[28:31], v[12:15], v[56:71]
v_exp_f32 v76, v76
v_exp_f32 v77, v77
v_exp_f32 v78, v78
v_exp_f32 v79, v79
v_mfma_f32_32x32x16_bf16 v[104:119], v[48:51], v[88:91], v[104:119]
v_cvt_pk_bf16_f32 v96, v72, v73
v_cvt_pk_bf16_f32 v97, v74, v75
v_exp_f32 v80, v80
v_exp_f32 v81, v81
v_mfma_f32_16x16x32_bf16 v[168:171], v[176:179], v[88:91], v[168:171]
v_exp_f32 v82, v82
v_exp_f32 v83, v83
v_mfma_f32_32x32x16_bf16 v[104:119], v[52:55], v[92:95], v[104:119]
v_cvt_pk_bf16_f32 v98, v76, v77
v_cvt_pk_bf16_f32 v99, v78, v79
v_exp_f32 v84, v84
v_exp_f32 v85, v85
v_mfma_f32_16x16x32_bf16 v[168:171], v[176:179], v[92:95], v[168:171]
v_exp_f32 v86, v86
v_exp_f32 v87, v87
v_cvt_pk_bf16_f32 v100, v80, v81
v_cvt_pk_bf16_f32 v101, v82, v83
v_cvt_pk_bf16_f32 v102, v84, v85
v_cvt_pk_bf16_f32 v103, v86, v87
v_mfma_f32_32x32x16_bf16 v[72:87], v[24:27], v[16:19], v[152:167]
v_exp_f32 v56, v56
v_exp_f32 v57, v57
ds_read_b128 v[32:35], v2 offset:61440
ds_read_b128 v[36:39], v2 offset:62464
ds_read_b128 v[40:43], v2 offset:59392
ds_read_b128 v[44:47], v2 offset:60416
v_exp_f32 v58, v58
v_exp_f32 v59, v59
v_mfma_f32_32x32x16_bf16 v[72:87], v[28:31], v[20:23], v[72:87]
v_exp_f32 v60, v60
v_exp_f32 v61, v61
v_exp_f32 v62, v62
v_exp_f32 v63, v63
v_mfma_f32_32x32x16_bf16 v[120:135], v[48:51], v[96:99], v[120:135]
v_cvt_pk_bf16_f32 v88, v56, v57
v_cvt_pk_bf16_f32 v89, v58, v59
v_exp_f32 v64, v64
v_exp_f32 v65, v65
v_mfma_f32_16x16x32_bf16 v[172:175], v[176:179], v[96:99], v[172:175]
v_exp_f32 v66, v66
v_exp_f32 v67, v67
v_mfma_f32_32x32x16_bf16 v[120:135], v[52:55], v[100:103], v[120:135]
v_cvt_pk_bf16_f32 v90, v60, v61
v_cvt_pk_bf16_f32 v91, v62, v63
v_exp_f32 v68, v68
v_exp_f32 v69, v69
v_mfma_f32_16x16x32_bf16 v[172:175], v[176:179], v[100:103], v[172:175]
v_exp_f32 v70, v70
v_exp_f32 v71, v71
v_cvt_pk_bf16_f32 v92, v64, v65
v_cvt_pk_bf16_f32 v93, v66, v67
v_cvt_pk_bf16_f32 v94, v68, v69
v_cvt_pk_bf16_f32 v95, v70, v71
s_waitcnt lgkmcnt(0)
v_mfma_f32_32x32x16_bf16 v[56:71], v[32:35], v[8:11], v[136:151]
v_exp_f32 v72, v72
v_exp_f32 v73, v73
v_exp_f32 v74, v74
v_exp_f32 v75, v75
v_mfma_f32_32x32x16_bf16 v[56:71], v[36:39], v[12:15], v[56:71]
v_exp_f32 v76, v76
v_exp_f32 v77, v77
v_exp_f32 v78, v78
v_exp_f32 v79, v79
v_mfma_f32_32x32x16_bf16 v[104:119], v[40:43], v[88:91], v[104:119]
v_cvt_pk_bf16_f32 v96, v72, v73
v_cvt_pk_bf16_f32 v97, v74, v75
v_exp_f32 v80, v80
v_exp_f32 v81, v81
v_mfma_f32_16x16x32_bf16 v[168:171], v[176:179], v[88:91], v[168:171]
v_exp_f32 v82, v82
v_exp_f32 v83, v83
v_mfma_f32_32x32x16_bf16 v[104:119], v[44:47], v[92:95], v[104:119]
v_cvt_pk_bf16_f32 v98, v76, v77
v_cvt_pk_bf16_f32 v99, v78, v79
v_exp_f32 v84, v84
v_exp_f32 v85, v85
v_mfma_f32_16x16x32_bf16 v[168:171], v[176:179], v[92:95], v[168:171]
v_exp_f32 v86, v86
v_exp_f32 v87, v87
v_cvt_pk_bf16_f32 v100, v80, v81
v_cvt_pk_bf16_f32 v101, v82, v83
v_cvt_pk_bf16_f32 v102, v84, v85
v_cvt_pk_bf16_f32 v103, v86, v87
s_waitcnt vmcnt(4)
s_barrier
v_mfma_f32_32x32x16_bf16 v[72:87], v[32:35], v[16:19], v[152:167]
v_exp_f32 v56, v56
v_exp_f32 v57, v57
ds_read_b128 v[24:27], v2 offset:0
ds_read_b128 v[28:31], v2 offset:1024
ds_read_b128 v[48:51], v2 offset:63488
ds_read_b128 v[52:55], v2 offset:64512
v_exp_f32 v58, v58
v_exp_f32 v59, v59
v_mfma_f32_32x32x16_bf16 v[72:87], v[36:39], v[20:23], v[72:87]
v_exp_f32 v60, v60
v_exp_f32 v61, v61
v_exp_f32 v62, v62
v_exp_f32 v63, v63
v_mfma_f32_32x32x16_bf16 v[120:135], v[40:43], v[96:99], v[120:135]
v_cvt_pk_bf16_f32 v88, v56, v57
v_cvt_pk_bf16_f32 v89, v58, v59
v_exp_f32 v64, v64
s_add_u32 m0, s16, 32768
s_nop 0
buffer_load_dwordx4 v3, s[8:11], s15 offen offset:0 lds
buffer_load_dwordx4 v3, s[8:11], s15 offen offset:1024 lds
buffer_load_dwordx4 v3, s[8:11], s15 offen offset:2048 lds
buffer_load_dwordx4 v3, s[8:11], s15 offen offset:3072 lds
s_add_u32 s15, s15, 16384
v_exp_f32 v65, v65
v_mfma_f32_16x16x32_bf16 v[172:175], v[176:179], v[96:99], v[172:175]
v_exp_f32 v66, v66
v_exp_f32 v67, v67
v_mfma_f32_32x32x16_bf16 v[120:135], v[44:47], v[100:103], v[120:135]
v_cvt_pk_bf16_f32 v90, v60, v61
v_cvt_pk_bf16_f32 v91, v62, v63
v_exp_f32 v68, v68
v_exp_f32 v69, v69
v_mfma_f32_16x16x32_bf16 v[172:175], v[176:179], v[100:103], v[172:175]
v_exp_f32 v70, v70
v_exp_f32 v71, v71
v_cvt_pk_bf16_f32 v92, v64, v65
v_cvt_pk_bf16_f32 v93, v66, v67
v_cvt_pk_bf16_f32 v94, v68, v69
v_cvt_pk_bf16_f32 v95, v70, v71
s_waitcnt lgkmcnt(0)
v_mfma_f32_32x32x16_bf16 v[56:71], v[24:27], v[8:11], v[136:151]
v_exp_f32 v72, v72
v_exp_f32 v73, v73
v_exp_f32 v74, v74
v_exp_f32 v75, v75
v_mfma_f32_32x32x16_bf16 v[56:71], v[28:31], v[12:15], v[56:71]
v_exp_f32 v76, v76
v_exp_f32 v77, v77
v_exp_f32 v78, v78
v_exp_f32 v79, v79
v_mfma_f32_32x32x16_bf16 v[104:119], v[48:51], v[88:91], v[104:119]
v_cvt_pk_bf16_f32 v96, v72, v73
v_cvt_pk_bf16_f32 v97, v74, v75
v_exp_f32 v80, v80
v_exp_f32 v81, v81
v_mfma_f32_16x16x32_bf16 v[168:171], v[176:179], v[88:91], v[168:171]
v_exp_f32 v82, v82
v_exp_f32 v83, v83
v_mfma_f32_32x32x16_bf16 v[104:119], v[52:55], v[92:95], v[104:119]
v_cvt_pk_bf16_f32 v98, v76, v77
v_cvt_pk_bf16_f32 v99, v78, v79
v_exp_f32 v84, v84
v_exp_f32 v85, v85
v_mfma_f32_16x16x32_bf16 v[168:171], v[176:179], v[92:95], v[168:171]
v_exp_f32 v86, v86
v_exp_f32 v87, v87
v_cvt_pk_bf16_f32 v100, v80, v81
v_cvt_pk_bf16_f32 v101, v82, v83
v_cvt_pk_bf16_f32 v102, v84, v85
v_cvt_pk_bf16_f32 v103, v86, v87
v_mfma_f32_32x32x16_bf16 v[72:87], v[24:27], v[16:19], v[152:167]
v_exp_f32 v56, v56
v_exp_f32 v57, v57
ds_read_b128 v[32:35], v2 offset:4096
ds_read_b128 v[36:39], v2 offset:5120
ds_read_b128 v[40:43], v2 offset:2048
ds_read_b128 v[44:47], v2 offset:3072
v_exp_f32 v58, v58
v_exp_f32 v59, v59
v_mfma_f32_32x32x16_bf16 v[72:87], v[28:31], v[20:23], v[72:87]
v_exp_f32 v60, v60
v_exp_f32 v61, v61
v_exp_f32 v62, v62
v_exp_f32 v63, v63
v_mfma_f32_32x32x16_bf16 v[120:135], v[48:51], v[96:99], v[120:135]
v_cvt_pk_bf16_f32 v88, v56, v57
v_cvt_pk_bf16_f32 v89, v58, v59
v_exp_f32 v64, v64
v_exp_f32 v65, v65
v_mfma_f32_16x16x32_bf16 v[172:175], v[176:179], v[96:99], v[172:175]
v_exp_f32 v66, v66
v_exp_f32 v67, v67
v_mfma_f32_32x32x16_bf16 v[120:135], v[52:55], v[100:103], v[120:135]
v_cvt_pk_bf16_f32 v90, v60, v61
v_cvt_pk_bf16_f32 v91, v62, v63
v_exp_f32 v68, v68
v_exp_f32 v69, v69
v_mfma_f32_16x16x32_bf16 v[172:175], v[176:179], v[100:103], v[172:175]
v_exp_f32 v70, v70
v_exp_f32 v71, v71
v_cvt_pk_bf16_f32 v92, v64, v65
v_cvt_pk_bf16_f32 v93, v66, v67
v_cvt_pk_bf16_f32 v94, v68, v69
v_cvt_pk_bf16_f32 v95, v70, v71
s_waitcnt lgkmcnt(0)
v_mfma_f32_32x32x16_bf16 v[56:71], v[32:35], v[8:11], v[136:151]
v_exp_f32 v72, v72
v_exp_f32 v73, v73
v_exp_f32 v74, v74
v_exp_f32 v75, v75
v_mfma_f32_32x32x16_bf16 v[56:71], v[36:39], v[12:15], v[56:71]
v_exp_f32 v76, v76
v_exp_f32 v77, v77
v_exp_f32 v78, v78
v_exp_f32 v79, v79
v_mfma_f32_32x32x16_bf16 v[104:119], v[40:43], v[88:91], v[104:119]
v_cvt_pk_bf16_f32 v96, v72, v73
v_cvt_pk_bf16_f32 v97, v74, v75
v_exp_f32 v80, v80
v_exp_f32 v81, v81
v_mfma_f32_16x16x32_bf16 v[168:171], v[176:179], v[88:91], v[168:171]
v_exp_f32 v82, v82
v_exp_f32 v83, v83
v_mfma_f32_32x32x16_bf16 v[104:119], v[44:47], v[92:95], v[104:119]
v_cvt_pk_bf16_f32 v98, v76, v77
v_cvt_pk_bf16_f32 v99, v78, v79
v_exp_f32 v84, v84
v_exp_f32 v85, v85
v_mfma_f32_16x16x32_bf16 v[168:171], v[176:179], v[92:95], v[168:171]
v_exp_f32 v86, v86
v_exp_f32 v87, v87
v_cvt_pk_bf16_f32 v100, v80, v81
v_cvt_pk_bf16_f32 v101, v82, v83
v_cvt_pk_bf16_f32 v102, v84, v85
v_cvt_pk_bf16_f32 v103, v86, v87
v_mfma_f32_32x32x16_bf16 v[72:87], v[32:35], v[16:19], v[152:167]
v_exp_f32 v56, v56
v_exp_f32 v57, v57
ds_read_b128 v[24:27], v2 offset:8192
ds_read_b128 v[28:31], v2 offset:9216
ds_read_b128 v[48:51], v2 offset:6144
ds_read_b128 v[52:55], v2 offset:7168
v_exp_f32 v58, v58
v_exp_f32 v59, v59
v_mfma_f32_32x32x16_bf16 v[72:87], v[36:39], v[20:23], v[72:87]
v_exp_f32 v60, v60
v_exp_f32 v61, v61
v_exp_f32 v62, v62
v_exp_f32 v63, v63
v_mfma_f32_32x32x16_bf16 v[120:135], v[40:43], v[96:99], v[120:135]
v_cvt_pk_bf16_f32 v88, v56, v57
v_cvt_pk_bf16_f32 v89, v58, v59
v_exp_f32 v64, v64
v_exp_f32 v65, v65
v_mfma_f32_16x16x32_bf16 v[172:175], v[176:179], v[96:99], v[172:175]
v_exp_f32 v66, v66
v_exp_f32 v67, v67
v_mfma_f32_32x32x16_bf16 v[120:135], v[44:47], v[100:103], v[120:135]
v_cvt_pk_bf16_f32 v90, v60, v61
v_cvt_pk_bf16_f32 v91, v62, v63
v_exp_f32 v68, v68
v_exp_f32 v69, v69
v_mfma_f32_16x16x32_bf16 v[172:175], v[176:179], v[100:103], v[172:175]
v_exp_f32 v70, v70
v_exp_f32 v71, v71
v_cvt_pk_bf16_f32 v92, v64, v65
v_cvt_pk_bf16_f32 v93, v66, v67
v_cvt_pk_bf16_f32 v94, v68, v69
v_cvt_pk_bf16_f32 v95, v70, v71
s_waitcnt lgkmcnt(0)
v_mfma_f32_32x32x16_bf16 v[56:71], v[24:27], v[8:11], v[136:151]
v_exp_f32 v72, v72
v_exp_f32 v73, v73
v_exp_f32 v74, v74
v_exp_f32 v75, v75
v_mfma_f32_32x32x16_bf16 v[56:71], v[28:31], v[12:15], v[56:71]
v_exp_f32 v76, v76
v_exp_f32 v77, v77
v_exp_f32 v78, v78
v_exp_f32 v79, v79
v_mfma_f32_32x32x16_bf16 v[104:119], v[48:51], v[88:91], v[104:119]
v_cvt_pk_bf16_f32 v96, v72, v73
v_cvt_pk_bf16_f32 v97, v74, v75
v_exp_f32 v80, v80
v_exp_f32 v81, v81
v_mfma_f32_16x16x32_bf16 v[168:171], v[176:179], v[88:91], v[168:171]
v_exp_f32 v82, v82
v_exp_f32 v83, v83
v_mfma_f32_32x32x16_bf16 v[104:119], v[52:55], v[92:95], v[104:119]
v_cvt_pk_bf16_f32 v98, v76, v77
v_cvt_pk_bf16_f32 v99, v78, v79
v_exp_f32 v84, v84
v_exp_f32 v85, v85
v_mfma_f32_16x16x32_bf16 v[168:171], v[176:179], v[92:95], v[168:171]
v_exp_f32 v86, v86
v_exp_f32 v87, v87
v_cvt_pk_bf16_f32 v100, v80, v81
v_cvt_pk_bf16_f32 v101, v82, v83
v_cvt_pk_bf16_f32 v102, v84, v85
v_cvt_pk_bf16_f32 v103, v86, v87
v_mfma_f32_32x32x16_bf16 v[72:87], v[24:27], v[16:19], v[152:167]
v_exp_f32 v56, v56
v_exp_f32 v57, v57
ds_read_b128 v[32:35], v2 offset:12288
ds_read_b128 v[36:39], v2 offset:13312
ds_read_b128 v[40:43], v2 offset:10240
ds_read_b128 v[44:47], v2 offset:11264
v_exp_f32 v58, v58
v_exp_f32 v59, v59
v_mfma_f32_32x32x16_bf16 v[72:87], v[28:31], v[20:23], v[72:87]
v_exp_f32 v60, v60
v_exp_f32 v61, v61
v_exp_f32 v62, v62
v_exp_f32 v63, v63
v_mfma_f32_32x32x16_bf16 v[120:135], v[48:51], v[96:99], v[120:135]
v_cvt_pk_bf16_f32 v88, v56, v57
v_cvt_pk_bf16_f32 v89, v58, v59
v_exp_f32 v64, v64
v_exp_f32 v65, v65
v_mfma_f32_16x16x32_bf16 v[172:175], v[176:179], v[96:99], v[172:175]
v_exp_f32 v66, v66
v_exp_f32 v67, v67
v_mfma_f32_32x32x16_bf16 v[120:135], v[52:55], v[100:103], v[120:135]
v_cvt_pk_bf16_f32 v90, v60, v61
v_cvt_pk_bf16_f32 v91, v62, v63
v_exp_f32 v68, v68
v_exp_f32 v69, v69
v_mfma_f32_16x16x32_bf16 v[172:175], v[176:179], v[100:103], v[172:175]
v_exp_f32 v70, v70
v_exp_f32 v71, v71
v_cvt_pk_bf16_f32 v92, v64, v65
v_cvt_pk_bf16_f32 v93, v66, v67
v_cvt_pk_bf16_f32 v94, v68, v69
v_cvt_pk_bf16_f32 v95, v70, v71
s_waitcnt lgkmcnt(0)
v_mfma_f32_32x32x16_bf16 v[56:71], v[32:35], v[8:11], v[136:151]
v_exp_f32 v72, v72
v_exp_f32 v73, v73
v_exp_f32 v74, v74
v_exp_f32 v75, v75
v_mfma_f32_32x32x16_bf16 v[56:71], v[36:39], v[12:15], v[56:71]
v_exp_f32 v76, v76
v_exp_f32 v77, v77
v_exp_f32 v78, v78
v_exp_f32 v79, v79
v_mfma_f32_32x32x16_bf16 v[104:119], v[40:43], v[88:91], v[104:119]
v_cvt_pk_bf16_f32 v96, v72, v73
v_cvt_pk_bf16_f32 v97, v74, v75
v_exp_f32 v80, v80
v_exp_f32 v81, v81
v_mfma_f32_16x16x32_bf16 v[168:171], v[176:179], v[88:91], v[168:171]
v_exp_f32 v82, v82
v_exp_f32 v83, v83
v_mfma_f32_32x32x16_bf16 v[104:119], v[44:47], v[92:95], v[104:119]
v_cvt_pk_bf16_f32 v98, v76, v77
v_cvt_pk_bf16_f32 v99, v78, v79
v_exp_f32 v84, v84
v_exp_f32 v85, v85
v_mfma_f32_16x16x32_bf16 v[168:171], v[176:179], v[92:95], v[168:171]
v_exp_f32 v86, v86
v_exp_f32 v87, v87
v_cvt_pk_bf16_f32 v100, v80, v81
v_cvt_pk_bf16_f32 v101, v82, v83
v_cvt_pk_bf16_f32 v102, v84, v85
v_cvt_pk_bf16_f32 v103, v86, v87
s_waitcnt vmcnt(4)
s_barrier
v_mfma_f32_32x32x16_bf16 v[72:87], v[32:35], v[16:19], v[152:167]
v_exp_f32 v56, v56
v_exp_f32 v57, v57
ds_read_b128 v[24:27], v2 offset:16384
ds_read_b128 v[28:31], v2 offset:17408
ds_read_b128 v[48:51], v2 offset:14336
ds_read_b128 v[52:55], v2 offset:15360
v_exp_f32 v58, v58
v_exp_f32 v59, v59
v_mfma_f32_32x32x16_bf16 v[72:87], v[36:39], v[20:23], v[72:87]
v_exp_f32 v60, v60
v_exp_f32 v61, v61
v_exp_f32 v62, v62
v_exp_f32 v63, v63
v_mfma_f32_32x32x16_bf16 v[120:135], v[40:43], v[96:99], v[120:135]
v_cvt_pk_bf16_f32 v88, v56, v57
v_cvt_pk_bf16_f32 v89, v58, v59
v_exp_f32 v64, v64
s_add_u32 m0, s16, 49152
s_nop 0
buffer_load_dwordx4 v3, s[8:11], s15 offen offset:0 lds
buffer_load_dwordx4 v3, s[8:11], s15 offen offset:1024 lds
buffer_load_dwordx4 v3, s[8:11], s15 offen offset:2048 lds
buffer_load_dwordx4 v3, s[8:11], s15 offen offset:3072 lds
s_add_u32 s15, s15, 16384
v_exp_f32 v65, v65
v_mfma_f32_16x16x32_bf16 v[172:175], v[176:179], v[96:99], v[172:175]
v_exp_f32 v66, v66
v_exp_f32 v67, v67
v_mfma_f32_32x32x16_bf16 v[120:135], v[44:47], v[100:103], v[120:135]
v_cvt_pk_bf16_f32 v90, v60, v61
v_cvt_pk_bf16_f32 v91, v62, v63
v_exp_f32 v68, v68
v_exp_f32 v69, v69
v_mfma_f32_16x16x32_bf16 v[172:175], v[176:179], v[100:103], v[172:175]
v_exp_f32 v70, v70
v_exp_f32 v71, v71
v_cvt_pk_bf16_f32 v92, v64, v65
v_cvt_pk_bf16_f32 v93, v66, v67
v_cvt_pk_bf16_f32 v94, v68, v69
v_cvt_pk_bf16_f32 v95, v70, v71
s_waitcnt lgkmcnt(0)
v_mfma_f32_32x32x16_bf16 v[56:71], v[24:27], v[8:11], v[136:151]
v_exp_f32 v72, v72
v_exp_f32 v73, v73
v_exp_f32 v74, v74
v_exp_f32 v75, v75
v_mfma_f32_32x32x16_bf16 v[56:71], v[28:31], v[12:15], v[56:71]
v_exp_f32 v76, v76
v_exp_f32 v77, v77
v_exp_f32 v78, v78
v_exp_f32 v79, v79
v_mfma_f32_32x32x16_bf16 v[104:119], v[48:51], v[88:91], v[104:119]
v_cvt_pk_bf16_f32 v96, v72, v73
v_cvt_pk_bf16_f32 v97, v74, v75
v_exp_f32 v80, v80
v_exp_f32 v81, v81
v_mfma_f32_16x16x32_bf16 v[168:171], v[176:179], v[88:91], v[168:171]
v_exp_f32 v82, v82
v_exp_f32 v83, v83
v_mfma_f32_32x32x16_bf16 v[104:119], v[52:55], v[92:95], v[104:119]
v_cvt_pk_bf16_f32 v98, v76, v77
v_cvt_pk_bf16_f32 v99, v78, v79
v_exp_f32 v84, v84
v_exp_f32 v85, v85
v_mfma_f32_16x16x32_bf16 v[168:171], v[176:179], v[92:95], v[168:171]
v_exp_f32 v86, v86
v_exp_f32 v87, v87
v_cvt_pk_bf16_f32 v100, v80, v81
v_cvt_pk_bf16_f32 v101, v82, v83
v_cvt_pk_bf16_f32 v102, v84, v85
v_cvt_pk_bf16_f32 v103, v86, v87
v_mfma_f32_32x32x16_bf16 v[72:87], v[24:27], v[16:19], v[152:167]
v_exp_f32 v56, v56
v_exp_f32 v57, v57
ds_read_b128 v[32:35], v2 offset:20480
ds_read_b128 v[36:39], v2 offset:21504
ds_read_b128 v[40:43], v2 offset:18432
ds_read_b128 v[44:47], v2 offset:19456
v_exp_f32 v58, v58
v_exp_f32 v59, v59
v_mfma_f32_32x32x16_bf16 v[72:87], v[28:31], v[20:23], v[72:87]
v_exp_f32 v60, v60
v_exp_f32 v61, v61
v_exp_f32 v62, v62
v_exp_f32 v63, v63
v_mfma_f32_32x32x16_bf16 v[120:135], v[48:51], v[96:99], v[120:135]
v_cvt_pk_bf16_f32 v88, v56, v57
v_cvt_pk_bf16_f32 v89, v58, v59
v_exp_f32 v64, v64
v_exp_f32 v65, v65
v_mfma_f32_16x16x32_bf16 v[172:175], v[176:179], v[96:99], v[172:175]
v_exp_f32 v66, v66
v_exp_f32 v67, v67
v_mfma_f32_32x32x16_bf16 v[120:135], v[52:55], v[100:103], v[120:135]
v_cvt_pk_bf16_f32 v90, v60, v61
v_cvt_pk_bf16_f32 v91, v62, v63
v_exp_f32 v68, v68
v_exp_f32 v69, v69
v_mfma_f32_16x16x32_bf16 v[172:175], v[176:179], v[100:103], v[172:175]
v_exp_f32 v70, v70
v_exp_f32 v71, v71
v_cvt_pk_bf16_f32 v92, v64, v65
v_cvt_pk_bf16_f32 v93, v66, v67
v_cvt_pk_bf16_f32 v94, v68, v69
v_cvt_pk_bf16_f32 v95, v70, v71
s_waitcnt lgkmcnt(0)
v_mfma_f32_32x32x16_bf16 v[56:71], v[32:35], v[8:11], v[136:151]
v_exp_f32 v72, v72
v_exp_f32 v73, v73
v_exp_f32 v74, v74
v_exp_f32 v75, v75
v_mfma_f32_32x32x16_bf16 v[56:71], v[36:39], v[12:15], v[56:71]
v_exp_f32 v76, v76
v_exp_f32 v77, v77
v_exp_f32 v78, v78
v_exp_f32 v79, v79
v_mfma_f32_32x32x16_bf16 v[104:119], v[40:43], v[88:91], v[104:119]
v_cvt_pk_bf16_f32 v96, v72, v73
v_cvt_pk_bf16_f32 v97, v74, v75
v_exp_f32 v80, v80
v_exp_f32 v81, v81
v_mfma_f32_16x16x32_bf16 v[168:171], v[176:179], v[88:91], v[168:171]
v_exp_f32 v82, v82
v_exp_f32 v83, v83
v_mfma_f32_32x32x16_bf16 v[104:119], v[44:47], v[92:95], v[104:119]
v_cvt_pk_bf16_f32 v98, v76, v77
v_cvt_pk_bf16_f32 v99, v78, v79
v_exp_f32 v84, v84
v_exp_f32 v85, v85
v_mfma_f32_16x16x32_bf16 v[168:171], v[176:179], v[92:95], v[168:171]
v_exp_f32 v86, v86
v_exp_f32 v87, v87
v_cvt_pk_bf16_f32 v100, v80, v81
v_cvt_pk_bf16_f32 v101, v82, v83
v_cvt_pk_bf16_f32 v102, v84, v85
v_cvt_pk_bf16_f32 v103, v86, v87
v_mfma_f32_32x32x16_bf16 v[72:87], v[32:35], v[16:19], v[152:167]
v_exp_f32 v56, v56
v_exp_f32 v57, v57
ds_read_b128 v[24:27], v2 offset:24576
ds_read_b128 v[28:31], v2 offset:25600
ds_read_b128 v[48:51], v2 offset:22528
ds_read_b128 v[52:55], v2 offset:23552
v_exp_f32 v58, v58
v_exp_f32 v59, v59
v_mfma_f32_32x32x16_bf16 v[72:87], v[36:39], v[20:23], v[72:87]
v_exp_f32 v60, v60
v_exp_f32 v61, v61
v_exp_f32 v62, v62
v_exp_f32 v63, v63
v_mfma_f32_32x32x16_bf16 v[120:135], v[40:43], v[96:99], v[120:135]
v_cvt_pk_bf16_f32 v88, v56, v57
v_cvt_pk_bf16_f32 v89, v58, v59
v_exp_f32 v64, v64
v_exp_f32 v65, v65
v_mfma_f32_16x16x32_bf16 v[172:175], v[176:179], v[96:99], v[172:175]
v_exp_f32 v66, v66
v_exp_f32 v67, v67
v_mfma_f32_32x32x16_bf16 v[120:135], v[44:47], v[100:103], v[120:135]
v_cvt_pk_bf16_f32 v90, v60, v61
v_cvt_pk_bf16_f32 v91, v62, v63
v_exp_f32 v68, v68
v_exp_f32 v69, v69
v_mfma_f32_16x16x32_bf16 v[172:175], v[176:179], v[100:103], v[172:175]
v_exp_f32 v70, v70
v_exp_f32 v71, v71
v_cvt_pk_bf16_f32 v92, v64, v65
v_cvt_pk_bf16_f32 v93, v66, v67
v_cvt_pk_bf16_f32 v94, v68, v69
v_cvt_pk_bf16_f32 v95, v70, v71
s_waitcnt lgkmcnt(0)
v_mfma_f32_32x32x16_bf16 v[56:71], v[24:27], v[8:11], v[136:151]
v_exp_f32 v72, v72
v_exp_f32 v73, v73
v_exp_f32 v74, v74
v_exp_f32 v75, v75
v_mfma_f32_32x32x16_bf16 v[56:71], v[28:31], v[12:15], v[56:71]
v_exp_f32 v76, v76
v_exp_f32 v77, v77
v_exp_f32 v78, v78
v_exp_f32 v79, v79
v_mfma_f32_32x32x16_bf16 v[104:119], v[48:51], v[88:91], v[104:119]
v_cvt_pk_bf16_f32 v96, v72, v73
v_cvt_pk_bf16_f32 v97, v74, v75
v_exp_f32 v80, v80
v_exp_f32 v81, v81
v_mfma_f32_16x16x32_bf16 v[168:171], v[176:179], v[88:91], v[168:171]
v_exp_f32 v82, v82
v_exp_f32 v83, v83
v_mfma_f32_32x32x16_bf16 v[104:119], v[52:55], v[92:95], v[104:119]
v_cvt_pk_bf16_f32 v98, v76, v77
v_cvt_pk_bf16_f32 v99, v78, v79
v_exp_f32 v84, v84
v_exp_f32 v85, v85
v_mfma_f32_16x16x32_bf16 v[168:171], v[176:179], v[92:95], v[168:171]
v_exp_f32 v86, v86
v_exp_f32 v87, v87
v_cvt_pk_bf16_f32 v100, v80, v81
v_cvt_pk_bf16_f32 v101, v82, v83
v_cvt_pk_bf16_f32 v102, v84, v85
v_cvt_pk_bf16_f32 v103, v86, v87
v_mfma_f32_32x32x16_bf16 v[72:87], v[24:27], v[16:19], v[152:167]
v_exp_f32 v56, v56
v_exp_f32 v57, v57
ds_read_b128 v[32:35], v2 offset:28672
ds_read_b128 v[36:39], v2 offset:29696
ds_read_b128 v[40:43], v2 offset:26624
ds_read_b128 v[44:47], v2 offset:27648
v_exp_f32 v58, v58
v_exp_f32 v59, v59
v_mfma_f32_32x32x16_bf16 v[72:87], v[28:31], v[20:23], v[72:87]
v_exp_f32 v60, v60
v_exp_f32 v61, v61
v_exp_f32 v62, v62
v_exp_f32 v63, v63
v_mfma_f32_32x32x16_bf16 v[120:135], v[48:51], v[96:99], v[120:135]
v_cvt_pk_bf16_f32 v88, v56, v57
v_cvt_pk_bf16_f32 v89, v58, v59
v_exp_f32 v64, v64
v_exp_f32 v65, v65
v_mfma_f32_16x16x32_bf16 v[172:175], v[176:179], v[96:99], v[172:175]
v_exp_f32 v66, v66
v_exp_f32 v67, v67
v_mfma_f32_32x32x16_bf16 v[120:135], v[52:55], v[100:103], v[120:135]
v_cvt_pk_bf16_f32 v90, v60, v61
v_cvt_pk_bf16_f32 v91, v62, v63
v_exp_f32 v68, v68
v_exp_f32 v69, v69
v_mfma_f32_16x16x32_bf16 v[172:175], v[176:179], v[100:103], v[172:175]
v_exp_f32 v70, v70
v_exp_f32 v71, v71
v_cvt_pk_bf16_f32 v92, v64, v65
v_cvt_pk_bf16_f32 v93, v66, v67
v_cvt_pk_bf16_f32 v94, v68, v69
v_cvt_pk_bf16_f32 v95, v70, v71
s_waitcnt lgkmcnt(0)
v_mfma_f32_32x32x16_bf16 v[56:71], v[32:35], v[8:11], v[136:151]
v_exp_f32 v72, v72
v_exp_f32 v73, v73
v_exp_f32 v74, v74
v_exp_f32 v75, v75
v_mfma_f32_32x32x16_bf16 v[56:71], v[36:39], v[12:15], v[56:71]
v_exp_f32 v76, v76
v_exp_f32 v77, v77
v_exp_f32 v78, v78
v_exp_f32 v79, v79
v_mfma_f32_32x32x16_bf16 v[104:119], v[40:43], v[88:91], v[104:119]
v_cvt_pk_bf16_f32 v96, v72, v73
v_cvt_pk_bf16_f32 v97, v74, v75
v_exp_f32 v80, v80
v_exp_f32 v81, v81
v_mfma_f32_16x16x32_bf16 v[168:171], v[176:179], v[88:91], v[168:171]
v_exp_f32 v82, v82
v_exp_f32 v83, v83
v_mfma_f32_32x32x16_bf16 v[104:119], v[44:47], v[92:95], v[104:119]
v_cvt_pk_bf16_f32 v98, v76, v77
v_cvt_pk_bf16_f32 v99, v78, v79
v_exp_f32 v84, v84
v_exp_f32 v85, v85
v_mfma_f32_16x16x32_bf16 v[168:171], v[176:179], v[92:95], v[168:171]
v_exp_f32 v86, v86
v_exp_f32 v87, v87
v_cvt_pk_bf16_f32 v100, v80, v81
v_cvt_pk_bf16_f32 v101, v82, v83
v_cvt_pk_bf16_f32 v102, v84, v85
v_cvt_pk_bf16_f32 v103, v86, v87
s_waitcnt vmcnt(4)
s_barrier
v_mfma_f32_32x32x16_bf16 v[72:87], v[32:35], v[16:19], v[152:167]
v_exp_f32 v56, v56
v_exp_f32 v57, v57
ds_read_b128 v[24:27], v2 offset:32768
ds_read_b128 v[28:31], v2 offset:33792
ds_read_b128 v[48:51], v2 offset:30720
ds_read_b128 v[52:55], v2 offset:31744
v_exp_f32 v58, v58
v_exp_f32 v59, v59
v_mfma_f32_32x32x16_bf16 v[72:87], v[36:39], v[20:23], v[72:87]
v_exp_f32 v60, v60
v_exp_f32 v61, v61
v_exp_f32 v62, v62
v_exp_f32 v63, v63
v_mfma_f32_32x32x16_bf16 v[120:135], v[40:43], v[96:99], v[120:135]
v_cvt_pk_bf16_f32 v88, v56, v57
v_cvt_pk_bf16_f32 v89, v58, v59
v_exp_f32 v64, v64
s_add_u32 m0, s16, 0
s_nop 0
buffer_load_dwordx4 v3, s[8:11], s15 offen offset:0 lds
buffer_load_dwordx4 v3, s[8:11], s15 offen offset:1024 lds
buffer_load_dwordx4 v3, s[8:11], s15 offen offset:2048 lds
buffer_load_dwordx4 v3, s[8:11], s15 offen offset:3072 lds
s_add_u32 s15, s15, 16384
v_exp_f32 v65, v65
v_mfma_f32_16x16x32_bf16 v[172:175], v[176:179], v[96:99], v[172:175]
v_exp_f32 v66, v66
v_exp_f32 v67, v67
v_mfma_f32_32x32x16_bf16 v[120:135], v[44:47], v[100:103], v[120:135]
v_cvt_pk_bf16_f32 v90, v60, v61
v_cvt_pk_bf16_f32 v91, v62, v63
v_exp_f32 v68, v68
v_exp_f32 v69, v69
v_mfma_f32_16x16x32_bf16 v[172:175], v[176:179], v[100:103], v[172:175]
v_exp_f32 v70, v70
v_exp_f32 v71, v71
v_cvt_pk_bf16_f32 v92, v64, v65
v_cvt_pk_bf16_f32 v93, v66, v67
v_cvt_pk_bf16_f32 v94, v68, v69
v_cvt_pk_bf16_f32 v95, v70, v71
s_waitcnt lgkmcnt(0)
v_mfma_f32_32x32x16_bf16 v[56:71], v[24:27], v[8:11], v[136:151]
v_exp_f32 v72, v72
v_exp_f32 v73, v73
v_exp_f32 v74, v74
v_exp_f32 v75, v75
v_mfma_f32_32x32x16_bf16 v[56:71], v[28:31], v[12:15], v[56:71]
v_exp_f32 v76, v76
v_exp_f32 v77, v77
v_exp_f32 v78, v78
v_exp_f32 v79, v79
v_mfma_f32_32x32x16_bf16 v[104:119], v[48:51], v[88:91], v[104:119]
v_cvt_pk_bf16_f32 v96, v72, v73
v_cvt_pk_bf16_f32 v97, v74, v75
v_exp_f32 v80, v80
v_exp_f32 v81, v81
v_mfma_f32_16x16x32_bf16 v[168:171], v[176:179], v[88:91], v[168:171]
v_exp_f32 v82, v82
v_exp_f32 v83, v83
v_mfma_f32_32x32x16_bf16 v[104:119], v[52:55], v[92:95], v[104:119]
v_cvt_pk_bf16_f32 v98, v76, v77
v_cvt_pk_bf16_f32 v99, v78, v79
v_exp_f32 v84, v84
v_exp_f32 v85, v85
v_mfma_f32_16x16x32_bf16 v[168:171], v[176:179], v[92:95], v[168:171]
v_exp_f32 v86, v86
v_exp_f32 v87, v87
v_cvt_pk_bf16_f32 v100, v80, v81
v_cvt_pk_bf16_f32 v101, v82, v83
v_cvt_pk_bf16_f32 v102, v84, v85
v_cvt_pk_bf16_f32 v103, v86, v87
v_mfma_f32_32x32x16_bf16 v[72:87], v[24:27], v[16:19], v[152:167]
v_exp_f32 v56, v56
v_exp_f32 v57, v57
ds_read_b128 v[32:35], v2 offset:36864
ds_read_b128 v[36:39], v2 offset:37888
ds_read_b128 v[40:43], v2 offset:34816
ds_read_b128 v[44:47], v2 offset:35840
v_exp_f32 v58, v58
v_exp_f32 v59, v59
v_mfma_f32_32x32x16_bf16 v[72:87], v[28:31], v[20:23], v[72:87]
v_exp_f32 v60, v60
v_exp_f32 v61, v61
v_exp_f32 v62, v62
v_exp_f32 v63, v63
v_mfma_f32_32x32x16_bf16 v[120:135], v[48:51], v[96:99], v[120:135]
v_cvt_pk_bf16_f32 v88, v56, v57
v_cvt_pk_bf16_f32 v89, v58, v59
v_exp_f32 v64, v64
v_exp_f32 v65, v65
v_mfma_f32_16x16x32_bf16 v[172:175], v[176:179], v[96:99], v[172:175]
v_exp_f32 v66, v66
v_exp_f32 v67, v67
v_mfma_f32_32x32x16_bf16 v[120:135], v[52:55], v[100:103], v[120:135]
v_cvt_pk_bf16_f32 v90, v60, v61
v_cvt_pk_bf16_f32 v91, v62, v63
v_exp_f32 v68, v68
v_exp_f32 v69, v69
v_mfma_f32_16x16x32_bf16 v[172:175], v[176:179], v[100:103], v[172:175]
v_exp_f32 v70, v70
v_exp_f32 v71, v71
v_cvt_pk_bf16_f32 v92, v64, v65
v_cvt_pk_bf16_f32 v93, v66, v67
v_cvt_pk_bf16_f32 v94, v68, v69
v_cvt_pk_bf16_f32 v95, v70, v71
s_waitcnt lgkmcnt(0)
v_mfma_f32_32x32x16_bf16 v[56:71], v[32:35], v[8:11], v[136:151]
v_exp_f32 v72, v72
v_exp_f32 v73, v73
v_exp_f32 v74, v74
v_exp_f32 v75, v75
v_mfma_f32_32x32x16_bf16 v[56:71], v[36:39], v[12:15], v[56:71]
v_exp_f32 v76, v76
v_exp_f32 v77, v77
v_exp_f32 v78, v78
v_exp_f32 v79, v79
v_mfma_f32_32x32x16_bf16 v[104:119], v[40:43], v[88:91], v[104:119]
v_cvt_pk_bf16_f32 v96, v72, v73
v_cvt_pk_bf16_f32 v97, v74, v75
v_exp_f32 v80, v80
v_exp_f32 v81, v81
v_mfma_f32_16x16x32_bf16 v[168:171], v[176:179], v[88:91], v[168:171]
v_exp_f32 v82, v82
v_exp_f32 v83, v83
v_mfma_f32_32x32x16_bf16 v[104:119], v[44:47], v[92:95], v[104:119]
v_cvt_pk_bf16_f32 v98, v76, v77
v_cvt_pk_bf16_f32 v99, v78, v79
v_exp_f32 v84, v84
v_exp_f32 v85, v85
v_mfma_f32_16x16x32_bf16 v[168:171], v[176:179], v[92:95], v[168:171]
v_exp_f32 v86, v86
v_exp_f32 v87, v87
v_cvt_pk_bf16_f32 v100, v80, v81
v_cvt_pk_bf16_f32 v101, v82, v83
v_cvt_pk_bf16_f32 v102, v84, v85
v_cvt_pk_bf16_f32 v103, v86, v87
v_mfma_f32_32x32x16_bf16 v[72:87], v[32:35], v[16:19], v[152:167]
v_exp_f32 v56, v56
v_exp_f32 v57, v57
ds_read_b128 v[24:27], v2 offset:40960
ds_read_b128 v[28:31], v2 offset:41984
ds_read_b128 v[48:51], v2 offset:38912
ds_read_b128 v[52:55], v2 offset:39936
v_exp_f32 v58, v58
v_exp_f32 v59, v59
v_mfma_f32_32x32x16_bf16 v[72:87], v[36:39], v[20:23], v[72:87]
v_exp_f32 v60, v60
v_exp_f32 v61, v61
v_exp_f32 v62, v62
v_exp_f32 v63, v63
v_mfma_f32_32x32x16_bf16 v[120:135], v[40:43], v[96:99], v[120:135]
v_cvt_pk_bf16_f32 v88, v56, v57
v_cvt_pk_bf16_f32 v89, v58, v59
v_exp_f32 v64, v64
v_exp_f32 v65, v65
v_mfma_f32_16x16x32_bf16 v[172:175], v[176:179], v[96:99], v[172:175]
v_exp_f32 v66, v66
v_exp_f32 v67, v67
v_mfma_f32_32x32x16_bf16 v[120:135], v[44:47], v[100:103], v[120:135]
v_cvt_pk_bf16_f32 v90, v60, v61
v_cvt_pk_bf16_f32 v91, v62, v63
v_exp_f32 v68, v68
v_exp_f32 v69, v69
v_mfma_f32_16x16x32_bf16 v[172:175], v[176:179], v[100:103], v[172:175]
v_exp_f32 v70, v70
v_exp_f32 v71, v71
v_cvt_pk_bf16_f32 v92, v64, v65
v_cvt_pk_bf16_f32 v93, v66, v67
v_cvt_pk_bf16_f32 v94, v68, v69
v_cvt_pk_bf16_f32 v95, v70, v71
s_waitcnt lgkmcnt(0)
v_mfma_f32_32x32x16_bf16 v[56:71], v[24:27], v[8:11], v[136:151]
v_exp_f32 v72, v72
v_exp_f32 v73, v73
v_exp_f32 v74, v74
v_exp_f32 v75, v75
v_mfma_f32_32x32x16_bf16 v[56:71], v[28:31], v[12:15], v[56:71]
v_exp_f32 v76, v76
v_exp_f32 v77, v77
v_exp_f32 v78, v78
v_exp_f32 v79, v79
v_mfma_f32_32x32x16_bf16 v[104:119], v[48:51], v[88:91], v[104:119]
v_cvt_pk_bf16_f32 v96, v72, v73
v_cvt_pk_bf16_f32 v97, v74, v75
v_exp_f32 v80, v80
v_exp_f32 v81, v81
v_mfma_f32_16x16x32_bf16 v[168:171], v[176:179], v[88:91], v[168:171]
v_exp_f32 v82, v82
v_exp_f32 v83, v83
v_mfma_f32_32x32x16_bf16 v[104:119], v[52:55], v[92:95], v[104:119]
v_cvt_pk_bf16_f32 v98, v76, v77
v_cvt_pk_bf16_f32 v99, v78, v79
v_exp_f32 v84, v84
v_exp_f32 v85, v85
v_mfma_f32_16x16x32_bf16 v[168:171], v[176:179], v[92:95], v[168:171]
v_exp_f32 v86, v86
v_exp_f32 v87, v87
v_cvt_pk_bf16_f32 v100, v80, v81
v_cvt_pk_bf16_f32 v101, v82, v83
v_cvt_pk_bf16_f32 v102, v84, v85
v_cvt_pk_bf16_f32 v103, v86, v87
v_mfma_f32_32x32x16_bf16 v[72:87], v[24:27], v[16:19], v[152:167]
v_exp_f32 v56, v56
v_exp_f32 v57, v57
ds_read_b128 v[32:35], v2 offset:45056
ds_read_b128 v[36:39], v2 offset:46080
ds_read_b128 v[40:43], v2 offset:43008
ds_read_b128 v[44:47], v2 offset:44032
v_exp_f32 v58, v58
v_exp_f32 v59, v59
v_mfma_f32_32x32x16_bf16 v[72:87], v[28:31], v[20:23], v[72:87]
v_exp_f32 v60, v60
v_exp_f32 v61, v61
v_exp_f32 v62, v62
v_exp_f32 v63, v63
v_mfma_f32_32x32x16_bf16 v[120:135], v[48:51], v[96:99], v[120:135]
v_cvt_pk_bf16_f32 v88, v56, v57
v_cvt_pk_bf16_f32 v89, v58, v59
v_exp_f32 v64, v64
v_exp_f32 v65, v65
v_mfma_f32_16x16x32_bf16 v[172:175], v[176:179], v[96:99], v[172:175]
v_exp_f32 v66, v66
v_exp_f32 v67, v67
v_mfma_f32_32x32x16_bf16 v[120:135], v[52:55], v[100:103], v[120:135]
v_cvt_pk_bf16_f32 v90, v60, v61
v_cvt_pk_bf16_f32 v91, v62, v63
v_exp_f32 v68, v68
v_exp_f32 v69, v69
v_mfma_f32_16x16x32_bf16 v[172:175], v[176:179], v[100:103], v[172:175]
v_exp_f32 v70, v70
v_exp_f32 v71, v71
v_cvt_pk_bf16_f32 v92, v64, v65
v_cvt_pk_bf16_f32 v93, v66, v67
v_cvt_pk_bf16_f32 v94, v68, v69
v_cvt_pk_bf16_f32 v95, v70, v71
s_waitcnt lgkmcnt(0)
v_mfma_f32_32x32x16_bf16 v[56:71], v[32:35], v[8:11], v[136:151]
v_exp_f32 v72, v72
v_exp_f32 v73, v73
v_exp_f32 v74, v74
v_exp_f32 v75, v75
v_mfma_f32_32x32x16_bf16 v[56:71], v[36:39], v[12:15], v[56:71]
v_exp_f32 v76, v76
v_exp_f32 v77, v77
v_exp_f32 v78, v78
v_exp_f32 v79, v79
v_mfma_f32_32x32x16_bf16 v[104:119], v[40:43], v[88:91], v[104:119]
v_cvt_pk_bf16_f32 v96, v72, v73
v_cvt_pk_bf16_f32 v97, v74, v75
v_exp_f32 v80, v80
v_exp_f32 v81, v81
v_mfma_f32_16x16x32_bf16 v[168:171], v[176:179], v[88:91], v[168:171]
v_exp_f32 v82, v82
v_exp_f32 v83, v83
v_mfma_f32_32x32x16_bf16 v[104:119], v[44:47], v[92:95], v[104:119]
v_cvt_pk_bf16_f32 v98, v76, v77
v_cvt_pk_bf16_f32 v99, v78, v79
v_exp_f32 v84, v84
v_exp_f32 v85, v85
v_mfma_f32_16x16x32_bf16 v[168:171], v[176:179], v[92:95], v[168:171]
v_exp_f32 v86, v86
v_exp_f32 v87, v87
v_cvt_pk_bf16_f32 v100, v80, v81
v_cvt_pk_bf16_f32 v101, v82, v83
v_cvt_pk_bf16_f32 v102, v84, v85
v_cvt_pk_bf16_f32 v103, v86, v87
s_waitcnt vmcnt(4)
s_barrier
v_mfma_f32_32x32x16_bf16 v[72:87], v[32:35], v[16:19], v[152:167]
v_exp_f32 v56, v56
v_exp_f32 v57, v57
ds_read_b128 v[24:27], v2 offset:49152
ds_read_b128 v[28:31], v2 offset:50176
ds_read_b128 v[48:51], v2 offset:47104
ds_read_b128 v[52:55], v2 offset:48128
v_exp_f32 v58, v58
v_exp_f32 v59, v59
v_mfma_f32_32x32x16_bf16 v[72:87], v[36:39], v[20:23], v[72:87]
v_exp_f32 v60, v60
v_exp_f32 v61, v61
v_exp_f32 v62, v62
v_exp_f32 v63, v63
v_mfma_f32_32x32x16_bf16 v[120:135], v[40:43], v[96:99], v[120:135]
v_cvt_pk_bf16_f32 v88, v56, v57
v_cvt_pk_bf16_f32 v89, v58, v59
v_exp_f32 v64, v64
s_add_u32 m0, s16, 16384
s_nop 0
buffer_load_dwordx4 v3, s[8:11], s15 offen offset:0 lds
buffer_load_dwordx4 v3, s[8:11], s15 offen offset:1024 lds
buffer_load_dwordx4 v3, s[8:11], s15 offen offset:2048 lds
buffer_load_dwordx4 v3, s[8:11], s15 offen offset:3072 lds
s_add_u32 s15, s15, 16384
v_exp_f32 v65, v65
v_mfma_f32_16x16x32_bf16 v[172:175], v[176:179], v[96:99], v[172:175]
v_exp_f32 v66, v66
v_exp_f32 v67, v67
v_mfma_f32_32x32x16_bf16 v[120:135], v[44:47], v[100:103], v[120:135]
v_cvt_pk_bf16_f32 v90, v60, v61
v_cvt_pk_bf16_f32 v91, v62, v63
v_exp_f32 v68, v68
v_exp_f32 v69, v69
v_mfma_f32_16x16x32_bf16 v[172:175], v[176:179], v[100:103], v[172:175]
v_exp_f32 v70, v70
v_exp_f32 v71, v71
v_cvt_pk_bf16_f32 v92, v64, v65
v_cvt_pk_bf16_f32 v93, v66, v67
v_cvt_pk_bf16_f32 v94, v68, v69
v_cvt_pk_bf16_f32 v95, v70, v71
s_waitcnt lgkmcnt(0)
v_mfma_f32_32x32x16_bf16 v[56:71], v[24:27], v[8:11], v[136:151]
v_exp_f32 v72, v72
v_exp_f32 v73, v73
v_exp_f32 v74, v74
v_exp_f32 v75, v75
v_mfma_f32_32x32x16_bf16 v[56:71], v[28:31], v[12:15], v[56:71]
v_exp_f32 v76, v76
v_exp_f32 v77, v77
v_exp_f32 v78, v78
v_exp_f32 v79, v79
v_mfma_f32_32x32x16_bf16 v[104:119], v[48:51], v[88:91], v[104:119]
v_cvt_pk_bf16_f32 v96, v72, v73
v_cvt_pk_bf16_f32 v97, v74, v75
v_exp_f32 v80, v80
v_exp_f32 v81, v81
v_mfma_f32_16x16x32_bf16 v[168:171], v[176:179], v[88:91], v[168:171]
v_exp_f32 v82, v82
v_exp_f32 v83, v83
v_mfma_f32_32x32x16_bf16 v[104:119], v[52:55], v[92:95], v[104:119]
v_cvt_pk_bf16_f32 v98, v76, v77
v_cvt_pk_bf16_f32 v99, v78, v79
v_exp_f32 v84, v84
v_exp_f32 v85, v85
v_mfma_f32_16x16x32_bf16 v[168:171], v[176:179], v[92:95], v[168:171]
v_exp_f32 v86, v86
v_exp_f32 v87, v87
v_cvt_pk_bf16_f32 v100, v80, v81
v_cvt_pk_bf16_f32 v101, v82, v83
v_cvt_pk_bf16_f32 v102, v84, v85
v_cvt_pk_bf16_f32 v103, v86, v87
v_mfma_f32_32x32x16_bf16 v[72:87], v[24:27], v[16:19], v[152:167]
v_exp_f32 v56, v56
v_exp_f32 v57, v57
ds_read_b128 v[32:35], v2 offset:53248
ds_read_b128 v[36:39], v2 offset:54272
ds_read_b128 v[40:43], v2 offset:51200
ds_read_b128 v[44:47], v2 offset:52224
v_exp_f32 v58, v58
v_exp_f32 v59, v59
v_mfma_f32_32x32x16_bf16 v[72:87], v[28:31], v[20:23], v[72:87]
v_exp_f32 v60, v60
v_exp_f32 v61, v61
v_exp_f32 v62, v62
v_exp_f32 v63, v63
v_mfma_f32_32x32x16_bf16 v[120:135], v[48:51], v[96:99], v[120:135]
v_cvt_pk_bf16_f32 v88, v56, v57
v_cvt_pk_bf16_f32 v89, v58, v59
v_exp_f32 v64, v64
v_exp_f32 v65, v65
v_mfma_f32_16x16x32_bf16 v[172:175], v[176:179], v[96:99], v[172:175]
v_exp_f32 v66, v66
v_exp_f32 v67, v67
v_mfma_f32_32x32x16_bf16 v[120:135], v[52:55], v[100:103], v[120:135]
v_cvt_pk_bf16_f32 v90, v60, v61
v_cvt_pk_bf16_f32 v91, v62, v63
v_exp_f32 v68, v68
v_exp_f32 v69, v69
v_mfma_f32_16x16x32_bf16 v[172:175], v[176:179], v[100:103], v[172:175]
v_exp_f32 v70, v70
v_exp_f32 v71, v71
v_cvt_pk_bf16_f32 v92, v64, v65
v_cvt_pk_bf16_f32 v93, v66, v67
v_cvt_pk_bf16_f32 v94, v68, v69
v_cvt_pk_bf16_f32 v95, v70, v71
s_waitcnt lgkmcnt(0)
v_mfma_f32_32x32x16_bf16 v[56:71], v[32:35], v[8:11], v[136:151]
v_exp_f32 v72, v72
v_exp_f32 v73, v73
v_exp_f32 v74, v74
v_exp_f32 v75, v75
v_mfma_f32_32x32x16_bf16 v[56:71], v[36:39], v[12:15], v[56:71]
v_exp_f32 v76, v76
v_exp_f32 v77, v77
v_exp_f32 v78, v78
v_exp_f32 v79, v79
v_mfma_f32_32x32x16_bf16 v[104:119], v[40:43], v[88:91], v[104:119]
v_cvt_pk_bf16_f32 v96, v72, v73
v_cvt_pk_bf16_f32 v97, v74, v75
v_exp_f32 v80, v80
v_exp_f32 v81, v81
v_mfma_f32_16x16x32_bf16 v[168:171], v[176:179], v[88:91], v[168:171]
v_exp_f32 v82, v82
v_exp_f32 v83, v83
v_mfma_f32_32x32x16_bf16 v[104:119], v[44:47], v[92:95], v[104:119]
v_cvt_pk_bf16_f32 v98, v76, v77
v_cvt_pk_bf16_f32 v99, v78, v79
v_exp_f32 v84, v84
v_exp_f32 v85, v85
v_mfma_f32_16x16x32_bf16 v[168:171], v[176:179], v[92:95], v[168:171]
v_exp_f32 v86, v86
v_exp_f32 v87, v87
v_cvt_pk_bf16_f32 v100, v80, v81
v_cvt_pk_bf16_f32 v101, v82, v83
v_cvt_pk_bf16_f32 v102, v84, v85
v_cvt_pk_bf16_f32 v103, v86, v87
v_mfma_f32_32x32x16_bf16 v[72:87], v[32:35], v[16:19], v[152:167]
v_exp_f32 v56, v56
v_exp_f32 v57, v57
ds_read_b128 v[24:27], v2 offset:57344
ds_read_b128 v[28:31], v2 offset:58368
ds_read_b128 v[48:51], v2 offset:55296
ds_read_b128 v[52:55], v2 offset:56320
v_exp_f32 v58, v58
v_exp_f32 v59, v59
v_mfma_f32_32x32x16_bf16 v[72:87], v[36:39], v[20:23], v[72:87]
v_exp_f32 v60, v60
v_exp_f32 v61, v61
v_exp_f32 v62, v62
v_exp_f32 v63, v63
v_mfma_f32_32x32x16_bf16 v[120:135], v[40:43], v[96:99], v[120:135]
v_cvt_pk_bf16_f32 v88, v56, v57
v_cvt_pk_bf16_f32 v89, v58, v59
v_exp_f32 v64, v64
v_exp_f32 v65, v65
v_mfma_f32_16x16x32_bf16 v[172:175], v[176:179], v[96:99], v[172:175]
v_exp_f32 v66, v66
v_exp_f32 v67, v67
v_mfma_f32_32x32x16_bf16 v[120:135], v[44:47], v[100:103], v[120:135]
v_cvt_pk_bf16_f32 v90, v60, v61
v_cvt_pk_bf16_f32 v91, v62, v63
v_exp_f32 v68, v68
v_exp_f32 v69, v69
v_mfma_f32_16x16x32_bf16 v[172:175], v[176:179], v[100:103], v[172:175]
v_exp_f32 v70, v70
v_exp_f32 v71, v71
v_cvt_pk_bf16_f32 v92, v64, v65
v_cvt_pk_bf16_f32 v93, v66, v67
v_cvt_pk_bf16_f32 v94, v68, v69
v_cvt_pk_bf16_f32 v95, v70, v71
s_waitcnt lgkmcnt(0)
v_mfma_f32_32x32x16_bf16 v[56:71], v[24:27], v[8:11], v[136:151]
v_exp_f32 v72, v72
v_exp_f32 v73, v73
v_exp_f32 v74, v74
v_exp_f32 v75, v75
v_mfma_f32_32x32x16_bf16 v[56:71], v[28:31], v[12:15], v[56:71]
v_exp_f32 v76, v76
v_exp_f32 v77, v77
v_exp_f32 v78, v78
v_exp_f32 v79, v79
v_mfma_f32_32x32x16_bf16 v[104:119], v[48:51], v[88:91], v[104:119]
v_cvt_pk_bf16_f32 v96, v72, v73
v_cvt_pk_bf16_f32 v97, v74, v75
v_exp_f32 v80, v80
v_exp_f32 v81, v81
v_mfma_f32_16x16x32_bf16 v[168:171], v[176:179], v[88:91], v[168:171]
v_exp_f32 v82, v82
v_exp_f32 v83, v83
v_mfma_f32_32x32x16_bf16 v[104:119], v[52:55], v[92:95], v[104:119]
v_cvt_pk_bf16_f32 v98, v76, v77
v_cvt_pk_bf16_f32 v99, v78, v79
v_exp_f32 v84, v84
v_exp_f32 v85, v85
v_mfma_f32_16x16x32_bf16 v[168:171], v[176:179], v[92:95], v[168:171]
v_exp_f32 v86, v86
v_exp_f32 v87, v87
v_cvt_pk_bf16_f32 v100, v80, v81
v_cvt_pk_bf16_f32 v101, v82, v83
v_cvt_pk_bf16_f32 v102, v84, v85
v_cvt_pk_bf16_f32 v103, v86, v87
v_mfma_f32_32x32x16_bf16 v[72:87], v[24:27], v[16:19], v[152:167]
v_exp_f32 v56, v56
v_exp_f32 v57, v57
ds_read_b128 v[32:35], v2 offset:61440
ds_read_b128 v[36:39], v2 offset:62464
ds_read_b128 v[40:43], v2 offset:59392
ds_read_b128 v[44:47], v2 offset:60416
v_exp_f32 v58, v58
v_exp_f32 v59, v59
v_mfma_f32_32x32x16_bf16 v[72:87], v[28:31], v[20:23], v[72:87]
v_exp_f32 v60, v60
v_exp_f32 v61, v61
v_exp_f32 v62, v62
v_exp_f32 v63, v63
v_mfma_f32_32x32x16_bf16 v[120:135], v[48:51], v[96:99], v[120:135]
v_cvt_pk_bf16_f32 v88, v56, v57
v_cvt_pk_bf16_f32 v89, v58, v59
v_exp_f32 v64, v64
v_exp_f32 v65, v65
v_mfma_f32_16x16x32_bf16 v[172:175], v[176:179], v[96:99], v[172:175]
v_exp_f32 v66, v66
v_exp_f32 v67, v67
v_mfma_f32_32x32x16_bf16 v[120:135], v[52:55], v[100:103], v[120:135]
v_cvt_pk_bf16_f32 v90, v60, v61
v_cvt_pk_bf16_f32 v91, v62, v63
v_exp_f32 v68, v68
v_exp_f32 v69, v69
v_mfma_f32_16x16x32_bf16 v[172:175], v[176:179], v[100:103], v[172:175]
v_exp_f32 v70, v70
v_exp_f32 v71, v71
v_cvt_pk_bf16_f32 v92, v64, v65
v_cvt_pk_bf16_f32 v93, v66, v67
v_cvt_pk_bf16_f32 v94, v68, v69
v_cvt_pk_bf16_f32 v95, v70, v71
s_waitcnt lgkmcnt(0)
v_mfma_f32_32x32x16_bf16 v[56:71], v[32:35], v[8:11], v[136:151]
v_exp_f32 v72, v72
v_exp_f32 v73, v73
v_exp_f32 v74, v74
v_exp_f32 v75, v75
v_mfma_f32_32x32x16_bf16 v[56:71], v[36:39], v[12:15], v[56:71]
v_exp_f32 v76, v76
v_exp_f32 v77, v77
v_exp_f32 v78, v78
v_exp_f32 v79, v79
v_mfma_f32_32x32x16_bf16 v[104:119], v[40:43], v[88:91], v[104:119]
v_cvt_pk_bf16_f32 v96, v72, v73
v_cvt_pk_bf16_f32 v97, v74, v75
v_exp_f32 v80, v80
v_exp_f32 v81, v81
v_mfma_f32_16x16x32_bf16 v[168:171], v[176:179], v[88:91], v[168:171]
v_exp_f32 v82, v82
v_exp_f32 v83, v83
v_mfma_f32_32x32x16_bf16 v[104:119], v[44:47], v[92:95], v[104:119]
v_cvt_pk_bf16_f32 v98, v76, v77
v_cvt_pk_bf16_f32 v99, v78, v79
v_exp_f32 v84, v84
v_exp_f32 v85, v85
v_mfma_f32_16x16x32_bf16 v[168:171], v[176:179], v[92:95], v[168:171]
v_exp_f32 v86, v86
v_exp_f32 v87, v87
v_cvt_pk_bf16_f32 v100, v80, v81
v_cvt_pk_bf16_f32 v101, v82, v83
v_cvt_pk_bf16_f32 v102, v84, v85
v_cvt_pk_bf16_f32 v103, v86, v87
s_waitcnt vmcnt(4)
s_barrier
v_mfma_f32_32x32x16_bf16 v[72:87], v[32:35], v[16:19], v[152:167]
v_exp_f32 v56, v56
v_exp_f32 v57, v57
ds_read_b128 v[24:27], v2 offset:0
ds_read_b128 v[28:31], v2 offset:1024
ds_read_b128 v[48:51], v2 offset:63488
ds_read_b128 v[52:55], v2 offset:64512
v_exp_f32 v58, v58
v_exp_f32 v59, v59
v_mfma_f32_32x32x16_bf16 v[72:87], v[36:39], v[20:23], v[72:87]
v_exp_f32 v60, v60
v_exp_f32 v61, v61
v_exp_f32 v62, v62
v_exp_f32 v63, v63
v_mfma_f32_32x32x16_bf16 v[120:135], v[40:43], v[96:99], v[120:135]
v_cvt_pk_bf16_f32 v88, v56, v57
v_cvt_pk_bf16_f32 v89, v58, v59
v_exp_f32 v64, v64
s_add_u32 m0, s16, 32768
s_nop 0
buffer_load_dwordx4 v3, s[8:11], s15 offen offset:0 lds
buffer_load_dwordx4 v3, s[8:11], s15 offen offset:1024 lds
buffer_load_dwordx4 v3, s[8:11], s15 offen offset:2048 lds
buffer_load_dwordx4 v3, s[8:11], s15 offen offset:3072 lds
s_add_u32 s15, s15, 16384
v_exp_f32 v65, v65
v_mfma_f32_16x16x32_bf16 v[172:175], v[176:179], v[96:99], v[172:175]
v_exp_f32 v66, v66
v_exp_f32 v67, v67
v_mfma_f32_32x32x16_bf16 v[120:135], v[44:47], v[100:103], v[120:135]
v_cvt_pk_bf16_f32 v90, v60, v61
v_cvt_pk_bf16_f32 v91, v62, v63
v_exp_f32 v68, v68
v_exp_f32 v69, v69
v_mfma_f32_16x16x32_bf16 v[172:175], v[176:179], v[100:103], v[172:175]
v_exp_f32 v70, v70
v_exp_f32 v71, v71
v_cvt_pk_bf16_f32 v92, v64, v65
v_cvt_pk_bf16_f32 v93, v66, v67
v_cvt_pk_bf16_f32 v94, v68, v69
v_cvt_pk_bf16_f32 v95, v70, v71
s_waitcnt lgkmcnt(0)
v_mfma_f32_32x32x16_bf16 v[56:71], v[24:27], v[8:11], v[136:151]
v_exp_f32 v72, v72
v_exp_f32 v73, v73
v_exp_f32 v74, v74
v_exp_f32 v75, v75
v_mfma_f32_32x32x16_bf16 v[56:71], v[28:31], v[12:15], v[56:71]
v_exp_f32 v76, v76
v_exp_f32 v77, v77
v_exp_f32 v78, v78
v_exp_f32 v79, v79
v_mfma_f32_32x32x16_bf16 v[104:119], v[48:51], v[88:91], v[104:119]
v_cvt_pk_bf16_f32 v96, v72, v73
v_cvt_pk_bf16_f32 v97, v74, v75
v_exp_f32 v80, v80
v_exp_f32 v81, v81
v_mfma_f32_16x16x32_bf16 v[168:171], v[176:179], v[88:91], v[168:171]
v_exp_f32 v82, v82
v_exp_f32 v83, v83
v_mfma_f32_32x32x16_bf16 v[104:119], v[52:55], v[92:95], v[104:119]
v_cvt_pk_bf16_f32 v98, v76, v77
v_cvt_pk_bf16_f32 v99, v78, v79
v_exp_f32 v84, v84
v_exp_f32 v85, v85
v_mfma_f32_16x16x32_bf16 v[168:171], v[176:179], v[92:95], v[168:171]
v_exp_f32 v86, v86
v_exp_f32 v87, v87
v_cvt_pk_bf16_f32 v100, v80, v81
v_cvt_pk_bf16_f32 v101, v82, v83
v_cvt_pk_bf16_f32 v102, v84, v85
v_cvt_pk_bf16_f32 v103, v86, v87
v_mfma_f32_32x32x16_bf16 v[72:87], v[24:27], v[16:19], v[152:167]
v_exp_f32 v56, v56
v_exp_f32 v57, v57
ds_read_b128 v[32:35], v2 offset:4096
ds_read_b128 v[36:39], v2 offset:5120
ds_read_b128 v[40:43], v2 offset:2048
ds_read_b128 v[44:47], v2 offset:3072
v_exp_f32 v58, v58
v_exp_f32 v59, v59
v_mfma_f32_32x32x16_bf16 v[72:87], v[28:31], v[20:23], v[72:87]
v_exp_f32 v60, v60
v_exp_f32 v61, v61
v_exp_f32 v62, v62
v_exp_f32 v63, v63
v_mfma_f32_32x32x16_bf16 v[120:135], v[48:51], v[96:99], v[120:135]
v_cvt_pk_bf16_f32 v88, v56, v57
v_cvt_pk_bf16_f32 v89, v58, v59
v_exp_f32 v64, v64
v_exp_f32 v65, v65
v_mfma_f32_16x16x32_bf16 v[172:175], v[176:179], v[96:99], v[172:175]
v_exp_f32 v66, v66
v_exp_f32 v67, v67
v_mfma_f32_32x32x16_bf16 v[120:135], v[52:55], v[100:103], v[120:135]
v_cvt_pk_bf16_f32 v90, v60, v61
v_cvt_pk_bf16_f32 v91, v62, v63
v_exp_f32 v68, v68
v_exp_f32 v69, v69
v_mfma_f32_16x16x32_bf16 v[172:175], v[176:179], v[100:103], v[172:175]
v_exp_f32 v70, v70
v_exp_f32 v71, v71
v_cvt_pk_bf16_f32 v92, v64, v65
v_cvt_pk_bf16_f32 v93, v66, v67
v_cvt_pk_bf16_f32 v94, v68, v69
v_cvt_pk_bf16_f32 v95, v70, v71
s_waitcnt lgkmcnt(0)
v_mfma_f32_32x32x16_bf16 v[56:71], v[32:35], v[8:11], v[136:151]
v_exp_f32 v72, v72
v_exp_f32 v73, v73
v_exp_f32 v74, v74
v_exp_f32 v75, v75
v_mfma_f32_32x32x16_bf16 v[56:71], v[36:39], v[12:15], v[56:71]
v_exp_f32 v76, v76
v_exp_f32 v77, v77
v_exp_f32 v78, v78
v_exp_f32 v79, v79
v_mfma_f32_32x32x16_bf16 v[104:119], v[40:43], v[88:91], v[104:119]
v_cvt_pk_bf16_f32 v96, v72, v73
v_cvt_pk_bf16_f32 v97, v74, v75
v_exp_f32 v80, v80
v_exp_f32 v81, v81
v_mfma_f32_16x16x32_bf16 v[168:171], v[176:179], v[88:91], v[168:171]
v_exp_f32 v82, v82
v_exp_f32 v83, v83
v_mfma_f32_32x32x16_bf16 v[104:119], v[44:47], v[92:95], v[104:119]
v_cvt_pk_bf16_f32 v98, v76, v77
v_cvt_pk_bf16_f32 v99, v78, v79
v_exp_f32 v84, v84
v_exp_f32 v85, v85
v_mfma_f32_16x16x32_bf16 v[168:171], v[176:179], v[92:95], v[168:171]
v_exp_f32 v86, v86
v_exp_f32 v87, v87
v_cvt_pk_bf16_f32 v100, v80, v81
v_cvt_pk_bf16_f32 v101, v82, v83
v_cvt_pk_bf16_f32 v102, v84, v85
v_cvt_pk_bf16_f32 v103, v86, v87
v_mfma_f32_32x32x16_bf16 v[72:87], v[32:35], v[16:19], v[152:167]
v_exp_f32 v56, v56
v_exp_f32 v57, v57
ds_read_b128 v[24:27], v2 offset:8192
ds_read_b128 v[28:31], v2 offset:9216
ds_read_b128 v[48:51], v2 offset:6144
ds_read_b128 v[52:55], v2 offset:7168
v_exp_f32 v58, v58
v_exp_f32 v59, v59
v_mfma_f32_32x32x16_bf16 v[72:87], v[36:39], v[20:23], v[72:87]
v_exp_f32 v60, v60
v_exp_f32 v61, v61
v_exp_f32 v62, v62
v_exp_f32 v63, v63
v_mfma_f32_32x32x16_bf16 v[120:135], v[40:43], v[96:99], v[120:135]
v_cvt_pk_bf16_f32 v88, v56, v57
v_cvt_pk_bf16_f32 v89, v58, v59
v_exp_f32 v64, v64
v_exp_f32 v65, v65
v_mfma_f32_16x16x32_bf16 v[172:175], v[176:179], v[96:99], v[172:175]
v_exp_f32 v66, v66
v_exp_f32 v67, v67
v_mfma_f32_32x32x16_bf16 v[120:135], v[44:47], v[100:103], v[120:135]
v_cvt_pk_bf16_f32 v90, v60, v61
v_cvt_pk_bf16_f32 v91, v62, v63
v_exp_f32 v68, v68
v_exp_f32 v69, v69
v_mfma_f32_16x16x32_bf16 v[172:175], v[176:179], v[100:103], v[172:175]
v_exp_f32 v70, v70
v_exp_f32 v71, v71
v_cvt_pk_bf16_f32 v92, v64, v65
v_cvt_pk_bf16_f32 v93, v66, v67
v_cvt_pk_bf16_f32 v94, v68, v69
v_cvt_pk_bf16_f32 v95, v70, v71
s_waitcnt lgkmcnt(0)
v_mfma_f32_32x32x16_bf16 v[56:71], v[24:27], v[8:11], v[136:151]
v_exp_f32 v72, v72
v_exp_f32 v73, v73
v_exp_f32 v74, v74
v_exp_f32 v75, v75
v_mfma_f32_32x32x16_bf16 v[56:71], v[28:31], v[12:15], v[56:71]
v_exp_f32 v76, v76
v_exp_f32 v77, v77
v_exp_f32 v78, v78
v_exp_f32 v79, v79
v_mfma_f32_32x32x16_bf16 v[104:119], v[48:51], v[88:91], v[104:119]
v_cvt_pk_bf16_f32 v96, v72, v73
v_cvt_pk_bf16_f32 v97, v74, v75
v_exp_f32 v80, v80
v_exp_f32 v81, v81
v_mfma_f32_16x16x32_bf16 v[168:171], v[176:179], v[88:91], v[168:171]
v_exp_f32 v82, v82
v_exp_f32 v83, v83
v_mfma_f32_32x32x16_bf16 v[104:119], v[52:55], v[92:95], v[104:119]
v_cvt_pk_bf16_f32 v98, v76, v77
v_cvt_pk_bf16_f32 v99, v78, v79
v_exp_f32 v84, v84
v_exp_f32 v85, v85
v_mfma_f32_16x16x32_bf16 v[168:171], v[176:179], v[92:95], v[168:171]
v_exp_f32 v86, v86
v_exp_f32 v87, v87
v_cvt_pk_bf16_f32 v100, v80, v81
v_cvt_pk_bf16_f32 v101, v82, v83
v_cvt_pk_bf16_f32 v102, v84, v85
v_cvt_pk_bf16_f32 v103, v86, v87
v_mfma_f32_32x32x16_bf16 v[72:87], v[24:27], v[16:19], v[152:167]
v_exp_f32 v56, v56
v_exp_f32 v57, v57
ds_read_b128 v[32:35], v2 offset:12288
ds_read_b128 v[36:39], v2 offset:13312
ds_read_b128 v[40:43], v2 offset:10240
ds_read_b128 v[44:47], v2 offset:11264
v_exp_f32 v58, v58
v_exp_f32 v59, v59
v_mfma_f32_32x32x16_bf16 v[72:87], v[28:31], v[20:23], v[72:87]
v_exp_f32 v60, v60
v_exp_f32 v61, v61
v_exp_f32 v62, v62
v_exp_f32 v63, v63
v_mfma_f32_32x32x16_bf16 v[120:135], v[48:51], v[96:99], v[120:135]
v_cvt_pk_bf16_f32 v88, v56, v57
v_cvt_pk_bf16_f32 v89, v58, v59
v_exp_f32 v64, v64
v_exp_f32 v65, v65
v_mfma_f32_16x16x32_bf16 v[172:175], v[176:179], v[96:99], v[172:175]
v_exp_f32 v66, v66
v_exp_f32 v67, v67
v_mfma_f32_32x32x16_bf16 v[120:135], v[52:55], v[100:103], v[120:135]
v_cvt_pk_bf16_f32 v90, v60, v61
v_cvt_pk_bf16_f32 v91, v62, v63
v_exp_f32 v68, v68
v_exp_f32 v69, v69
v_mfma_f32_16x16x32_bf16 v[172:175], v[176:179], v[100:103], v[172:175]
v_exp_f32 v70, v70
v_exp_f32 v71, v71
v_cvt_pk_bf16_f32 v92, v64, v65
v_cvt_pk_bf16_f32 v93, v66, v67
v_cvt_pk_bf16_f32 v94, v68, v69
v_cvt_pk_bf16_f32 v95, v70, v71
s_waitcnt lgkmcnt(0)
v_mfma_f32_32x32x16_bf16 v[56:71], v[32:35], v[8:11], v[136:151]
v_exp_f32 v72, v72
v_exp_f32 v73, v73
v_exp_f32 v74, v74
v_exp_f32 v75, v75
v_mfma_f32_32x32x16_bf16 v[56:71], v[36:39], v[12:15], v[56:71]
v_exp_f32 v76, v76
v_exp_f32 v77, v77
v_exp_f32 v78, v78
v_exp_f32 v79, v79
v_mfma_f32_32x32x16_bf16 v[104:119], v[40:43], v[88:91], v[104:119]
v_cvt_pk_bf16_f32 v96, v72, v73
v_cvt_pk_bf16_f32 v97, v74, v75
v_exp_f32 v80, v80
v_exp_f32 v81, v81
v_mfma_f32_16x16x32_bf16 v[168:171], v[176:179], v[88:91], v[168:171]
v_exp_f32 v82, v82
v_exp_f32 v83, v83
v_mfma_f32_32x32x16_bf16 v[104:119], v[44:47], v[92:95], v[104:119]
v_cvt_pk_bf16_f32 v98, v76, v77
v_cvt_pk_bf16_f32 v99, v78, v79
v_exp_f32 v84, v84
v_exp_f32 v85, v85
v_mfma_f32_16x16x32_bf16 v[168:171], v[176:179], v[92:95], v[168:171]
v_exp_f32 v86, v86
v_exp_f32 v87, v87
v_cvt_pk_bf16_f32 v100, v80, v81
v_cvt_pk_bf16_f32 v101, v82, v83
v_cvt_pk_bf16_f32 v102, v84, v85
v_cvt_pk_bf16_f32 v103, v86, v87
s_waitcnt vmcnt(4)
s_barrier
v_mfma_f32_32x32x16_bf16 v[72:87], v[32:35], v[16:19], v[152:167]
v_exp_f32 v56, v56
v_exp_f32 v57, v57
ds_read_b128 v[24:27], v2 offset:16384
ds_read_b128 v[28:31], v2 offset:17408
ds_read_b128 v[48:51], v2 offset:14336
ds_read_b128 v[52:55], v2 offset:15360
v_exp_f32 v58, v58
v_exp_f32 v59, v59
v_mfma_f32_32x32x16_bf16 v[72:87], v[36:39], v[20:23], v[72:87]
v_exp_f32 v60, v60
v_exp_f32 v61, v61
v_exp_f32 v62, v62
v_exp_f32 v63, v63
v_mfma_f32_32x32x16_bf16 v[120:135], v[40:43], v[96:99], v[120:135]
v_cvt_pk_bf16_f32 v88, v56, v57
v_cvt_pk_bf16_f32 v89, v58, v59
v_exp_f32 v64, v64
s_add_u32 m0, s16, 49152
s_nop 0
buffer_load_dwordx4 v3, s[8:11], s15 offen offset:0 lds
buffer_load_dwordx4 v3, s[8:11], s15 offen offset:1024 lds
buffer_load_dwordx4 v3, s[8:11], s15 offen offset:2048 lds
buffer_load_dwordx4 v3, s[8:11], s15 offen offset:3072 lds
s_add_u32 s15, s15, 16384
v_exp_f32 v65, v65
v_mfma_f32_16x16x32_bf16 v[172:175], v[176:179], v[96:99], v[172:175]
v_exp_f32 v66, v66
v_exp_f32 v67, v67
v_mfma_f32_32x32x16_bf16 v[120:135], v[44:47], v[100:103], v[120:135]
v_cvt_pk_bf16_f32 v90, v60, v61
v_cvt_pk_bf16_f32 v91, v62, v63
v_exp_f32 v68, v68
v_exp_f32 v69, v69
v_mfma_f32_16x16x32_bf16 v[172:175], v[176:179], v[100:103], v[172:175]
v_exp_f32 v70, v70
v_exp_f32 v71, v71
v_cvt_pk_bf16_f32 v92, v64, v65
v_cvt_pk_bf16_f32 v93, v66, v67
v_cvt_pk_bf16_f32 v94, v68, v69
v_cvt_pk_bf16_f32 v95, v70, v71
s_waitcnt lgkmcnt(0)
v_mfma_f32_32x32x16_bf16 v[56:71], v[24:27], v[8:11], v[136:151]
v_exp_f32 v72, v72
v_exp_f32 v73, v73
v_exp_f32 v74, v74
v_exp_f32 v75, v75
v_mfma_f32_32x32x16_bf16 v[56:71], v[28:31], v[12:15], v[56:71]
v_exp_f32 v76, v76
v_exp_f32 v77, v77
v_exp_f32 v78, v78
v_exp_f32 v79, v79
v_mfma_f32_32x32x16_bf16 v[104:119], v[48:51], v[88:91], v[104:119]
v_cvt_pk_bf16_f32 v96, v72, v73
v_cvt_pk_bf16_f32 v97, v74, v75
v_exp_f32 v80, v80
v_exp_f32 v81, v81
v_mfma_f32_16x16x32_bf16 v[168:171], v[176:179], v[88:91], v[168:171]
v_exp_f32 v82, v82
v_exp_f32 v83, v83
v_mfma_f32_32x32x16_bf16 v[104:119], v[52:55], v[92:95], v[104:119]
v_cvt_pk_bf16_f32 v98, v76, v77
v_cvt_pk_bf16_f32 v99, v78, v79
v_exp_f32 v84, v84
v_exp_f32 v85, v85
v_mfma_f32_16x16x32_bf16 v[168:171], v[176:179], v[92:95], v[168:171]
v_exp_f32 v86, v86
v_exp_f32 v87, v87
v_cvt_pk_bf16_f32 v100, v80, v81
v_cvt_pk_bf16_f32 v101, v82, v83
v_cvt_pk_bf16_f32 v102, v84, v85
v_cvt_pk_bf16_f32 v103, v86, v87
v_mfma_f32_32x32x16_bf16 v[72:87], v[24:27], v[16:19], v[152:167]
v_exp_f32 v56, v56
v_exp_f32 v57, v57
ds_read_b128 v[32:35], v2 offset:20480
ds_read_b128 v[36:39], v2 offset:21504
ds_read_b128 v[40:43], v2 offset:18432
ds_read_b128 v[44:47], v2 offset:19456
v_exp_f32 v58, v58
v_exp_f32 v59, v59
v_mfma_f32_32x32x16_bf16 v[72:87], v[28:31], v[20:23], v[72:87]
v_exp_f32 v60, v60
v_exp_f32 v61, v61
v_exp_f32 v62, v62
v_exp_f32 v63, v63
v_mfma_f32_32x32x16_bf16 v[120:135], v[48:51], v[96:99], v[120:135]
v_cvt_pk_bf16_f32 v88, v56, v57
v_cvt_pk_bf16_f32 v89, v58, v59
v_exp_f32 v64, v64
v_exp_f32 v65, v65
v_mfma_f32_16x16x32_bf16 v[172:175], v[176:179], v[96:99], v[172:175]
v_exp_f32 v66, v66
v_exp_f32 v67, v67
v_mfma_f32_32x32x16_bf16 v[120:135], v[52:55], v[100:103], v[120:135]
v_cvt_pk_bf16_f32 v90, v60, v61
v_cvt_pk_bf16_f32 v91, v62, v63
v_exp_f32 v68, v68
v_exp_f32 v69, v69
v_mfma_f32_16x16x32_bf16 v[172:175], v[176:179], v[100:103], v[172:175]
v_exp_f32 v70, v70
v_exp_f32 v71, v71
v_cvt_pk_bf16_f32 v92, v64, v65
v_cvt_pk_bf16_f32 v93, v66, v67
v_cvt_pk_bf16_f32 v94, v68, v69
v_cvt_pk_bf16_f32 v95, v70, v71
s_waitcnt lgkmcnt(0)
v_mfma_f32_32x32x16_bf16 v[56:71], v[32:35], v[8:11], v[136:151]
v_exp_f32 v72, v72
v_exp_f32 v73, v73
v_exp_f32 v74, v74
v_exp_f32 v75, v75
v_mfma_f32_32x32x16_bf16 v[56:71], v[36:39], v[12:15], v[56:71]
v_exp_f32 v76, v76
v_exp_f32 v77, v77
v_exp_f32 v78, v78
v_exp_f32 v79, v79
v_mfma_f32_32x32x16_bf16 v[104:119], v[40:43], v[88:91], v[104:119]
v_cvt_pk_bf16_f32 v96, v72, v73
v_cvt_pk_bf16_f32 v97, v74, v75
v_exp_f32 v80, v80
v_exp_f32 v81, v81
v_mfma_f32_16x16x32_bf16 v[168:171], v[176:179], v[88:91], v[168:171]
v_exp_f32 v82, v82
v_exp_f32 v83, v83
v_mfma_f32_32x32x16_bf16 v[104:119], v[44:47], v[92:95], v[104:119]
v_cvt_pk_bf16_f32 v98, v76, v77
v_cvt_pk_bf16_f32 v99, v78, v79
v_exp_f32 v84, v84
v_exp_f32 v85, v85
v_mfma_f32_16x16x32_bf16 v[168:171], v[176:179], v[92:95], v[168:171]
v_exp_f32 v86, v86
v_exp_f32 v87, v87
v_cvt_pk_bf16_f32 v100, v80, v81
v_cvt_pk_bf16_f32 v101, v82, v83
v_cvt_pk_bf16_f32 v102, v84, v85
v_cvt_pk_bf16_f32 v103, v86, v87
v_mfma_f32_32x32x16_bf16 v[72:87], v[32:35], v[16:19], v[152:167]
v_exp_f32 v56, v56
v_exp_f32 v57, v57
ds_read_b128 v[24:27], v2 offset:24576
ds_read_b128 v[28:31], v2 offset:25600
ds_read_b128 v[48:51], v2 offset:22528
ds_read_b128 v[52:55], v2 offset:23552
v_exp_f32 v58, v58
v_exp_f32 v59, v59
v_mfma_f32_32x32x16_bf16 v[72:87], v[36:39], v[20:23], v[72:87]
v_exp_f32 v60, v60
v_exp_f32 v61, v61
v_exp_f32 v62, v62
v_exp_f32 v63, v63
v_mfma_f32_32x32x16_bf16 v[120:135], v[40:43], v[96:99], v[120:135]
v_cvt_pk_bf16_f32 v88, v56, v57
v_cvt_pk_bf16_f32 v89, v58, v59
v_exp_f32 v64, v64
v_exp_f32 v65, v65
v_mfma_f32_16x16x32_bf16 v[172:175], v[176:179], v[96:99], v[172:175]
v_exp_f32 v66, v66
v_exp_f32 v67, v67
v_mfma_f32_32x32x16_bf16 v[120:135], v[44:47], v[100:103], v[120:135]
v_cvt_pk_bf16_f32 v90, v60, v61
v_cvt_pk_bf16_f32 v91, v62, v63
v_exp_f32 v68, v68
v_exp_f32 v69, v69
v_mfma_f32_16x16x32_bf16 v[172:175], v[176:179], v[100:103], v[172:175]
v_exp_f32 v70, v70
v_exp_f32 v71, v71
v_cvt_pk_bf16_f32 v92, v64, v65
v_cvt_pk_bf16_f32 v93, v66, v67
v_cvt_pk_bf16_f32 v94, v68, v69
v_cvt_pk_bf16_f32 v95, v70, v71
s_waitcnt lgkmcnt(0)
v_mfma_f32_32x32x16_bf16 v[56:71], v[24:27], v[8:11], v[136:151]
v_exp_f32 v72, v72
v_exp_f32 v73, v73
v_exp_f32 v74, v74
v_exp_f32 v75, v75
v_mfma_f32_32x32x16_bf16 v[56:71], v[28:31], v[12:15], v[56:71]
v_exp_f32 v76, v76
v_exp_f32 v77, v77
v_exp_f32 v78, v78
v_exp_f32 v79, v79
v_mfma_f32_32x32x16_bf16 v[104:119], v[48:51], v[88:91], v[104:119]
v_cvt_pk_bf16_f32 v96, v72, v73
v_cvt_pk_bf16_f32 v97, v74, v75
v_exp_f32 v80, v80
v_exp_f32 v81, v81
v_mfma_f32_16x16x32_bf16 v[168:171], v[176:179], v[88:91], v[168:171]
v_exp_f32 v82, v82
v_exp_f32 v83, v83
v_mfma_f32_32x32x16_bf16 v[104:119], v[52:55], v[92:95], v[104:119]
v_cvt_pk_bf16_f32 v98, v76, v77
v_cvt_pk_bf16_f32 v99, v78, v79
v_exp_f32 v84, v84
v_exp_f32 v85, v85
v_mfma_f32_16x16x32_bf16 v[168:171], v[176:179], v[92:95], v[168:171]
v_exp_f32 v86, v86
v_exp_f32 v87, v87
v_cvt_pk_bf16_f32 v100, v80, v81
v_cvt_pk_bf16_f32 v101, v82, v83
v_cvt_pk_bf16_f32 v102, v84, v85
v_cvt_pk_bf16_f32 v103, v86, v87
v_mfma_f32_32x32x16_bf16 v[72:87], v[24:27], v[16:19], v[152:167]
v_exp_f32 v56, v56
v_exp_f32 v57, v57
ds_read_b128 v[32:35], v2 offset:28672
ds_read_b128 v[36:39], v2 offset:29696
ds_read_b128 v[40:43], v2 offset:26624
ds_read_b128 v[44:47], v2 offset:27648
v_exp_f32 v58, v58
v_exp_f32 v59, v59
v_mfma_f32_32x32x16_bf16 v[72:87], v[28:31], v[20:23], v[72:87]
v_exp_f32 v60, v60
v_exp_f32 v61, v61
v_exp_f32 v62, v62
v_exp_f32 v63, v63
v_mfma_f32_32x32x16_bf16 v[120:135], v[48:51], v[96:99], v[120:135]
v_cvt_pk_bf16_f32 v88, v56, v57
v_cvt_pk_bf16_f32 v89, v58, v59
v_exp_f32 v64, v64
v_exp_f32 v65, v65
v_mfma_f32_16x16x32_bf16 v[172:175], v[176:179], v[96:99], v[172:175]
v_exp_f32 v66, v66
v_exp_f32 v67, v67
v_mfma_f32_32x32x16_bf16 v[120:135], v[52:55], v[100:103], v[120:135]
v_cvt_pk_bf16_f32 v90, v60, v61
v_cvt_pk_bf16_f32 v91, v62, v63
v_exp_f32 v68, v68
v_exp_f32 v69, v69
v_mfma_f32_16x16x32_bf16 v[172:175], v[176:179], v[100:103], v[172:175]
v_exp_f32 v70, v70
v_exp_f32 v71, v71
v_cvt_pk_bf16_f32 v92, v64, v65
v_cvt_pk_bf16_f32 v93, v66, v67
v_cvt_pk_bf16_f32 v94, v68, v69
v_cvt_pk_bf16_f32 v95, v70, v71
s_waitcnt lgkmcnt(0)
v_mfma_f32_32x32x16_bf16 v[56:71], v[32:35], v[8:11], v[136:151]
v_exp_f32 v72, v72
v_exp_f32 v73, v73
v_exp_f32 v74, v74
v_exp_f32 v75, v75
v_mfma_f32_32x32x16_bf16 v[56:71], v[36:39], v[12:15], v[56:71]
v_exp_f32 v76, v76
v_exp_f32 v77, v77
v_exp_f32 v78, v78
v_exp_f32 v79, v79
v_mfma_f32_32x32x16_bf16 v[104:119], v[40:43], v[88:91], v[104:119]
v_cvt_pk_bf16_f32 v96, v72, v73
v_cvt_pk_bf16_f32 v97, v74, v75
v_exp_f32 v80, v80
v_exp_f32 v81, v81
v_mfma_f32_16x16x32_bf16 v[168:171], v[176:179], v[88:91], v[168:171]
v_exp_f32 v82, v82
v_exp_f32 v83, v83
v_mfma_f32_32x32x16_bf16 v[104:119], v[44:47], v[92:95], v[104:119]
v_cvt_pk_bf16_f32 v98, v76, v77
v_cvt_pk_bf16_f32 v99, v78, v79
v_exp_f32 v84, v84
v_exp_f32 v85, v85
v_mfma_f32_16x16x32_bf16 v[168:171], v[176:179], v[92:95], v[168:171]
v_exp_f32 v86, v86
v_exp_f32 v87, v87
v_cvt_pk_bf16_f32 v100, v80, v81
v_cvt_pk_bf16_f32 v101, v82, v83
v_cvt_pk_bf16_f32 v102, v84, v85
v_cvt_pk_bf16_f32 v103, v86, v87
s_waitcnt vmcnt(4)
s_barrier
v_mfma_f32_32x32x16_bf16 v[72:87], v[32:35], v[16:19], v[152:167]
v_exp_f32 v56, v56
v_exp_f32 v57, v57
ds_read_b128 v[24:27], v2 offset:32768
ds_read_b128 v[28:31], v2 offset:33792
ds_read_b128 v[48:51], v2 offset:30720
ds_read_b128 v[52:55], v2 offset:31744
v_exp_f32 v58, v58
v_exp_f32 v59, v59
v_mfma_f32_32x32x16_bf16 v[72:87], v[36:39], v[20:23], v[72:87]
v_exp_f32 v60, v60
v_exp_f32 v61, v61
v_exp_f32 v62, v62
v_exp_f32 v63, v63
v_mfma_f32_32x32x16_bf16 v[120:135], v[40:43], v[96:99], v[120:135]
v_cvt_pk_bf16_f32 v88, v56, v57
v_cvt_pk_bf16_f32 v89, v58, v59
v_exp_f32 v64, v64
v_exp_f32 v65, v65
v_mfma_f32_16x16x32_bf16 v[172:175], v[176:179], v[96:99], v[172:175]
v_exp_f32 v66, v66
v_exp_f32 v67, v67
v_mfma_f32_32x32x16_bf16 v[120:135], v[44:47], v[100:103], v[120:135]
v_cvt_pk_bf16_f32 v90, v60, v61
v_cvt_pk_bf16_f32 v91, v62, v63
v_exp_f32 v68, v68
v_exp_f32 v69, v69
v_mfma_f32_16x16x32_bf16 v[172:175], v[176:179], v[100:103], v[172:175]
v_exp_f32 v70, v70
v_exp_f32 v71, v71
v_cvt_pk_bf16_f32 v92, v64, v65
v_cvt_pk_bf16_f32 v93, v66, v67
v_cvt_pk_bf16_f32 v94, v68, v69
v_cvt_pk_bf16_f32 v95, v70, v71
s_waitcnt lgkmcnt(0)
v_mfma_f32_32x32x16_bf16 v[56:71], v[24:27], v[8:11], v[136:151]
v_exp_f32 v72, v72
v_exp_f32 v73, v73
v_exp_f32 v74, v74
v_exp_f32 v75, v75
v_mfma_f32_32x32x16_bf16 v[56:71], v[28:31], v[12:15], v[56:71]
v_exp_f32 v76, v76
v_exp_f32 v77, v77
v_exp_f32 v78, v78
v_exp_f32 v79, v79
v_mfma_f32_32x32x16_bf16 v[104:119], v[48:51], v[88:91], v[104:119]
v_cvt_pk_bf16_f32 v96, v72, v73
v_cvt_pk_bf16_f32 v97, v74, v75
v_exp_f32 v80, v80
v_exp_f32 v81, v81
v_mfma_f32_16x16x32_bf16 v[168:171], v[176:179], v[88:91], v[168:171]
v_exp_f32 v82, v82
v_exp_f32 v83, v83
v_mfma_f32_32x32x16_bf16 v[104:119], v[52:55], v[92:95], v[104:119]
v_cvt_pk_bf16_f32 v98, v76, v77
v_cvt_pk_bf16_f32 v99, v78, v79
v_exp_f32 v84, v84
buffer_load_dwordx4 v[188:191], v2, s[52:55], s48 offen
buffer_load_dwordx4 v[192:195], v2, s[52:55], s48 offen offset:1024
v_exp_f32 v85, v85
v_mfma_f32_16x16x32_bf16 v[168:171], v[176:179], v[92:95], v[168:171]
v_exp_f32 v86, v86
v_exp_f32 v87, v87
v_cvt_pk_bf16_f32 v100, v80, v81
v_cvt_pk_bf16_f32 v101, v82, v83
v_cvt_pk_bf16_f32 v102, v84, v85
v_cvt_pk_bf16_f32 v103, v86, v87
v_mfma_f32_32x32x16_bf16 v[72:87], v[24:27], v[16:19], v[152:167]
v_exp_f32 v56, v56
v_exp_f32 v57, v57
ds_read_b128 v[32:35], v2 offset:36864
ds_read_b128 v[36:39], v2 offset:37888
ds_read_b128 v[40:43], v2 offset:34816
ds_read_b128 v[44:47], v2 offset:35840
v_exp_f32 v58, v58
v_exp_f32 v59, v59
v_mfma_f32_32x32x16_bf16 v[72:87], v[28:31], v[20:23], v[72:87]
v_exp_f32 v60, v60
v_exp_f32 v61, v61
v_exp_f32 v62, v62
v_exp_f32 v63, v63
v_mfma_f32_32x32x16_bf16 v[120:135], v[48:51], v[96:99], v[120:135]
v_cvt_pk_bf16_f32 v88, v56, v57
v_cvt_pk_bf16_f32 v89, v58, v59
v_exp_f32 v64, v64
v_exp_f32 v65, v65
v_mfma_f32_16x16x32_bf16 v[172:175], v[176:179], v[96:99], v[172:175]
v_exp_f32 v66, v66
v_exp_f32 v67, v67
v_mfma_f32_32x32x16_bf16 v[120:135], v[52:55], v[100:103], v[120:135]
v_cvt_pk_bf16_f32 v90, v60, v61
v_cvt_pk_bf16_f32 v91, v62, v63
v_exp_f32 v68, v68
v_exp_f32 v69, v69
v_mfma_f32_16x16x32_bf16 v[172:175], v[176:179], v[100:103], v[172:175]
v_exp_f32 v70, v70
v_exp_f32 v71, v71
v_cvt_pk_bf16_f32 v92, v64, v65
v_cvt_pk_bf16_f32 v93, v66, v67
v_cvt_pk_bf16_f32 v94, v68, v69
v_cvt_pk_bf16_f32 v95, v70, v71
s_waitcnt lgkmcnt(0)
v_mfma_f32_32x32x16_bf16 v[56:71], v[32:35], v[8:11], v[136:151]
v_exp_f32 v72, v72
v_exp_f32 v73, v73
v_exp_f32 v74, v74
v_exp_f32 v75, v75
v_mfma_f32_32x32x16_bf16 v[56:71], v[36:39], v[12:15], v[56:71]
v_exp_f32 v76, v76
v_exp_f32 v77, v77
v_exp_f32 v78, v78
v_exp_f32 v79, v79
v_mfma_f32_32x32x16_bf16 v[104:119], v[40:43], v[88:91], v[104:119]
v_cvt_pk_bf16_f32 v96, v72, v73
v_cvt_pk_bf16_f32 v97, v74, v75
v_exp_f32 v80, v80
v_exp_f32 v81, v81
v_mfma_f32_16x16x32_bf16 v[168:171], v[176:179], v[88:91], v[168:171]
v_exp_f32 v82, v82
v_exp_f32 v83, v83
v_mfma_f32_32x32x16_bf16 v[104:119], v[44:47], v[92:95], v[104:119]
v_cvt_pk_bf16_f32 v98, v76, v77
v_cvt_pk_bf16_f32 v99, v78, v79
v_exp_f32 v84, v84
v_exp_f32 v85, v85
v_mfma_f32_16x16x32_bf16 v[168:171], v[176:179], v[92:95], v[168:171]
v_exp_f32 v86, v86
v_exp_f32 v87, v87
v_cvt_pk_bf16_f32 v100, v80, v81
v_cvt_pk_bf16_f32 v101, v82, v83
v_cvt_pk_bf16_f32 v102, v84, v85
v_cvt_pk_bf16_f32 v103, v86, v87
v_mfma_f32_32x32x16_bf16 v[72:87], v[32:35], v[16:19], v[152:167]
v_exp_f32 v56, v56
v_exp_f32 v57, v57
ds_read_b128 v[24:27], v2 offset:40960
ds_read_b128 v[28:31], v2 offset:41984
ds_read_b128 v[48:51], v2 offset:38912
ds_read_b128 v[52:55], v2 offset:39936
v_exp_f32 v58, v58
v_exp_f32 v59, v59
v_mfma_f32_32x32x16_bf16 v[72:87], v[36:39], v[20:23], v[72:87]
v_exp_f32 v60, v60
v_exp_f32 v61, v61
v_exp_f32 v62, v62
v_exp_f32 v63, v63
v_mfma_f32_32x32x16_bf16 v[120:135], v[40:43], v[96:99], v[120:135]
v_cvt_pk_bf16_f32 v88, v56, v57
v_cvt_pk_bf16_f32 v89, v58, v59
v_exp_f32 v64, v64
v_exp_f32 v65, v65
v_mfma_f32_16x16x32_bf16 v[172:175], v[176:179], v[96:99], v[172:175]
v_exp_f32 v66, v66
v_exp_f32 v67, v67
v_mfma_f32_32x32x16_bf16 v[120:135], v[44:47], v[100:103], v[120:135]
v_cvt_pk_bf16_f32 v90, v60, v61
v_cvt_pk_bf16_f32 v91, v62, v63
v_exp_f32 v68, v68
v_exp_f32 v69, v69
v_mfma_f32_16x16x32_bf16 v[172:175], v[176:179], v[100:103], v[172:175]
v_exp_f32 v70, v70
v_exp_f32 v71, v71
v_cvt_pk_bf16_f32 v92, v64, v65
v_cvt_pk_bf16_f32 v93, v66, v67
v_cvt_pk_bf16_f32 v94, v68, v69
v_cvt_pk_bf16_f32 v95, v70, v71
s_waitcnt lgkmcnt(0)
v_mfma_f32_32x32x16_bf16 v[56:71], v[24:27], v[8:11], v[136:151]
v_exp_f32 v72, v72
v_exp_f32 v73, v73
v_exp_f32 v74, v74
v_exp_f32 v75, v75
v_mfma_f32_32x32x16_bf16 v[56:71], v[28:31], v[12:15], v[56:71]
v_exp_f32 v76, v76
v_exp_f32 v77, v77
v_exp_f32 v78, v78
v_exp_f32 v79, v79
v_mfma_f32_32x32x16_bf16 v[104:119], v[48:51], v[88:91], v[104:119]
v_cvt_pk_bf16_f32 v96, v72, v73
v_cvt_pk_bf16_f32 v97, v74, v75
v_exp_f32 v80, v80
v_exp_f32 v81, v81
v_mfma_f32_16x16x32_bf16 v[168:171], v[176:179], v[88:91], v[168:171]
v_exp_f32 v82, v82
v_exp_f32 v83, v83
v_mfma_f32_32x32x16_bf16 v[104:119], v[52:55], v[92:95], v[104:119]
v_cvt_pk_bf16_f32 v98, v76, v77
v_cvt_pk_bf16_f32 v99, v78, v79
v_exp_f32 v84, v84
v_exp_f32 v85, v85
v_mfma_f32_16x16x32_bf16 v[168:171], v[176:179], v[92:95], v[168:171]
v_exp_f32 v86, v86
v_exp_f32 v87, v87
v_cvt_pk_bf16_f32 v100, v80, v81
v_cvt_pk_bf16_f32 v101, v82, v83
v_cvt_pk_bf16_f32 v102, v84, v85
v_cvt_pk_bf16_f32 v103, v86, v87
v_mfma_f32_32x32x16_bf16 v[72:87], v[24:27], v[16:19], v[152:167]
v_exp_f32 v56, v56
v_exp_f32 v57, v57
ds_read_b128 v[32:35], v2 offset:45056
ds_read_b128 v[36:39], v2 offset:46080
ds_read_b128 v[40:43], v2 offset:43008
ds_read_b128 v[44:47], v2 offset:44032
v_exp_f32 v58, v58
v_exp_f32 v59, v59
v_mfma_f32_32x32x16_bf16 v[72:87], v[28:31], v[20:23], v[72:87]
v_exp_f32 v60, v60
v_exp_f32 v61, v61
v_exp_f32 v62, v62
v_exp_f32 v63, v63
v_mfma_f32_32x32x16_bf16 v[120:135], v[48:51], v[96:99], v[120:135]
v_cvt_pk_bf16_f32 v88, v56, v57
v_cvt_pk_bf16_f32 v89, v58, v59
v_exp_f32 v64, v64
v_exp_f32 v65, v65
v_mfma_f32_16x16x32_bf16 v[172:175], v[176:179], v[96:99], v[172:175]
v_exp_f32 v66, v66
v_exp_f32 v67, v67
v_mfma_f32_32x32x16_bf16 v[120:135], v[52:55], v[100:103], v[120:135]
v_cvt_pk_bf16_f32 v90, v60, v61
v_cvt_pk_bf16_f32 v91, v62, v63
v_exp_f32 v68, v68
v_exp_f32 v69, v69
v_mfma_f32_16x16x32_bf16 v[172:175], v[176:179], v[100:103], v[172:175]
v_exp_f32 v70, v70
v_exp_f32 v71, v71
v_cvt_pk_bf16_f32 v92, v64, v65
v_cvt_pk_bf16_f32 v93, v66, v67
v_cvt_pk_bf16_f32 v94, v68, v69
v_cvt_pk_bf16_f32 v95, v70, v71
s_waitcnt lgkmcnt(0)
v_mfma_f32_32x32x16_bf16 v[56:71], v[32:35], v[8:11], v[136:151]
v_exp_f32 v72, v72
v_exp_f32 v73, v73
v_exp_f32 v74, v74
v_exp_f32 v75, v75
v_mfma_f32_32x32x16_bf16 v[56:71], v[36:39], v[12:15], v[56:71]
v_exp_f32 v76, v76
v_exp_f32 v77, v77
v_exp_f32 v78, v78
v_exp_f32 v79, v79
v_mfma_f32_32x32x16_bf16 v[104:119], v[40:43], v[88:91], v[104:119]
v_cvt_pk_bf16_f32 v96, v72, v73
v_cvt_pk_bf16_f32 v97, v74, v75
v_exp_f32 v80, v80
v_exp_f32 v81, v81
v_mfma_f32_16x16x32_bf16 v[168:171], v[176:179], v[88:91], v[168:171]
v_exp_f32 v82, v82
v_exp_f32 v83, v83
v_mfma_f32_32x32x16_bf16 v[104:119], v[44:47], v[92:95], v[104:119]
v_cvt_pk_bf16_f32 v98, v76, v77
v_cvt_pk_bf16_f32 v99, v78, v79
v_exp_f32 v84, v84
v_exp_f32 v85, v85
v_mfma_f32_16x16x32_bf16 v[168:171], v[176:179], v[92:95], v[168:171]
v_exp_f32 v86, v86
v_exp_f32 v87, v87
v_cvt_pk_bf16_f32 v100, v80, v81
v_cvt_pk_bf16_f32 v101, v82, v83
v_cvt_pk_bf16_f32 v102, v84, v85
v_cvt_pk_bf16_f32 v103, v86, v87
s_waitcnt vmcnt(2)
s_barrier
v_mfma_f32_32x32x16_bf16 v[72:87], v[32:35], v[16:19], v[152:167]
v_exp_f32 v56, v56
v_exp_f32 v57, v57
ds_read_b128 v[24:27], v2 offset:49152
ds_read_b128 v[28:31], v2 offset:50176
ds_read_b128 v[48:51], v2 offset:47104
ds_read_b128 v[52:55], v2 offset:48128
v_exp_f32 v58, v58
v_exp_f32 v59, v59
v_mfma_f32_32x32x16_bf16 v[72:87], v[36:39], v[20:23], v[72:87]
v_exp_f32 v60, v60
v_exp_f32 v61, v61
v_exp_f32 v62, v62
v_exp_f32 v63, v63
v_mfma_f32_32x32x16_bf16 v[120:135], v[40:43], v[96:99], v[120:135]
v_cvt_pk_bf16_f32 v88, v56, v57
v_cvt_pk_bf16_f32 v89, v58, v59
v_exp_f32 v64, v64
v_exp_f32 v65, v65
v_mfma_f32_16x16x32_bf16 v[172:175], v[176:179], v[96:99], v[172:175]
v_exp_f32 v66, v66
v_exp_f32 v67, v67
v_mfma_f32_32x32x16_bf16 v[120:135], v[44:47], v[100:103], v[120:135]
v_cvt_pk_bf16_f32 v90, v60, v61
v_cvt_pk_bf16_f32 v91, v62, v63
v_exp_f32 v68, v68
v_exp_f32 v69, v69
v_mfma_f32_16x16x32_bf16 v[172:175], v[176:179], v[100:103], v[172:175]
v_exp_f32 v70, v70
v_exp_f32 v71, v71
v_cvt_pk_bf16_f32 v92, v64, v65
v_cvt_pk_bf16_f32 v93, v66, v67
v_cvt_pk_bf16_f32 v94, v68, v69
v_cvt_pk_bf16_f32 v95, v70, v71
s_waitcnt lgkmcnt(0)
v_mfma_f32_32x32x16_bf16 v[56:71], v[24:27], v[8:11], v[136:151]
v_exp_f32 v72, v72
v_exp_f32 v73, v73
v_exp_f32 v74, v74
v_exp_f32 v75, v75
v_mfma_f32_32x32x16_bf16 v[56:71], v[28:31], v[12:15], v[56:71]
v_exp_f32 v76, v76
v_exp_f32 v77, v77
v_exp_f32 v78, v78
v_exp_f32 v79, v79
v_mfma_f32_32x32x16_bf16 v[104:119], v[48:51], v[88:91], v[104:119]
v_cvt_pk_bf16_f32 v96, v72, v73
v_cvt_pk_bf16_f32 v97, v74, v75
v_exp_f32 v80, v80
v_exp_f32 v81, v81
v_mfma_f32_16x16x32_bf16 v[168:171], v[176:179], v[88:91], v[168:171]
v_exp_f32 v82, v82
v_exp_f32 v83, v83
v_mfma_f32_32x32x16_bf16 v[104:119], v[52:55], v[92:95], v[104:119]
v_cvt_pk_bf16_f32 v98, v76, v77
v_cvt_pk_bf16_f32 v99, v78, v79
v_exp_f32 v84, v84
v_exp_f32 v85, v85
v_mfma_f32_16x16x32_bf16 v[168:171], v[176:179], v[92:95], v[168:171]
v_exp_f32 v86, v86
v_exp_f32 v87, v87
v_cvt_pk_bf16_f32 v100, v80, v81
v_cvt_pk_bf16_f32 v101, v82, v83
v_cvt_pk_bf16_f32 v102, v84, v85
v_cvt_pk_bf16_f32 v103, v86, v87
v_mfma_f32_32x32x16_bf16 v[72:87], v[24:27], v[16:19], v[152:167]
v_exp_f32 v56, v56
v_exp_f32 v57, v57
ds_read_b128 v[32:35], v2 offset:53248
ds_read_b128 v[36:39], v2 offset:54272
ds_read_b128 v[40:43], v2 offset:51200
ds_read_b128 v[44:47], v2 offset:52224
v_exp_f32 v58, v58
v_exp_f32 v59, v59
v_mfma_f32_32x32x16_bf16 v[72:87], v[28:31], v[20:23], v[72:87]
v_exp_f32 v60, v60
v_exp_f32 v61, v61
v_exp_f32 v62, v62
v_exp_f32 v63, v63
v_mfma_f32_32x32x16_bf16 v[120:135], v[48:51], v[96:99], v[120:135]
v_cvt_pk_bf16_f32 v88, v56, v57
v_cvt_pk_bf16_f32 v89, v58, v59
v_exp_f32 v64, v64
v_exp_f32 v65, v65
v_mfma_f32_16x16x32_bf16 v[172:175], v[176:179], v[96:99], v[172:175]
v_exp_f32 v66, v66
v_exp_f32 v67, v67
v_mfma_f32_32x32x16_bf16 v[120:135], v[52:55], v[100:103], v[120:135]
v_cvt_pk_bf16_f32 v90, v60, v61
v_cvt_pk_bf16_f32 v91, v62, v63
v_exp_f32 v68, v68
v_exp_f32 v69, v69
v_mfma_f32_16x16x32_bf16 v[172:175], v[176:179], v[100:103], v[172:175]
v_exp_f32 v70, v70
v_exp_f32 v71, v71
v_cvt_pk_bf16_f32 v92, v64, v65
v_cvt_pk_bf16_f32 v93, v66, v67
v_cvt_pk_bf16_f32 v94, v68, v69
v_cvt_pk_bf16_f32 v95, v70, v71
s_waitcnt lgkmcnt(0)
v_mfma_f32_32x32x16_bf16 v[56:71], v[32:35], v[8:11], v[136:151]
v_exp_f32 v72, v72
v_exp_f32 v73, v73
v_exp_f32 v74, v74
v_exp_f32 v75, v75
v_mfma_f32_32x32x16_bf16 v[56:71], v[36:39], v[12:15], v[56:71]
v_exp_f32 v76, v76
v_exp_f32 v77, v77
v_exp_f32 v78, v78
v_exp_f32 v79, v79
v_mfma_f32_32x32x16_bf16 v[104:119], v[40:43], v[88:91], v[104:119]
v_cvt_pk_bf16_f32 v96, v72, v73
v_cvt_pk_bf16_f32 v97, v74, v75
v_exp_f32 v80, v80
v_exp_f32 v81, v81
v_mfma_f32_16x16x32_bf16 v[168:171], v[176:179], v[88:91], v[168:171]
v_exp_f32 v82, v82
v_exp_f32 v83, v83
v_mfma_f32_32x32x16_bf16 v[104:119], v[44:47], v[92:95], v[104:119]
v_cvt_pk_bf16_f32 v98, v76, v77
v_cvt_pk_bf16_f32 v99, v78, v79
v_exp_f32 v84, v84
v_exp_f32 v85, v85
v_mfma_f32_16x16x32_bf16 v[168:171], v[176:179], v[92:95], v[168:171]
v_exp_f32 v86, v86
v_exp_f32 v87, v87
v_cvt_pk_bf16_f32 v100, v80, v81
v_cvt_pk_bf16_f32 v101, v82, v83
v_cvt_pk_bf16_f32 v102, v84, v85
v_cvt_pk_bf16_f32 v103, v86, v87
v_mfma_f32_32x32x16_bf16 v[72:87], v[32:35], v[16:19], v[152:167]
v_exp_f32 v56, v56
v_exp_f32 v57, v57
ds_read_b128 v[24:27], v2 offset:57344
ds_read_b128 v[28:31], v2 offset:58368
ds_read_b128 v[48:51], v2 offset:55296
ds_read_b128 v[52:55], v2 offset:56320
v_exp_f32 v58, v58
v_exp_f32 v59, v59
v_mfma_f32_32x32x16_bf16 v[72:87], v[36:39], v[20:23], v[72:87]
v_exp_f32 v60, v60
v_exp_f32 v61, v61
v_exp_f32 v62, v62
v_exp_f32 v63, v63
v_mfma_f32_32x32x16_bf16 v[120:135], v[40:43], v[96:99], v[120:135]
v_cvt_pk_bf16_f32 v88, v56, v57
v_cvt_pk_bf16_f32 v89, v58, v59
v_exp_f32 v64, v64
v_exp_f32 v65, v65
v_mfma_f32_16x16x32_bf16 v[172:175], v[176:179], v[96:99], v[172:175]
v_exp_f32 v66, v66
v_exp_f32 v67, v67
v_mfma_f32_32x32x16_bf16 v[120:135], v[44:47], v[100:103], v[120:135]
v_cvt_pk_bf16_f32 v90, v60, v61
v_cvt_pk_bf16_f32 v91, v62, v63
v_exp_f32 v68, v68
v_exp_f32 v69, v69
v_mfma_f32_16x16x32_bf16 v[172:175], v[176:179], v[100:103], v[172:175]
v_exp_f32 v70, v70
v_exp_f32 v71, v71
v_cvt_pk_bf16_f32 v92, v64, v65
v_cvt_pk_bf16_f32 v93, v66, v67
v_cvt_pk_bf16_f32 v94, v68, v69
v_cvt_pk_bf16_f32 v95, v70, v71
s_waitcnt lgkmcnt(0)
v_mfma_f32_32x32x16_bf16 v[56:71], v[24:27], v[8:11], v[136:151]
v_exp_f32 v72, v72
v_exp_f32 v73, v73
v_exp_f32 v74, v74
v_exp_f32 v75, v75
v_mfma_f32_32x32x16_bf16 v[56:71], v[28:31], v[12:15], v[56:71]
v_exp_f32 v76, v76
v_exp_f32 v77, v77
v_exp_f32 v78, v78
v_exp_f32 v79, v79
v_mfma_f32_32x32x16_bf16 v[104:119], v[48:51], v[88:91], v[104:119]
v_cvt_pk_bf16_f32 v96, v72, v73
v_cvt_pk_bf16_f32 v97, v74, v75
v_exp_f32 v80, v80
v_exp_f32 v81, v81
v_mfma_f32_16x16x32_bf16 v[168:171], v[176:179], v[88:91], v[168:171]
v_exp_f32 v82, v82
v_exp_f32 v83, v83
v_mfma_f32_32x32x16_bf16 v[104:119], v[52:55], v[92:95], v[104:119]
v_cvt_pk_bf16_f32 v98, v76, v77
v_cvt_pk_bf16_f32 v99, v78, v79
v_exp_f32 v84, v84
v_exp_f32 v85, v85
v_mfma_f32_16x16x32_bf16 v[168:171], v[176:179], v[92:95], v[168:171]
v_exp_f32 v86, v86
v_exp_f32 v87, v87
v_cvt_pk_bf16_f32 v100, v80, v81
v_cvt_pk_bf16_f32 v101, v82, v83
v_cvt_pk_bf16_f32 v102, v84, v85
v_cvt_pk_bf16_f32 v103, v86, v87
v_mfma_f32_32x32x16_bf16 v[72:87], v[24:27], v[16:19], v[152:167]
v_exp_f32 v56, v56
v_exp_f32 v57, v57
ds_read_b128 v[32:35], v2 offset:61440
ds_read_b128 v[36:39], v2 offset:62464
ds_read_b128 v[40:43], v2 offset:59392
ds_read_b128 v[44:47], v2 offset:60416
v_exp_f32 v58, v58
v_exp_f32 v59, v59
v_mfma_f32_32x32x16_bf16 v[72:87], v[28:31], v[20:23], v[72:87]
v_exp_f32 v60, v60
v_exp_f32 v61, v61
v_exp_f32 v62, v62
v_exp_f32 v63, v63
v_mfma_f32_32x32x16_bf16 v[120:135], v[48:51], v[96:99], v[120:135]
v_cvt_pk_bf16_f32 v88, v56, v57
v_cvt_pk_bf16_f32 v89, v58, v59
v_exp_f32 v64, v64
v_exp_f32 v65, v65
v_mfma_f32_16x16x32_bf16 v[172:175], v[176:179], v[96:99], v[172:175]
v_exp_f32 v66, v66
v_exp_f32 v67, v67
v_mfma_f32_32x32x16_bf16 v[120:135], v[52:55], v[100:103], v[120:135]
v_cvt_pk_bf16_f32 v90, v60, v61
v_cvt_pk_bf16_f32 v91, v62, v63
v_exp_f32 v68, v68
v_exp_f32 v69, v69
v_mfma_f32_16x16x32_bf16 v[172:175], v[176:179], v[100:103], v[172:175]
v_exp_f32 v70, v70
v_exp_f32 v71, v71
v_cvt_pk_bf16_f32 v92, v64, v65
v_cvt_pk_bf16_f32 v93, v66, v67
v_cvt_pk_bf16_f32 v94, v68, v69
v_cvt_pk_bf16_f32 v95, v70, v71
s_waitcnt lgkmcnt(0)
v_mfma_f32_32x32x16_bf16 v[56:71], v[32:35], v[8:11], v[136:151]
v_exp_f32 v72, v72
v_exp_f32 v73, v73
v_exp_f32 v74, v74
v_exp_f32 v75, v75
v_mfma_f32_32x32x16_bf16 v[56:71], v[36:39], v[12:15], v[56:71]
v_exp_f32 v76, v76
v_exp_f32 v77, v77
v_exp_f32 v78, v78
v_exp_f32 v79, v79
v_mfma_f32_32x32x16_bf16 v[104:119], v[40:43], v[88:91], v[104:119]
v_cvt_pk_bf16_f32 v96, v72, v73
v_cvt_pk_bf16_f32 v97, v74, v75
v_exp_f32 v80, v80
v_exp_f32 v81, v81
v_mfma_f32_16x16x32_bf16 v[168:171], v[176:179], v[88:91], v[168:171]
v_exp_f32 v82, v82
v_exp_f32 v83, v83
v_mfma_f32_32x32x16_bf16 v[104:119], v[44:47], v[92:95], v[104:119]
v_cvt_pk_bf16_f32 v98, v76, v77
v_cvt_pk_bf16_f32 v99, v78, v79
v_exp_f32 v84, v84
v_exp_f32 v85, v85
v_mfma_f32_16x16x32_bf16 v[168:171], v[176:179], v[92:95], v[168:171]
v_exp_f32 v86, v86
v_exp_f32 v87, v87
v_cvt_pk_bf16_f32 v100, v80, v81
v_cvt_pk_bf16_f32 v101, v82, v83
v_cvt_pk_bf16_f32 v102, v84, v85
v_cvt_pk_bf16_f32 v103, v86, v87
v_mfma_f32_32x32x16_bf16 v[72:87], v[32:35], v[16:19], v[152:167]
v_exp_f32 v56, v56
v_exp_f32 v57, v57
ds_read_b128 v[48:51], v2 offset:63488
ds_read_b128 v[52:55], v2 offset:64512
v_exp_f32 v58, v58
v_exp_f32 v59, v59
v_mfma_f32_32x32x16_bf16 v[72:87], v[36:39], v[20:23], v[72:87]
v_exp_f32 v60, v60
v_exp_f32 v61, v61
v_exp_f32 v62, v62
v_exp_f32 v63, v63
v_mfma_f32_32x32x16_bf16 v[120:135], v[40:43], v[96:99], v[120:135]
v_cvt_pk_bf16_f32 v88, v56, v57
v_cvt_pk_bf16_f32 v89, v58, v59
v_exp_f32 v64, v64
v_exp_f32 v65, v65
v_mfma_f32_16x16x32_bf16 v[172:175], v[176:179], v[96:99], v[172:175]
v_exp_f32 v66, v66
v_exp_f32 v67, v67
v_mfma_f32_32x32x16_bf16 v[120:135], v[44:47], v[100:103], v[120:135]
v_cvt_pk_bf16_f32 v90, v60, v61
v_cvt_pk_bf16_f32 v91, v62, v63
v_exp_f32 v68, v68
v_exp_f32 v69, v69
v_mfma_f32_16x16x32_bf16 v[172:175], v[176:179], v[100:103], v[172:175]
v_exp_f32 v70, v70
v_exp_f32 v71, v71
v_cvt_pk_bf16_f32 v92, v64, v65
v_cvt_pk_bf16_f32 v93, v66, v67
v_cvt_pk_bf16_f32 v94, v68, v69
v_cvt_pk_bf16_f32 v95, v70, v71
s_waitcnt lgkmcnt(0)
v_exp_f32 v72, v72
v_exp_f32 v73, v73
v_mfma_f32_32x32x16_bf16 v[104:119], v[48:51], v[88:91], v[104:119]
v_exp_f32 v74, v74
v_exp_f32 v75, v75
v_exp_f32 v76, v76
v_exp_f32 v77, v77
v_exp_f32 v78, v78
v_exp_f32 v79, v79
v_mfma_f32_16x16x32_bf16 v[168:171], v[176:179], v[88:91], v[168:171]
v_cvt_pk_bf16_f32 v96, v72, v73
v_cvt_pk_bf16_f32 v97, v74, v75
v_exp_f32 v80, v80
v_exp_f32 v81, v81
v_mfma_f32_32x32x16_bf16 v[104:119], v[52:55], v[92:95], v[104:119]
v_exp_f32 v82, v82
v_exp_f32 v83, v83
v_cvt_pk_bf16_f32 v98, v76, v77
v_cvt_pk_bf16_f32 v99, v78, v79
v_exp_f32 v84, v84
v_exp_f32 v85, v85
v_mfma_f32_16x16x32_bf16 v[168:171], v[176:179], v[92:95], v[168:171]
v_exp_f32 v86, v86
v_exp_f32 v87, v87
v_cvt_pk_bf16_f32 v100, v80, v81
v_cvt_pk_bf16_f32 v101, v82, v83
v_cvt_pk_bf16_f32 v102, v84, v85
v_cvt_pk_bf16_f32 v103, v86, v87
s_nop 1
v_mfma_f32_32x32x16_bf16 v[120:135], v[48:51], v[96:99], v[120:135]
v_mfma_f32_16x16x32_bf16 v[172:175], v[176:179], v[96:99], v[172:175]
v_mfma_f32_32x32x16_bf16 v[120:135], v[52:55], v[100:103], v[120:135]
v_mfma_f32_16x16x32_bf16 v[172:175], v[176:179], v[100:103], v[172:175]
v_and_b32 v7, 15, v1
v_lshlrev_b32 v7, 2, v7
v_and_b32 v5, 16, v1
v_cmp_ne_u32 s[20:21], 0, v5
s_nop 15
v_and_b32 v7, 15, v1
v_lshlrev_b32 v7, 2, v7
ds_bpermute_b32 v5, v7, v168
ds_bpermute_b32 v6, v7, v169
s_waitcnt lgkmcnt(0)
v_cndmask_b32 v180, v5, v6, s[20:21]
v_mul_f32 v4, 0, v104
v_fmac_f32 v4, 0, v105
v_fmac_f32 v4, 0, v106
v_fmac_f32 v4, 0, v107
v_fmac_f32 v4, 0, v108
v_fmac_f32 v4, 0, v109
v_fmac_f32 v4, 0, v110
v_fmac_f32 v4, 0, v111
v_fmac_f32 v4, 0, v112
v_fmac_f32 v4, 0, v113
v_fmac_f32 v4, 0, v114
v_fmac_f32 v4, 0, v115
v_fmac_f32 v4, 0, v116
v_fmac_f32 v4, 0, v117
v_fmac_f32 v4, 0, v118
v_fmac_f32 v4, 0, v119
v_add_f32 v4, v4, v180
v_cmp_ngt_f32 vcc, s24, v4
s_cbranch_vccnz L_k2_fallback_1
L_k2_back_2:
v_rcp_f32 v180, v180
s_nop 0
v_mul_f32 v104, v104, v180
v_mul_f32 v105, v105, v180
v_mul_f32 v106, v106, v180
v_mul_f32 v107, v107, v180
v_mul_f32 v108, v108, v180
v_mul_f32 v109, v109, v180
v_mul_f32 v110, v110, v180
v_mul_f32 v111, v111, v180
v_mul_f32 v112, v112, v180
v_mul_f32 v113, v113, v180
v_mul_f32 v114, v114, v180
v_mul_f32 v115, v115, v180
v_mul_f32 v116, v116, v180
v_mul_f32 v117, v117, v180
v_mul_f32 v118, v118, v180
v_mul_f32 v119, v119, v180
v_cvt_pk_bf16_f32 v136, v104, v105
v_cvt_pk_bf16_f32 v137, v106, v107
v_cvt_pk_bf16_f32 v138, v108, v109
v_cvt_pk_bf16_f32 v139, v110, v111
v_cvt_pk_bf16_f32 v140, v112, v113
v_cvt_pk_bf16_f32 v141, v114, v115
v_cvt_pk_bf16_f32 v142, v116, v117
v_cvt_pk_bf16_f32 v143, v118, v119
buffer_store_dwordx4 v[136:139], v182, s[8:11], 0 offen sc1
buffer_store_dwordx4 v[140:143], v182, s[8:11], 0 offen offset:1024 sc1
v_and_b32 v7, 15, v1
v_lshlrev_b32 v7, 2, v7
ds_bpermute_b32 v5, v7, v172
ds_bpermute_b32 v6, v7, v173
s_waitcnt lgkmcnt(0)
v_cndmask_b32 v180, v5, v6, s[20:21]
v_mul_f32 v4, 0, v120
v_fmac_f32 v4, 0, v121
v_fmac_f32 v4, 0, v122
v_fmac_f32 v4, 0, v123
v_fmac_f32 v4, 0, v124
v_fmac_f32 v4, 0, v125
v_fmac_f32 v4, 0, v126
v_fmac_f32 v4, 0, v127
v_fmac_f32 v4, 0, v128
v_fmac_f32 v4, 0, v129
v_fmac_f32 v4, 0, v130
v_fmac_f32 v4, 0, v131
v_fmac_f32 v4, 0, v132
v_fmac_f32 v4, 0, v133
v_fmac_f32 v4, 0, v134
v_fmac_f32 v4, 0, v135
v_add_f32 v4, v4, v180
v_cmp_ngt_f32 vcc, s24, v4
s_cbranch_vccnz L_k2_fallback_3
L_k2_back_4:
v_rcp_f32 v180, v180
s_nop 0
v_mul_f32 v120, v120, v180
v_mul_f32 v121, v121, v180
v_mul_f32 v122, v122, v180
v_mul_f32 v123, v123, v180
v_mul_f32 v124, v124, v180
v_mul_f32 v125, v125, v180
v_mul_f32 v126, v126, v180
v_mul_f32 v127, v127, v180
v_mul_f32 v128, v128, v180
v_mul_f32 v129, v129, v180
v_mul_f32 v130, v130, v180
v_mul_f32 v131, v131, v180
v_mul_f32 v132, v132, v180
v_mul_f32 v133, v133, v180
v_mul_f32 v134, v134, v180
v_mul_f32 v135, v135, v180
v_cvt_pk_bf16_f32 v144, v120, v121
v_cvt_pk_bf16_f32 v145, v122, v123
v_cvt_pk_bf16_f32 v146, v124, v125
v_cvt_pk_bf16_f32 v147, v126, v127
v_cvt_pk_bf16_f32 v148, v128, v129
v_cvt_pk_bf16_f32 v149, v130, v131
v_cvt_pk_bf16_f32 v150, v132, v133
v_cvt_pk_bf16_f32 v151, v134, v135
v_add_u32 v182, 294912, v182
buffer_store_dwordx4 v[144:147], v182, s[8:11], 0 offen sc1
buffer_store_dwordx4 v[148:151], v182, s[8:11], 0 offen offset:1024 sc1
s_waitcnt vmcnt(0)
s_barrier
s_cmp_lg_u32 s14, 0
s_cbranch_scc1 L_k2_noflag_5
s_lshl_b32 s18, s2, 2
s_add_u32 s18, s18, 50348032
v_mov_b32 v4, 1
v_mov_b32 v5, 0
s_mov_b64 exec, 1
buffer_store_dword v4, v5, s[8:11], s18 offen sc1
s_mov_b64 exec, -1
L_k2_noflag_5:
s_endpgm
L_k2_fallback_1:
s_nop 15
v_mov_b32 v104, 0
v_mov_b32 v105, 0
v_mov_b32 v106, 0
v_mov_b32 v107, 0
v_mov_b32 v108, 0
v_mov_b32 v109, 0
v_mov_b32 v110, 0
v_mov_b32 v111, 0
v_mov_b32 v112, 0
v_mov_b32 v113, 0
v_mov_b32 v114, 0
v_mov_b32 v115, 0
v_mov_b32 v116, 0
v_mov_b32 v117, 0
v_mov_b32 v118, 0
v_mov_b32 v119, 0
v_mov_b32 v180, 0
v_mov_b32 v183, 0xff7fffff
v_add_u32 v7, s25, v2
s_mov_b32 s17, 0
L_k2_fb_6:
buffer_load_dwordx4 v[24:27], v7, s[8:11], s17 offen
buffer_load_dwordx4 v[28:31], v7, s[8:11], s17 offen offset:1024
buffer_load_dwordx4 v[40:43], v7, s[8:11], s17 offen offset:2048
buffer_load_dwordx4 v[44:47], v7, s[8:11], s17 offen offset:3072
s_waitcnt vmcnt(0)
v_mfma_f32_32x32x16_bf16 v[56:71], v[24:27], v[8:11], 0
v_mfma_f32_32x32x16_bf16 v[56:71], v[28:31], v[12:15], v[56:71]
s_nop 15
v_max3_f32 v181, v56, v57, v58
v_max3_f32 v181, v181, v59, v60
v_max3_f32 v181, v181, v61, v62
v_max3_f32 v181, v181, v63, v64
v_max3_f32 v181, v181, v65, v66
v_max3_f32 v181, v181, v67, v68
v_max3_f32 v181, v181, v69, v70
v_max_f32 v181, v181, v71
v_mov_b32 v4, v181
s_nop 1
v_permlane32_swap_b32 v181, v4
s_nop 1
v_max_f32 v181, v181, v4
v_max_f32 v181, v181, v183
v_sub_f32 v184, v183, v181
v_exp_f32 v184, v184
v_mov_b32 v183, v181
v_sub_f32 v56, v56, v181
v_sub_f32 v57, v57, v181
v_sub_f32 v58, v58, v181
v_sub_f32 v59, v59, v181
v_sub_f32 v60, v60, v181
v_sub_f32 v61, v61, v181
v_sub_f32 v62, v62, v181
v_sub_f32 v63, v63, v181
v_sub_f32 v64, v64, v181
v_sub_f32 v65, v65, v181
v_sub_f32 v66, v66, v181
v_sub_f32 v67, v67, v181
v_sub_f32 v68, v68, v181
v_sub_f32 v69, v69, v181
v_sub_f32 v70, v70, v181
v_sub_f32 v71, v71, v181
v_exp_f32 v56, v56
v_exp_f32 v57, v57
v_exp_f32 v58, v58
v_exp_f32 v59, v59
v_exp_f32 v60, v60
v_exp_f32 v61, v61
v_exp_f32 v62, v62
v_exp_f32 v63, v63
v_exp_f32 v64, v64
v_exp_f32 v65, v65
v_exp_f32 v66, v66
v_exp_f32 v67, v67
v_exp_f32 v68, v68
v_exp_f32 v69, v69
v_exp_f32 v70, v70
v_exp_f32 v71, v71
v_mul_f32 v104, v104, v184
v_mul_f32 v105, v105, v184
v_mul_f32 v106, v106, v184
v_mul_f32 v107, v107, v184
v_mul_f32 v108, v108, v184
v_mul_f32 v109, v109, v184
v_mul_f32 v110, v110, v184
v_mul_f32 v111, v111, v184
v_mul_f32 v112, v112, v184
v_mul_f32 v113, v113, v184
v_mul_f32 v114, v114, v184
v_mul_f32 v115, v115, v184
v_mul_f32 v116, v116, v184
v_mul_f32 v117, v117, v184
v_mul_f32 v118, v118, v184
v_mul_f32 v119, v119, v184
v_mul_f32 v180, v180, v184
v_add_f32 v180, v180, v56
v_add_f32 v180, v180, v57
v_add_f32 v180, v180, v58
v_add_f32 v180, v180, v59
v_add_f32 v180, v180, v60
v_add_f32 v180, v180, v61
v_add_f32 v180, v180, v62
v_add_f32 v180, v180, v63
v_add_f32 v180, v180, v64
v_add_f32 v180, v180, v65
v_add_f32 v180, v180, v66
v_add_f32 v180, v180, v67
v_add_f32 v180, v180, v68
v_add_f32 v180, v180, v69
v_add_f32 v180, v180, v70
v_add_f32 v180, v180, v71
v_cvt_pk_bf16_f32 v88, v56, v57
v_cvt_pk_bf16_f32 v89, v58, v59
v_cvt_pk_bf16_f32 v90, v60, v61
v_cvt_pk_bf16_f32 v91, v62, v63
v_cvt_pk_bf16_f32 v92, v64, v65
v_cvt_pk_bf16_f32 v93, v66, v67
v_cvt_pk_bf16_f32 v94, v68, v69
v_cvt_pk_bf16_f32 v95, v70, v71
s_nop 1
v_mfma_f32_32x32x16_bf16 v[104:119], v[40:43], v[88:91], v[104:119]
v_mfma_f32_32x32x16_bf16 v[104:119], v[44:47], v[92:95], v[104:119]
s_nop 15
s_add_u32 s17, s17, 4096
s_cmp_lt_u32 s17, 262144
s_cbranch_scc1 L_k2_fb_6
v_mov_b32 v4, v180
s_nop 1
v_permlane32_swap_b32 v180, v4
s_nop 1
v_add_f32 v180, v180, v4
s_branch L_k2_back_2
L_k2_fallback_3:
s_nop 15
v_mov_b32 v120, 0
v_mov_b32 v121, 0
v_mov_b32 v122, 0
v_mov_b32 v123, 0
v_mov_b32 v124, 0
v_mov_b32 v125, 0
v_mov_b32 v126, 0
v_mov_b32 v127, 0
v_mov_b32 v128, 0
v_mov_b32 v129, 0
v_mov_b32 v130, 0
v_mov_b32 v131, 0
v_mov_b32 v132, 0
v_mov_b32 v133, 0
v_mov_b32 v134, 0
v_mov_b32 v135, 0
v_mov_b32 v180, 0
v_mov_b32 v183, 0xff7fffff
v_add_u32 v7, s25, v2
s_mov_b32 s17, 0
L_k2_fb_7:
buffer_load_dwordx4 v[24:27], v7, s[8:11], s17 offen
buffer_load_dwordx4 v[28:31], v7, s[8:11], s17 offen offset:1024
buffer_load_dwordx4 v[40:43], v7, s[8:11], s17 offen offset:2048
buffer_load_dwordx4 v[44:47], v7, s[8:11], s17 offen offset:3072
s_waitcnt vmcnt(0)
v_mfma_f32_32x32x16_bf16 v[56:71], v[24:27], v[16:19], 0
v_mfma_f32_32x32x16_bf16 v[56:71], v[28:31], v[20:23], v[56:71]
s_nop 15
v_max3_f32 v181, v56, v57, v58
v_max3_f32 v181, v181, v59, v60
v_max3_f32 v181, v181, v61, v62
v_max3_f32 v181, v181, v63, v64
v_max3_f32 v181, v181, v65, v66
v_max3_f32 v181, v181, v67, v68
v_max3_f32 v181, v181, v69, v70
v_max_f32 v181, v181, v71
v_mov_b32 v4, v181
s_nop 1
v_permlane32_swap_b32 v181, v4
s_nop 1
v_max_f32 v181, v181, v4
v_max_f32 v181, v181, v183
v_sub_f32 v184, v183, v181
v_exp_f32 v184, v184
v_mov_b32 v183, v181
v_sub_f32 v56, v56, v181
v_sub_f32 v57, v57, v181
v_sub_f32 v58, v58, v181
v_sub_f32 v59, v59, v181
v_sub_f32 v60, v60, v181
v_sub_f32 v61, v61, v181
v_sub_f32 v62, v62, v181
v_sub_f32 v63, v63, v181
v_sub_f32 v64, v64, v181
v_sub_f32 v65, v65, v181
v_sub_f32 v66, v66, v181
v_sub_f32 v67, v67, v181
v_sub_f32 v68, v68, v181
v_sub_f32 v69, v69, v181
v_sub_f32 v70, v70, v181
v_sub_f32 v71, v71, v181
v_exp_f32 v56, v56
v_exp_f32 v57, v57
v_exp_f32 v58, v58
v_exp_f32 v59, v59
v_exp_f32 v60, v60
v_exp_f32 v61, v61
v_exp_f32 v62, v62
v_exp_f32 v63, v63
v_exp_f32 v64, v64
v_exp_f32 v65, v65
v_exp_f32 v66, v66
v_exp_f32 v67, v67
v_exp_f32 v68, v68
v_exp_f32 v69, v69
v_exp_f32 v70, v70
v_exp_f32 v71, v71
v_mul_f32 v120, v120, v184
v_mul_f32 v121, v121, v184
v_mul_f32 v122, v122, v184
v_mul_f32 v123, v123, v184
v_mul_f32 v124, v124, v184
v_mul_f32 v125, v125, v184
v_mul_f32 v126, v126, v184
v_mul_f32 v127, v127, v184
v_mul_f32 v128, v128, v184
v_mul_f32 v129, v129, v184
v_mul_f32 v130, v130, v184
v_mul_f32 v131, v131, v184
v_mul_f32 v132, v132, v184
v_mul_f32 v133, v133, v184
v_mul_f32 v134, v134, v184
v_mul_f32 v135, v135, v184
v_mul_f32 v180, v180, v184
v_add_f32 v180, v180, v56
v_add_f32 v180, v180, v57
v_add_f32 v180, v180, v58
v_add_f32 v180, v180, v59
v_add_f32 v180, v180, v60
v_add_f32 v180, v180, v61
v_add_f32 v180, v180, v62
v_add_f32 v180, v180, v63
v_add_f32 v180, v180, v64
v_add_f32 v180, v180, v65
v_add_f32 v180, v180, v66
v_add_f32 v180, v180, v67
v_add_f32 v180, v180, v68
v_add_f32 v180, v180, v69
v_add_f32 v180, v180, v70
v_add_f32 v180, v180, v71
v_cvt_pk_bf16_f32 v88, v56, v57
v_cvt_pk_bf16_f32 v89, v58, v59
v_cvt_pk_bf16_f32 v90, v60, v61
v_cvt_pk_bf16_f32 v91, v62, v63
v_cvt_pk_bf16_f32 v92, v64, v65
v_cvt_pk_bf16_f32 v93, v66, v67
v_cvt_pk_bf16_f32 v94, v68, v69
v_cvt_pk_bf16_f32 v95, v70, v71
s_nop 1
v_mfma_f32_32x32x16_bf16 v[120:135], v[40:43], v[88:91], v[120:135]
v_mfma_f32_32x32x16_bf16 v[120:135], v[44:47], v[92:95], v[120:135]
s_nop 15
s_add_u32 s17, s17, 4096
s_cmp_lt_u32 s17, 262144
s_cbranch_scc1 L_k2_fb_7
v_mov_b32 v4, v180
s_nop 1
v_permlane32_swap_b32 v180, v4
s_nop 1
v_add_f32 v180, v180, v4
s_branch L_k2_back_4
L_k2_down:
s_load_dwordx2 s[4:5], s[0:1], 48
s_load_dwordx2 s[6:7], s[0:1], 72
s_load_dwordx2 s[48:49], s[0:1], 16
s_load_dwordx2 s[50:51], s[0:1], 0
s_load_dwordx2 s[64:65], s[0:1], 56
s_and_b32 s26, s2, 7
s_lshr_b32 s27, s2, 3
s_and_b32 s27, s27, 31
s_and_b32 s19, s27, 1
s_lshr_b32 s27, s27, 1
s_lshr_b32 s28, s26, 1
s_lshl_b32 s28, s28, 2
s_and_b32 s29, s27, 3
s_add_u32 s16, s28, s29
s_and_b32 s28, s26, 1
s_lshl_b32 s28, s28, 2
s_lshr_b32 s29, s27, 2
s_add_u32 s17, s28, s29
s_lshl_b32 s20, s16, 3
s_add_u32 s20, s20, s17
v_and_b32 v1, 63, v0
v_lshrrev_b32 v16, 6, v0
s_nop 0
v_readfirstlane_b32 s18, v16
s_nop 3
v_lshrrev_b32 v16, 5, v1
v_lshlrev_b32 v16, 2, v16
v_bfe_u32 v17, v1, 2, 2
v_add_u32 v16, v16, v17
v_lshlrev_b32 v16, 8, v16
v_bfe_u32 v18, v1, 4, 1
v_lshl_add_u32 v16, v18, 5, v16
v_and_b32 v18, 3, v1
v_lshl_add_u32 v16, v18, 3, v16
v_xor_b32 v18, 0, v17
v_lshl_add_u32 v2, v18, 6, v16
v_add_u32 v6, 0x10000, v2
v_xor_b32 v18, 1, v17
v_lshl_add_u32 v3, v18, 6, v16
v_add_u32 v7, 0x10000, v3
v_xor_b32 v18, 2, v17
v_lshl_add_u32 v4, v18, 6, v16
v_add_u32 v8, 0x10000, v4
v_xor_b32 v18, 3, v17
v_lshl_add_u32 v5, v18, 6, v16
v_add_u32 v9, 0x10000, v5
s_lshl_b32 s26, s16, 2
s_add_u32 s26, s26, s18
s_mul_i32 s26, s26, 294912
s_mul_i32 s27, s19, 114688
s_add_u32 s26, s26, s27
s_add_u32 s26, s26, 16842752
v_lshlrev_b32 v16, 4, v1
v_add_u32 v10, s26, v16
s_lshl_b32 s26, s20, 1
s_add_u32 s26, s26, s19
s_lshl_b32 s26, s26, 2
s_add_u32 s26, s26, s18
s_lshl_b32 s26, s26, 14
s_add_u32 s26, s26, 58720256
v_add_u32 v196, s26, v16
v_add_u32 v197, 4096, v196
v_add_u32 v198, 4096, v197
v_add_u32 v199, 4096, v198
v_lshrrev_b32 v16, 4, v1
s_lshl_b32 s26, s18, 4
v_add_u32 v17, s26, v16
v_lshlrev_b32 v17, 11, v17
v_bfe_u32 v18, v1, 2, 2
v_xor_b32 v18, v18, v16
v_lshl_add_u32 v17, v18, 6, v17
v_and_b32 v18, 3, v1
v_lshl_add_u32 v17, v18, 4, v17
s_lshl_b32 s28, s17, 8
v_add_u32 v11, s28, v17
v_add_u32 v12, 8192, v11
v_add_u32 v13, 8192, v12
v_add_u32 v14, 8192, v13
s_lshl_b32 s23, s18, 12
s_mov_b32 s21, 0
s_mul_i32 s22, s19, 3670016
s_waitcnt lgkmcnt(0)
s_mov_b32 s8, s6
s_and_b32 s9, s7, 0xffff
s_mov_b32 s10, 268435456
s_mov_b32 s11, 0x00020000
s_mov_b32 s12, s4
s_and_b32 s13, s5, 0xffff
s_mov_b32 s14, 7340032
s_mov_b32 s15, 0x00020000
s_add_u32 m0, s23, 0
s_nop 0
buffer_load_dwordx4 v11, s[12:15], s22 offen lds
s_add_u32 m0, s23, 1024
s_nop 0
buffer_load_dwordx4 v12, s[12:15], s22 offen lds
s_add_u32 m0, s23, 2048
s_nop 0
buffer_load_dwordx4 v13, s[12:15], s22 offen lds
s_add_u32 m0, s23, 3072
s_nop 0
buffer_load_dwordx4 v14, s[12:15], s22 offen lds
buffer_load_dwordx4 v[20:23], v10, s[8:11], s21 offen offset:0
buffer_load_dwordx4 v[24:27], v10, s[8:11], s21 offen offset:1024
buffer_load_dwordx4 v[28:31], v10, s[8:11], s21 offen offset:2048
buffer_load_dwordx4 v[32:35], v10, s[8:11], s21 offen offset:3072
s_add_u32 s21, s21, 4096
s_add_u32 s22, s22, 131072
s_add_u32 m0, s23, 16384
s_nop 0
buffer_load_dwordx4 v11, s[12:15], s22 offen lds
s_add_u32 m0, s23, 17408
s_nop 0
buffer_load_dwordx4 v12, s[12:15], s22 offen lds
s_add_u32 m0, s23, 18432
s_nop 0
buffer_load_dwordx4 v13, s[12:15], s22 offen lds
s_add_u32 m0, s23, 19456
s_nop 0
buffer_load_dwordx4 v14, s[12:15], s22 offen lds
buffer_load_dwordx4 v[36:39], v10, s[8:11], s21 offen offset:0
buffer_load_dwordx4 v[40:43], v10, s[8:11], s21 offen offset:1024
buffer_load_dwordx4 v[44:47], v10, s[8:11], s21 offen offset:2048
buffer_load_dwordx4 v[48:51], v10, s[8:11], s21 offen offset:3072
s_add_u32 s21, s21, 4096
s_add_u32 s22, s22, 131072
s_waitcnt vmcnt(8)
s_barrier
ds_read_b64_tr_b16 v[100:101], v2 offset:0
ds_read_b64_tr_b16 v[102:103], v2 offset:2048
ds_read_b64_tr_b16 v[104:105], v3 offset:0
ds_read_b64_tr_b16 v[106:107], v3 offset:2048
ds_read_b64_tr_b16 v[108:109], v4 offset:0
ds_read_b64_tr_b16 v[110:111], v4 offset:2048
ds_read_b64_tr_b16 v[112:113], v5 offset:0
ds_read_b64_tr_b16 v[114:115], v5 offset:2048
ds_read_b64_tr_b16 v[116:117], v2 offset:4096
ds_read_b64_tr_b16 v[118:119], v2 offset:6144
ds_read_b64_tr_b16 v[120:121], v3 offset:4096
ds_read_b64_tr_b16 v[122:123], v3 offset:6144
ds_read_b64_tr_b16 v[124:125], v4 offset:4096
ds_read_b64_tr_b16 v[126:127], v4 offset:6144
ds_read_b64_tr_b16 v[128:129], v5 offset:4096
ds_read_b64_tr_b16 v[130:131], v5 offset:6144
s_waitcnt lgkmcnt(14)
v_mfma_f32_32x32x16_bf16 v[132:147], v[100:103], v[20:23], 0
ds_read_b64_tr_b16 v[100:101], v2 offset:8192
ds_read_b64_tr_b16 v[102:103], v2 offset:10240
s_add_u32 m0, s23, 32768
s_nop 0
buffer_load_dwordx4 v11, s[12:15], s22 offen lds
s_waitcnt lgkmcnt(14)
v_mfma_f32_32x32x16_bf16 v[148:163], v[104:107], v[20:23], 0
ds_read_b64_tr_b16 v[104:105], v3 offset:8192
ds_read_b64_tr_b16 v[106:107], v3 offset:10240
s_add_u32 m0, s23, 33792
s_nop 0
buffer_load_dwordx4 v12, s[12:15], s22 offen lds
s_waitcnt lgkmcnt(14)
v_mfma_f32_32x32x16_bf16 v[164:179], v[108:111], v[20:23], 0
ds_read_b64_tr_b16 v[108:109], v4 offset:8192
ds_read_b64_tr_b16 v[110:111], v4 offset:10240
s_add_u32 m0, s23, 34816
s_nop 0
buffer_load_dwordx4 v13, s[12:15], s22 offen lds
s_waitcnt lgkmcnt(14)
v_mfma_f32_32x32x16_bf16 v[180:195], v[112:115], v[20:23], 0
ds_read_b64_tr_b16 v[112:113], v5 offset:8192
ds_read_b64_tr_b16 v[114:115], v5 offset:10240
s_add_u32 m0, s23, 35840
s_nop 0
buffer_load_dwordx4 v14, s[12:15], s22 offen lds
s_waitcnt lgkmcnt(14)
v_mfma_f32_32x32x16_bf16 v[132:147], v[116:119], v[24:27], v[132:147]
ds_read_b64_tr_b16 v[116:117], v2 offset:12288
ds_read_b64_tr_b16 v[118:119], v2 offset:14336
buffer_load_dwordx4 v[52:55], v10, s[8:11], s21 offen offset:0
s_waitcnt lgkmcnt(14)
v_mfma_f32_32x32x16_bf16 v[148:163], v[120:123], v[24:27], v[148:163]
ds_read_b64_tr_b16 v[120:121], v3 offset:12288
ds_read_b64_tr_b16 v[122:123], v3 offset:14336
buffer_load_dwordx4 v[56:59], v10, s[8:11], s21 offen offset:1024
s_waitcnt lgkmcnt(14)
v_mfma_f32_32x32x16_bf16 v[164:179], v[124:127], v[24:27], v[164:179]
ds_read_b64_tr_b16 v[124:125], v4 offset:12288
ds_read_b64_tr_b16 v[126:127], v4 offset:14336
buffer_load_dwordx4 v[60:63], v10, s[8:11], s21 offen offset:2048
s_waitcnt lgkmcnt(14)
v_mfma_f32_32x32x16_bf16 v[180:195], v[128:131], v[24:27], v[180:195]
ds_read_b64_tr_b16 v[128:129], v5 offset:12288
ds_read_b64_tr_b16 v[130:131], v5 offset:14336
buffer_load_dwordx4 v[64:67], v10, s[8:11], s21 offen offset:3072
s_add_u32 s21, s21, 4096
s_add_u32 s22, s22, 131072
s_waitcnt vmcnt(8)
s_barrier
s_waitcnt lgkmcnt(14)
v_mfma_f32_32x32x16_bf16 v[132:147], v[100:103], v[28:31], v[132:147]
ds_read_b64_tr_b16 v[100:101], v2 offset:16384
ds_read_b64_tr_b16 v[102:103], v2 offset:18432
s_add_u32 m0, s23, 49152
s_nop 0
buffer_load_dwordx4 v11, s[12:15], s22 offen lds
s_waitcnt lgkmcnt(14)
v_mfma_f32_32x32x16_bf16 v[148:163], v[104:107], v[28:31], v[148:163]
ds_read_b64_tr_b16 v[104:105], v3 offset:16384
ds_read_b64_tr_b16 v[106:107], v3 offset:18432
s_add_u32 m0, s23, 50176
s_nop 0
buffer_load_dwordx4 v12, s[12:15], s22 offen lds
s_waitcnt lgkmcnt(14)
v_mfma_f32_32x32x16_bf16 v[164:179], v[108:111], v[28:31], v[164:179]
ds_read_b64_tr_b16 v[108:109], v4 offset:16384
ds_read_b64_tr_b16 v[110:111], v4 offset:18432
s_add_u32 m0, s23, 51200
s_nop 0
buffer_load_dwordx4 v13, s[12:15], s22 offen lds
s_waitcnt lgkmcnt(14)
v_mfma_f32_32x32x16_bf16 v[180:195], v[112:115], v[28:31], v[180:195]
ds_read_b64_tr_b16 v[112:113], v5 offset:16384
ds_read_b64_tr_b16 v[114:115], v5 offset:18432
s_add_u32 m0, s23, 52224
s_nop 0
buffer_load_dwordx4 v14, s[12:15], s22 offen lds
s_waitcnt lgkmcnt(14)
v_mfma_f32_32x32x16_bf16 v[132:147], v[116:119], v[32:35], v[132:147]
ds_read_b64_tr_b16 v[116:117], v2 offset:20480
ds_read_b64_tr_b16 v[118:119], v2 offset:22528
buffer_load_dwordx4 v[68:71], v10, s[8:11], s21 offen offset:0
s_waitcnt lgkmcnt(14)
v_mfma_f32_32x32x16_bf16 v[148:163], v[120:123], v[32:35], v[148:163]
ds_read_b64_tr_b16 v[120:121], v3 offset:20480
ds_read_b64_tr_b16 v[122:123], v3 offset:22528
buffer_load_dwordx4 v[72:75], v10, s[8:11], s21 offen offset:1024
s_waitcnt lgkmcnt(14)
v_mfma_f32_32x32x16_bf16 v[164:179], v[124:127], v[32:35], v[164:179]
ds_read_b64_tr_b16 v[124:125], v4 offset:20480
ds_read_b64_tr_b16 v[126:127], v4 offset:22528
buffer_load_dwordx4 v[76:79], v10, s[8:11], s21 offen offset:2048
s_waitcnt lgkmcnt(14)
v_mfma_f32_32x32x16_bf16 v[180:195], v[128:131], v[32:35], v[180:195]
ds_read_b64_tr_b16 v[128:129], v5 offset:20480
ds_read_b64_tr_b16 v[130:131], v5 offset:22528
buffer_load_dwordx4 v[80:83], v10, s[8:11], s21 offen offset:3072
s_add_u32 s21, s21, 4096
s_add_u32 s22, s22, 131072
s_waitcnt lgkmcnt(14)
v_mfma_f32_32x32x16_bf16 v[132:147], v[100:103], v[36:39], v[132:147]
ds_read_b64_tr_b16 v[100:101], v2 offset:24576
ds_read_b64_tr_b16 v[102:103], v2 offset:26624
s_add_u32 m0, s23, 65536
s_nop 0
buffer_load_dwordx4 v11, s[12:15], s22 offen lds
s_waitcnt lgkmcnt(14)
v_mfma_f32_32x32x16_bf16 v[148:163], v[104:107], v[36:39], v[148:163]
ds_read_b64_tr_b16 v[104:105], v3 offset:24576
ds_read_b64_tr_b16 v[106:107], v3 offset:26624
s_add_u32 m0, s23, 66560
s_nop 0
buffer_load_dwordx4 v12, s[12:15], s22 offen lds
s_waitcnt lgkmcnt(14)
v_mfma_f32_32x32x16_bf16 v[164:179], v[108:111], v[36:39], v[164:179]
ds_read_b64_tr_b16 v[108:109], v4 offset:24576
ds_read_b64_tr_b16 v[110:111], v4 offset:26624
s_add_u32 m0, s23, 67584
s_nop 0
buffer_load_dwordx4 v13, s[12:15], s22 offen lds
s_waitcnt lgkmcnt(14)
v_mfma_f32_32x32x16_bf16 v[180:195], v[112:115], v[36:39], v[180:195]
ds_read_b64_tr_b16 v[112:113], v5 offset:24576
ds_read_b64_tr_b16 v[114:115], v5 offset:26624
s_add_u32 m0, s23, 68608
s_nop 0
buffer_load_dwordx4 v14, s[12:15], s22 offen lds
s_waitcnt lgkmcnt(14)
v_mfma_f32_32x32x16_bf16 v[132:147], v[116:119], v[40:43], v[132:147]
ds_read_b64_tr_b16 v[116:117], v2 offset:28672
ds_read_b64_tr_b16 v[118:119], v2 offset:30720
buffer_load_dwordx4 v[84:87], v10, s[8:11], s21 offen offset:0
s_waitcnt lgkmcnt(14)
v_mfma_f32_32x32x16_bf16 v[148:163], v[120:123], v[40:43], v[148:163]
ds_read_b64_tr_b16 v[120:121], v3 offset:28672
ds_read_b64_tr_b16 v[122:123], v3 offset:30720
buffer_load_dwordx4 v[88:91], v10, s[8:11], s21 offen offset:1024
s_waitcnt lgkmcnt(14)
v_mfma_f32_32x32x16_bf16 v[164:179], v[124:127], v[40:43], v[164:179]
ds_read_b64_tr_b16 v[124:125], v4 offset:28672
ds_read_b64_tr_b16 v[126:127], v4 offset:30720
buffer_load_dwordx4 v[92:95], v10, s[8:11], s21 offen offset:2048
s_waitcnt lgkmcnt(14)
v_mfma_f32_32x32x16_bf16 v[180:195], v[128:131], v[40:43], v[180:195]
ds_read_b64_tr_b16 v[128:129], v5 offset:28672
ds_read_b64_tr_b16 v[130:131], v5 offset:30720
buffer_load_dwordx4 v[96:99], v10, s[8:11], s21 offen offset:3072
s_add_u32 s21, s21, 4096
s_add_u32 s22, s22, 131072
s_waitcnt vmcnt(16)
s_barrier
s_waitcnt lgkmcnt(14)
v_mfma_f32_32x32x16_bf16 v[132:147], v[100:103], v[44:47], v[132:147]
ds_read_b64_tr_b16 v[100:101], v2 offset:32768
ds_read_b64_tr_b16 v[102:103], v2 offset:34816
s_add_u32 m0, s23, 0
s_nop 0
buffer_load_dwordx4 v11, s[12:15], s22 offen lds
s_waitcnt lgkmcnt(14)
v_mfma_f32_32x32x16_bf16 v[148:163], v[104:107], v[44:47], v[148:163]
ds_read_b64_tr_b16 v[104:105], v3 offset:32768
ds_read_b64_tr_b16 v[106:107], v3 offset:34816
s_add_u32 m0, s23, 1024
s_nop 0
buffer_load_dwordx4 v12, s[12:15], s22 offen lds
s_waitcnt lgkmcnt(14)
v_mfma_f32_32x32x16_bf16 v[164:179], v[108:111], v[44:47], v[164:179]
ds_read_b64_tr_b16 v[108:109], v4 offset:32768
ds_read_b64_tr_b16 v[110:111], v4 offset:34816
s_add_u32 m0, s23, 2048
s_nop 0
buffer_load_dwordx4 v13, s[12:15], s22 offen lds
s_waitcnt lgkmcnt(14)
v_mfma_f32_32x32x16_bf16 v[180:195], v[112:115], v[44:47], v[180:195]
ds_read_b64_tr_b16 v[112:113], v5 offset:32768
ds_read_b64_tr_b16 v[114:115], v5 offset:34816
s_add_u32 m0, s23, 3072
s_nop 0
buffer_load_dwordx4 v14, s[12:15], s22 offen lds
s_waitcnt lgkmcnt(14)
v_mfma_f32_32x32x16_bf16 v[132:147], v[116:119], v[48:51], v[132:147]
ds_read_b64_tr_b16 v[116:117], v2 offset:36864
ds_read_b64_tr_b16 v[118:119], v2 offset:38912
buffer_load_dwordx4 v[20:23], v10, s[8:11], s21 offen offset:0
s_waitcnt lgkmcnt(14)
v_mfma_f32_32x32x16_bf16 v[148:163], v[120:123], v[48:51], v[148:163]
ds_read_b64_tr_b16 v[120:121], v3 offset:36864
ds_read_b64_tr_b16 v[122:123], v3 offset:38912
buffer_load_dwordx4 v[24:27], v10, s[8:11], s21 offen offset:1024
s_waitcnt lgkmcnt(14)
v_mfma_f32_32x32x16_bf16 v[164:179], v[124:127], v[48:51], v[164:179]
ds_read_b64_tr_b16 v[124:125], v4 offset:36864
ds_read_b64_tr_b16 v[126:127], v4 offset:38912
buffer_load_dwordx4 v[28:31], v10, s[8:11], s21 offen offset:2048
s_waitcnt lgkmcnt(14)
v_mfma_f32_32x32x16_bf16 v[180:195], v[128:131], v[48:51], v[180:195]
ds_read_b64_tr_b16 v[128:129], v5 offset:36864
ds_read_b64_tr_b16 v[130:131], v5 offset:38912
buffer_load_dwordx4 v[32:35], v10, s[8:11], s21 offen offset:3072
s_add_u32 s21, s21, 4096
s_add_u32 s22, s22, 131072
s_waitcnt lgkmcnt(14)
v_mfma_f32_32x32x16_bf16 v[132:147], v[100:103], v[52:55], v[132:147]
ds_read_b64_tr_b16 v[100:101], v2 offset:40960
ds_read_b64_tr_b16 v[102:103], v2 offset:43008
s_waitcnt lgkmcnt(14)
v_mfma_f32_32x32x16_bf16 v[148:163], v[104:107], v[52:55], v[148:163]
ds_read_b64_tr_b16 v[104:105], v3 offset:40960
ds_read_b64_tr_b16 v[106:107], v3 offset:43008
s_waitcnt lgkmcnt(14)
v_mfma_f32_32x32x16_bf16 v[164:179], v[108:111], v[52:55], v[164:179]
ds_read_b64_tr_b16 v[108:109], v4 offset:40960
ds_read_b64_tr_b16 v[110:111], v4 offset:43008
s_waitcnt lgkmcnt(14)
v_mfma_f32_32x32x16_bf16 v[180:195], v[112:115], v[52:55], v[180:195]
ds_read_b64_tr_b16 v[112:113], v5 offset:40960
ds_read_b64_tr_b16 v[114:115], v5 offset:43008
s_waitcnt lgkmcnt(14)
v_mfma_f32_32x32x16_bf16 v[132:147], v[116:119], v[56:59], v[132:147]
ds_read_b64_tr_b16 v[116:117], v2 offset:45056
ds_read_b64_tr_b16 v[118:119], v2 offset:47104
s_waitcnt lgkmcnt(14)
v_mfma_f32_32x32x16_bf16 v[148:163], v[120:123], v[56:59], v[148:163]
ds_read_b64_tr_b16 v[120:121], v3 offset:45056
ds_read_b64_tr_b16 v[122:123], v3 offset:47104
s_waitcnt lgkmcnt(14)
v_mfma_f32_32x32x16_bf16 v[164:179], v[124:127], v[56:59], v[164:179]
ds_read_b64_tr_b16 v[124:125], v4 offset:45056
ds_read_b64_tr_b16 v[126:127], v4 offset:47104
s_waitcnt lgkmcnt(14)
v_mfma_f32_32x32x16_bf16 v[180:195], v[128:131], v[56:59], v[180:195]
ds_read_b64_tr_b16 v[128:129], v5 offset:45056
ds_read_b64_tr_b16 v[130:131], v5 offset:47104
s_waitcnt vmcnt(16)
s_barrier
s_waitcnt lgkmcnt(14)
v_mfma_f32_32x32x16_bf16 v[132:147], v[100:103], v[60:63], v[132:147]
ds_read_b64_tr_b16 v[100:101], v2 offset:49152
ds_read_b64_tr_b16 v[102:103], v2 offset:51200
s_add_u32 m0, s23, 16384
s_nop 0
buffer_load_dwordx4 v11, s[12:15], s22 offen lds
s_waitcnt lgkmcnt(14)
v_mfma_f32_32x32x16_bf16 v[148:163], v[104:107], v[60:63], v[148:163]
ds_read_b64_tr_b16 v[104:105], v3 offset:49152
ds_read_b64_tr_b16 v[106:107], v3 offset:51200
s_add_u32 m0, s23, 17408
s_nop 0
buffer_load_dwordx4 v12, s[12:15], s22 offen lds
s_waitcnt lgkmcnt(14)
v_mfma_f32_32x32x16_bf16 v[164:179], v[108:111], v[60:63], v[164:179]
ds_read_b64_tr_b16 v[108:109], v4 offset:49152
ds_read_b64_tr_b16 v[110:111], v4 offset:51200
s_add_u32 m0, s23, 18432
s_nop 0
buffer_load_dwordx4 v13, s[12:15], s22 offen lds
s_waitcnt lgkmcnt(14)
v_mfma_f32_32x32x16_bf16 v[180:195], v[112:115], v[60:63], v[180:195]
ds_read_b64_tr_b16 v[112:113], v5 offset:49152
ds_read_b64_tr_b16 v[114:115], v5 offset:51200
s_add_u32 m0, s23, 19456
s_nop 0
buffer_load_dwordx4 v14, s[12:15], s22 offen lds
s_waitcnt lgkmcnt(14)
v_mfma_f32_32x32x16_bf16 v[132:147], v[116:119], v[64:67], v[132:147]
ds_read_b64_tr_b16 v[116:117], v2 offset:53248
ds_read_b64_tr_b16 v[118:119], v2 offset:55296
buffer_load_dwordx4 v[36:39], v10, s[8:11], s21 offen offset:0
s_waitcnt lgkmcnt(14)
v_mfma_f32_32x32x16_bf16 v[148:163], v[120:123], v[64:67], v[148:163]
ds_read_b64_tr_b16 v[120:121], v3 offset:53248
ds_read_b64_tr_b16 v[122:123], v3 offset:55296
buffer_load_dwordx4 v[40:43], v10, s[8:11], s21 offen offset:1024
s_waitcnt lgkmcnt(14)
v_mfma_f32_32x32x16_bf16 v[164:179], v[124:127], v[64:67], v[164:179]
ds_read_b64_tr_b16 v[124:125], v4 offset:53248
ds_read_b64_tr_b16 v[126:127], v4 offset:55296
buffer_load_dwordx4 v[44:47], v10, s[8:11], s21 offen offset:2048
s_waitcnt lgkmcnt(14)
v_mfma_f32_32x32x16_bf16 v[180:195], v[128:131], v[64:67], v[180:195]
ds_read_b64_tr_b16 v[128:129], v5 offset:53248
ds_read_b64_tr_b16 v[130:131], v5 offset:55296
buffer_load_dwordx4 v[48:51], v10, s[8:11], s21 offen offset:3072
s_add_u32 s21, s21, 4096
s_add_u32 s22, s22, 131072
s_mov_b32 s24, 0
L_k2_gloop_8:
s_waitcnt lgkmcnt(14)
v_mfma_f32_32x32x16_bf16 v[132:147], v[100:103], v[68:71], v[132:147]
ds_read_b64_tr_b16 v[100:101], v2 offset:57344
ds_read_b64_tr_b16 v[102:103], v2 offset:59392
s_waitcnt lgkmcnt(14)
v_mfma_f32_32x32x16_bf16 v[148:163], v[104:107], v[68:71], v[148:163]
ds_read_b64_tr_b16 v[104:105], v3 offset:57344
ds_read_b64_tr_b16 v[106:107], v3 offset:59392
s_waitcnt lgkmcnt(14)
v_mfma_f32_32x32x16_bf16 v[164:179], v[108:111], v[68:71], v[164:179]
ds_read_b64_tr_b16 v[108:109], v4 offset:57344
ds_read_b64_tr_b16 v[110:111], v4 offset:59392
s_waitcnt lgkmcnt(14)
v_mfma_f32_32x32x16_bf16 v[180:195], v[112:115], v[68:71], v[180:195]
ds_read_b64_tr_b16 v[112:113], v5 offset:57344
ds_read_b64_tr_b16 v[114:115], v5 offset:59392
s_waitcnt lgkmcnt(14)
v_mfma_f32_32x32x16_bf16 v[132:147], v[116:119], v[72:75], v[132:147]
ds_read_b64_tr_b16 v[116:117], v2 offset:61440
ds_read_b64_tr_b16 v[118:119], v2 offset:63488
s_waitcnt lgkmcnt(14)
v_mfma_f32_32x32x16_bf16 v[148:163], v[120:123], v[72:75], v[148:163]
ds_read_b64_tr_b16 v[120:121], v3 offset:61440
ds_read_b64_tr_b16 v[122:123], v3 offset:63488
s_waitcnt lgkmcnt(14)
v_mfma_f32_32x32x16_bf16 v[164:179], v[124:127], v[72:75], v[164:179]
ds_read_b64_tr_b16 v[124:125], v4 offset:61440
ds_read_b64_tr_b16 v[126:127], v4 offset:63488
s_waitcnt lgkmcnt(14)
v_mfma_f32_32x32x16_bf16 v[180:195], v[128:131], v[72:75], v[180:195]
ds_read_b64_tr_b16 v[128:129], v5 offset:61440
ds_read_b64_tr_b16 v[130:131], v5 offset:63488
s_waitcnt vmcnt(16)
s_barrier
s_waitcnt lgkmcnt(14)
v_mfma_f32_32x32x16_bf16 v[132:147], v[100:103], v[76:79], v[132:147]
ds_read_b64_tr_b16 v[100:101], v6 offset:0
ds_read_b64_tr_b16 v[102:103], v6 offset:2048
s_add_u32 m0, s23, 32768
s_nop 0
buffer_load_dwordx4 v11, s[12:15], s22 offen lds
s_waitcnt lgkmcnt(14)
v_mfma_f32_32x32x16_bf16 v[148:163], v[104:107], v[76:79], v[148:163]
ds_read_b64_tr_b16 v[104:105], v7 offset:0
ds_read_b64_tr_b16 v[106:107], v7 offset:2048
s_add_u32 m0, s23, 33792
s_nop 0
buffer_load_dwordx4 v12, s[12:15], s22 offen lds
s_waitcnt lgkmcnt(14)
v_mfma_f32_32x32x16_bf16 v[164:179], v[108:111], v[76:79], v[164:179]
ds_read_b64_tr_b16 v[108:109], v8 offset:0
ds_read_b64_tr_b16 v[110:111], v8 offset:2048
s_add_u32 m0, s23, 34816
s_nop 0
buffer_load_dwordx4 v13, s[12:15], s22 offen lds
s_waitcnt lgkmcnt(14)
v_mfma_f32_32x32x16_bf16 v[180:195], v[112:115], v[76:79], v[180:195]
ds_read_b64_tr_b16 v[112:113], v9 offset:0
ds_read_b64_tr_b16 v[114:115], v9 offset:2048
s_add_u32 m0, s23, 35840
s_nop 0
buffer_load_dwordx4 v14, s[12:15], s22 offen lds
s_waitcnt lgkmcnt(14)
v_mfma_f32_32x32x16_bf16 v[132:147], v[116:119], v[80:83], v[132:147]
ds_read_b64_tr_b16 v[116:117], v6 offset:4096
ds_read_b64_tr_b16 v[118:119], v6 offset:6144
buffer_load_dwordx4 v[52:55], v10, s[8:11], s21 offen offset:0
s_waitcnt lgkmcnt(14)
v_mfma_f32_32x32x16_bf16 v[148:163], v[120:123], v[80:83], v[148:163]
ds_read_b64_tr_b16 v[120:121], v7 offset:4096
ds_read_b64_tr_b16 v[122:123], v7 offset:6144
buffer_load_dwordx4 v[56:59], v10, s[8:11], s21 offen offset:1024
s_waitcnt lgkmcnt(14)
v_mfma_f32_32x32x16_bf16 v[164:179], v[124:127], v[80:83], v[164:179]
ds_read_b64_tr_b16 v[124:125], v8 offset:4096
ds_read_b64_tr_b16 v[126:127], v8 offset:6144
buffer_load_dwordx4 v[60:63], v10, s[8:11], s21 offen offset:2048
s_waitcnt lgkmcnt(14)
v_mfma_f32_32x32x16_bf16 v[180:195], v[128:131], v[80:83], v[180:195]
ds_read_b64_tr_b16 v[128:129], v9 offset:4096
ds_read_b64_tr_b16 v[130:131], v9 offset:6144
buffer_load_dwordx4 v[64:67], v10, s[8:11], s21 offen offset:3072
s_add_u32 s21, s21, 4096
s_add_u32 s22, s22, 131072
s_waitcnt lgkmcnt(14)
v_mfma_f32_32x32x16_bf16 v[132:147], v[100:103], v[84:87], v[132:147]
ds_read_b64_tr_b16 v[100:101], v6 offset:8192
ds_read_b64_tr_b16 v[102:103], v6 offset:10240
s_waitcnt lgkmcnt(14)
v_mfma_f32_32x32x16_bf16 v[148:163], v[104:107], v[84:87], v[148:163]
ds_read_b64_tr_b16 v[104:105], v7 offset:8192
ds_read_b64_tr_b16 v[106:107], v7 offset:10240
s_waitcnt lgkmcnt(14)
v_mfma_f32_32x32x16_bf16 v[164:179], v[108:111], v[84:87], v[164:179]
ds_read_b64_tr_b16 v[108:109], v8 offset:8192
ds_read_b64_tr_b16 v[110:111], v8 offset:10240
s_waitcnt lgkmcnt(14)
v_mfma_f32_32x32x16_bf16 v[180:195], v[112:115], v[84:87], v[180:195]
ds_read_b64_tr_b16 v[112:113], v9 offset:8192
ds_read_b64_tr_b16 v[114:115], v9 offset:10240
s_waitcnt lgkmcnt(14)
v_mfma_f32_32x32x16_bf16 v[132:147], v[116:119], v[88:91], v[132:147]
ds_read_b64_tr_b16 v[116:117], v6 offset:12288
ds_read_b64_tr_b16 v[118:119], v6 offset:14336
s_waitcnt lgkmcnt(14)
v_mfma_f32_32x32x16_bf16 v[148:163], v[120:123], v[88:91], v[148:163]
ds_read_b64_tr_b16 v[120:121], v7 offset:12288
ds_read_b64_tr_b16 v[122:123], v7 offset:14336
s_waitcnt lgkmcnt(14)
v_mfma_f32_32x32x16_bf16 v[164:179], v[124:127], v[88:91], v[164:179]
ds_read_b64_tr_b16 v[124:125], v8 offset:12288
ds_read_b64_tr_b16 v[126:127], v8 offset:14336
s_waitcnt lgkmcnt(14)
v_mfma_f32_32x32x16_bf16 v[180:195], v[128:131], v[88:91], v[180:195]
ds_read_b64_tr_b16 v[128:129], v9 offset:12288
ds_read_b64_tr_b16 v[130:131], v9 offset:14336
s_waitcnt vmcnt(16)
s_barrier
s_waitcnt lgkmcnt(14)
v_mfma_f32_32x32x16_bf16 v[132:147], v[100:103], v[92:95], v[132:147]
ds_read_b64_tr_b16 v[100:101], v2 offset:0
ds_read_b64_tr_b16 v[102:103], v2 offset:2048
s_add_u32 m0, s23, 49152
s_nop 0
buffer_load_dwordx4 v11, s[12:15], s22 offen lds
s_waitcnt lgkmcnt(14)
v_mfma_f32_32x32x16_bf16 v[148:163], v[104:107], v[92:95], v[148:163]
ds_read_b64_tr_b16 v[104:105], v3 offset:0
ds_read_b64_tr_b16 v[106:107], v3 offset:2048
s_add_u32 m0, s23, 50176
s_nop 0
buffer_load_dwordx4 v12, s[12:15], s22 offen lds
s_waitcnt lgkmcnt(14)
v_mfma_f32_32x32x16_bf16 v[164:179], v[108:111], v[92:95], v[164:179]
ds_read_b64_tr_b16 v[108:109], v4 offset:0
ds_read_b64_tr_b16 v[110:111], v4 offset:2048
s_add_u32 m0, s23, 51200
s_nop 0
buffer_load_dwordx4 v13, s[12:15], s22 offen lds
s_waitcnt lgkmcnt(14)
v_mfma_f32_32x32x16_bf16 v[180:195], v[112:115], v[92:95], v[180:195]
ds_read_b64_tr_b16 v[112:113], v5 offset:0
ds_read_b64_tr_b16 v[114:115], v5 offset:2048
s_add_u32 m0, s23, 52224
s_nop 0
buffer_load_dwordx4 v14, s[12:15], s22 offen lds
s_waitcnt lgkmcnt(14)
v_mfma_f32_32x32x16_bf16 v[132:147], v[116:119], v[96:99], v[132:147]
ds_read_b64_tr_b16 v[116:117], v2 offset:4096
ds_read_b64_tr_b16 v[118:119], v2 offset:6144
buffer_load_dwordx4 v[68:71], v10, s[8:11], s21 offen offset:0
s_waitcnt lgkmcnt(14)
v_mfma_f32_32x32x16_bf16 v[148:163], v[120:123], v[96:99], v[148:163]
ds_read_b64_tr_b16 v[120:121], v3 offset:4096
ds_read_b64_tr_b16 v[122:123], v3 offset:6144
buffer_load_dwordx4 v[72:75], v10, s[8:11], s21 offen offset:1024
s_waitcnt lgkmcnt(14)
v_mfma_f32_32x32x16_bf16 v[164:179], v[124:127], v[96:99], v[164:179]
ds_read_b64_tr_b16 v[124:125], v4 offset:4096
ds_read_b64_tr_b16 v[126:127], v4 offset:6144
buffer_load_dwordx4 v[76:79], v10, s[8:11], s21 offen offset:2048
s_waitcnt lgkmcnt(14)
v_mfma_f32_32x32x16_bf16 v[180:195], v[128:131], v[96:99], v[180:195]
ds_read_b64_tr_b16 v[128:129], v5 offset:4096
ds_read_b64_tr_b16 v[130:131], v5 offset:6144
buffer_load_dwordx4 v[80:83], v10, s[8:11], s21 offen offset:3072
s_add_u32 s21, s21, 4096
s_add_u32 s22, s22, 131072
s_waitcnt lgkmcnt(14)
v_mfma_f32_32x32x16_bf16 v[132:147], v[100:103], v[20:23], v[132:147]
ds_read_b64_tr_b16 v[100:101], v2 offset:8192
ds_read_b64_tr_b16 v[102:103], v2 offset:10240
s_waitcnt lgkmcnt(14)
v_mfma_f32_32x32x16_bf16 v[148:163], v[104:107], v[20:23], v[148:163]
ds_read_b64_tr_b16 v[104:105], v3 offset:8192
ds_read_b64_tr_b16 v[106:107], v3 offset:10240
s_waitcnt lgkmcnt(14)
v_mfma_f32_32x32x16_bf16 v[164:179], v[108:111], v[20:23], v[164:179]
ds_read_b64_tr_b16 v[108:109], v4 offset:8192
ds_read_b64_tr_b16 v[110:111], v4 offset:10240
s_waitcnt lgkmcnt(14)
v_mfma_f32_32x32x16_bf16 v[180:195], v[112:115], v[20:23], v[180:195]
ds_read_b64_tr_b16 v[112:113], v5 offset:8192
ds_read_b64_tr_b16 v[114:115], v5 offset:10240
s_waitcnt lgkmcnt(14)
v_mfma_f32_32x32x16_bf16 v[132:147], v[116:119], v[24:27], v[132:147]
ds_read_b64_tr_b16 v[116:117], v2 offset:12288
ds_read_b64_tr_b16 v[118:119], v2 offset:14336
s_waitcnt lgkmcnt(14)
v_mfma_f32_32x32x16_bf16 v[148:163], v[120:123], v[24:27], v[148:163]
ds_read_b64_tr_b16 v[120:121], v3 offset:12288
ds_read_b64_tr_b16 v[122:123], v3 offset:14336
s_waitcnt lgkmcnt(14)
v_mfma_f32_32x32x16_bf16 v[164:179], v[124:127], v[24:27], v[164:179]
ds_read_b64_tr_b16 v[124:125], v4 offset:12288
ds_read_b64_tr_b16 v[126:127], v4 offset:14336
s_waitcnt lgkmcnt(14)
v_mfma_f32_32x32x16_bf16 v[180:195], v[128:131], v[24:27], v[180:195]
ds_read_b64_tr_b16 v[128:129], v5 offset:12288
ds_read_b64_tr_b16 v[130:131], v5 offset:14336
s_waitcnt vmcnt(16)
s_barrier
s_waitcnt lgkmcnt(14)
v_mfma_f32_32x32x16_bf16 v[132:147], v[100:103], v[28:31], v[132:147]
ds_read_b64_tr_b16 v[100:101], v2 offset:16384
ds_read_b64_tr_b16 v[102:103], v2 offset:18432
s_add_u32 m0, s23, 65536
s_nop 0
buffer_load_dwordx4 v11, s[12:15], s22 offen lds
s_waitcnt lgkmcnt(14)
v_mfma_f32_32x32x16_bf16 v[148:163], v[104:107], v[28:31], v[148:163]
ds_read_b64_tr_b16 v[104:105], v3 offset:16384
ds_read_b64_tr_b16 v[106:107], v3 offset:18432
s_add_u32 m0, s23, 66560
s_nop 0
buffer_load_dwordx4 v12, s[12:15], s22 offen lds
s_waitcnt lgkmcnt(14)
v_mfma_f32_32x32x16_bf16 v[164:179], v[108:111], v[28:31], v[164:179]
ds_read_b64_tr_b16 v[108:109], v4 offset:16384
ds_read_b64_tr_b16 v[110:111], v4 offset:18432
s_add_u32 m0, s23, 67584
s_nop 0
buffer_load_dwordx4 v13, s[12:15], s22 offen lds
s_waitcnt lgkmcnt(14)
v_mfma_f32_32x32x16_bf16 v[180:195], v[112:115], v[28:31], v[180:195]
ds_read_b64_tr_b16 v[112:113], v5 offset:16384
ds_read_b64_tr_b16 v[114:115], v5 offset:18432
s_add_u32 m0, s23, 68608
s_nop 0
buffer_load_dwordx4 v14, s[12:15], s22 offen lds
s_waitcnt lgkmcnt(14)
v_mfma_f32_32x32x16_bf16 v[132:147], v[116:119], v[32:35], v[132:147]
ds_read_b64_tr_b16 v[116:117], v2 offset:20480
ds_read_b64_tr_b16 v[118:119], v2 offset:22528
buffer_load_dwordx4 v[84:87], v10, s[8:11], s21 offen offset:0
s_waitcnt lgkmcnt(14)
v_mfma_f32_32x32x16_bf16 v[148:163], v[120:123], v[32:35], v[148:163]
ds_read_b64_tr_b16 v[120:121], v3 offset:20480
ds_read_b64_tr_b16 v[122:123], v3 offset:22528
buffer_load_dwordx4 v[88:91], v10, s[8:11], s21 offen offset:1024
s_waitcnt lgkmcnt(14)
v_mfma_f32_32x32x16_bf16 v[164:179], v[124:127], v[32:35], v[164:179]
ds_read_b64_tr_b16 v[124:125], v4 offset:20480
ds_read_b64_tr_b16 v[126:127], v4 offset:22528
buffer_load_dwordx4 v[92:95], v10, s[8:11], s21 offen offset:2048
s_waitcnt lgkmcnt(14)
v_mfma_f32_32x32x16_bf16 v[180:195], v[128:131], v[32:35], v[180:195]
ds_read_b64_tr_b16 v[128:129], v5 offset:20480
ds_read_b64_tr_b16 v[130:131], v5 offset:22528
buffer_load_dwordx4 v[96:99], v10, s[8:11], s21 offen offset:3072
s_add_u32 s21, s21, 4096
s_add_u32 s22, s22, 131072
s_waitcnt lgkmcnt(14)
v_mfma_f32_32x32x16_bf16 v[132:147], v[100:103], v[36:39], v[132:147]
ds_read_b64_tr_b16 v[100:101], v2 offset:24576
ds_read_b64_tr_b16 v[102:103], v2 offset:26624
s_waitcnt lgkmcnt(14)
v_mfma_f32_32x32x16_bf16 v[148:163], v[104:107], v[36:39], v[148:163]
ds_read_b64_tr_b16 v[104:105], v3 offset:24576
ds_read_b64_tr_b16 v[106:107], v3 offset:26624
s_waitcnt lgkmcnt(14)
v_mfma_f32_32x32x16_bf16 v[164:179], v[108:111], v[36:39], v[164:179]
ds_read_b64_tr_b16 v[108:109], v4 offset:24576
ds_read_b64_tr_b16 v[110:111], v4 offset:26624
s_waitcnt lgkmcnt(14)
v_mfma_f32_32x32x16_bf16 v[180:195], v[112:115], v[36:39], v[180:195]
ds_read_b64_tr_b16 v[112:113], v5 offset:24576
ds_read_b64_tr_b16 v[114:115], v5 offset:26624
s_waitcnt lgkmcnt(14)
v_mfma_f32_32x32x16_bf16 v[132:147], v[116:119], v[40:43], v[132:147]
ds_read_b64_tr_b16 v[116:117], v2 offset:28672
ds_read_b64_tr_b16 v[118:119], v2 offset:30720
s_waitcnt lgkmcnt(14)
v_mfma_f32_32x32x16_bf16 v[148:163], v[120:123], v[40:43], v[148:163]
ds_read_b64_tr_b16 v[120:121], v3 offset:28672
ds_read_b64_tr_b16 v[122:123], v3 offset:30720
s_waitcnt lgkmcnt(14)
v_mfma_f32_32x32x16_bf16 v[164:179], v[124:127], v[40:43], v[164:179]
ds_read_b64_tr_b16 v[124:125], v4 offset:28672
ds_read_b64_tr_b16 v[126:127], v4 offset:30720
s_waitcnt lgkmcnt(14)
v_mfma_f32_32x32x16_bf16 v[180:195], v[128:131], v[40:43], v[180:195]
ds_read_b64_tr_b16 v[128:129], v5 offset:28672
ds_read_b64_tr_b16 v[130:131], v5 offset:30720
s_waitcnt vmcnt(16)
s_barrier
s_waitcnt lgkmcnt(14)
v_mfma_f32_32x32x16_bf16 v[132:147], v[100:103], v[44:47], v[132:147]
ds_read_b64_tr_b16 v[100:101], v2 offset:32768
ds_read_b64_tr_b16 v[102:103], v2 offset:34816
s_add_u32 m0, s23, 0
s_nop 0
buffer_load_dwordx4 v11, s[12:15], s22 offen lds
s_waitcnt lgkmcnt(14)
v_mfma_f32_32x32x16_bf16 v[148:163], v[104:107], v[44:47], v[148:163]
ds_read_b64_tr_b16 v[104:105], v3 offset:32768
ds_read_b64_tr_b16 v[106:107], v3 offset:34816
s_add_u32 m0, s23, 1024
s_nop 0
buffer_load_dwordx4 v12, s[12:15], s22 offen lds
s_waitcnt lgkmcnt(14)
v_mfma_f32_32x32x16_bf16 v[164:179], v[108:111], v[44:47], v[164:179]
ds_read_b64_tr_b16 v[108:109], v4 offset:32768
ds_read_b64_tr_b16 v[110:111], v4 offset:34816
s_add_u32 m0, s23, 2048
s_nop 0
buffer_load_dwordx4 v13, s[12:15], s22 offen lds
s_waitcnt lgkmcnt(14)
v_mfma_f32_32x32x16_bf16 v[180:195], v[112:115], v[44:47], v[180:195]
ds_read_b64_tr_b16 v[112:113], v5 offset:32768
ds_read_b64_tr_b16 v[114:115], v5 offset:34816
s_add_u32 m0, s23, 3072
s_nop 0
buffer_load_dwordx4 v14, s[12:15], s22 offen lds
s_waitcnt lgkmcnt(14)
v_mfma_f32_32x32x16_bf16 v[132:147], v[116:119], v[48:51], v[132:147]
ds_read_b64_tr_b16 v[116:117], v2 offset:36864
ds_read_b64_tr_b16 v[118:119], v2 offset:38912
buffer_load_dwordx4 v[20:23], v10, s[8:11], s21 offen offset:0
s_waitcnt lgkmcnt(14)
v_mfma_f32_32x32x16_bf16 v[148:163], v[120:123], v[48:51], v[148:163]
ds_read_b64_tr_b16 v[120:121], v3 offset:36864
ds_read_b64_tr_b16 v[122:123], v3 offset:38912
buffer_load_dwordx4 v[24:27], v10, s[8:11], s21 offen offset:1024
s_waitcnt lgkmcnt(14)
v_mfma_f32_32x32x16_bf16 v[164:179], v[124:127], v[48:51], v[164:179]
ds_read_b64_tr_b16 v[124:125], v4 offset:36864
ds_read_b64_tr_b16 v[126:127], v4 offset:38912
buffer_load_dwordx4 v[28:31], v10, s[8:11], s21 offen offset:2048
s_waitcnt lgkmcnt(14)
v_mfma_f32_32x32x16_bf16 v[180:195], v[128:131], v[48:51], v[180:195]
ds_read_b64_tr_b16 v[128:129], v5 offset:36864
ds_read_b64_tr_b16 v[130:131], v5 offset:38912
buffer_load_dwordx4 v[32:35], v10, s[8:11], s21 offen offset:3072
s_add_u32 s21, s21, 4096
s_add_u32 s22, s22, 131072
s_waitcnt lgkmcnt(14)
v_mfma_f32_32x32x16_bf16 v[132:147], v[100:103], v[52:55], v[132:147]
ds_read_b64_tr_b16 v[100:101], v2 offset:40960
ds_read_b64_tr_b16 v[102:103], v2 offset:43008
s_waitcnt lgkmcnt(14)
v_mfma_f32_32x32x16_bf16 v[148:163], v[104:107], v[52:55], v[148:163]
ds_read_b64_tr_b16 v[104:105], v3 offset:40960
ds_read_b64_tr_b16 v[106:107], v3 offset:43008
s_waitcnt lgkmcnt(14)
v_mfma_f32_32x32x16_bf16 v[164:179], v[108:111], v[52:55], v[164:179]
ds_read_b64_tr_b16 v[108:109], v4 offset:40960
ds_read_b64_tr_b16 v[110:111], v4 offset:43008
s_waitcnt lgkmcnt(14)
v_mfma_f32_32x32x16_bf16 v[180:195], v[112:115], v[52:55], v[180:195]
ds_read_b64_tr_b16 v[112:113], v5 offset:40960
ds_read_b64_tr_b16 v[114:115], v5 offset:43008
s_waitcnt lgkmcnt(14)
v_mfma_f32_32x32x16_bf16 v[132:147], v[116:119], v[56:59], v[132:147]
ds_read_b64_tr_b16 v[116:117], v2 offset:45056
ds_read_b64_tr_b16 v[118:119], v2 offset:47104
s_waitcnt lgkmcnt(14)
v_mfma_f32_32x32x16_bf16 v[148:163], v[120:123], v[56:59], v[148:163]
ds_read_b64_tr_b16 v[120:121], v3 offset:45056
ds_read_b64_tr_b16 v[122:123], v3 offset:47104
s_waitcnt lgkmcnt(14)
v_mfma_f32_32x32x16_bf16 v[164:179], v[124:127], v[56:59], v[164:179]
ds_read_b64_tr_b16 v[124:125], v4 offset:45056
ds_read_b64_tr_b16 v[126:127], v4 offset:47104
s_waitcnt lgkmcnt(14)
v_mfma_f32_32x32x16_bf16 v[180:195], v[128:131], v[56:59], v[180:195]
ds_read_b64_tr_b16 v[128:129], v5 offset:45056
ds_read_b64_tr_b16 v[130:131], v5 offset:47104
s_waitcnt vmcnt(16)
s_barrier
s_waitcnt lgkmcnt(14)
v_mfma_f32_32x32x16_bf16 v[132:147], v[100:103], v[60:63], v[132:147]
ds_read_b64_tr_b16 v[100:101], v2 offset:49152
ds_read_b64_tr_b16 v[102:103], v2 offset:51200
s_add_u32 m0, s23, 16384
s_nop 0
buffer_load_dwordx4 v11, s[12:15], s22 offen lds
s_waitcnt lgkmcnt(14)
v_mfma_f32_32x32x16_bf16 v[148:163], v[104:107], v[60:63], v[148:163]
ds_read_b64_tr_b16 v[104:105], v3 offset:49152
ds_read_b64_tr_b16 v[106:107], v3 offset:51200
s_add_u32 m0, s23, 17408
s_nop 0
buffer_load_dwordx4 v12, s[12:15], s22 offen lds
s_waitcnt lgkmcnt(14)
v_mfma_f32_32x32x16_bf16 v[164:179], v[108:111], v[60:63], v[164:179]
ds_read_b64_tr_b16 v[108:109], v4 offset:49152
ds_read_b64_tr_b16 v[110:111], v4 offset:51200
s_add_u32 m0, s23, 18432
s_nop 0
buffer_load_dwordx4 v13, s[12:15], s22 offen lds
s_waitcnt lgkmcnt(14)
v_mfma_f32_32x32x16_bf16 v[180:195], v[112:115], v[60:63], v[180:195]
ds_read_b64_tr_b16 v[112:113], v5 offset:49152
ds_read_b64_tr_b16 v[114:115], v5 offset:51200
s_add_u32 m0, s23, 19456
s_nop 0
buffer_load_dwordx4 v14, s[12:15], s22 offen lds
s_waitcnt lgkmcnt(14)
v_mfma_f32_32x32x16_bf16 v[132:147], v[116:119], v[64:67], v[132:147]
ds_read_b64_tr_b16 v[116:117], v2 offset:53248
ds_read_b64_tr_b16 v[118:119], v2 offset:55296
buffer_load_dwordx4 v[36:39], v10, s[8:11], s21 offen offset:0
s_waitcnt lgkmcnt(14)
v_mfma_f32_32x32x16_bf16 v[148:163], v[120:123], v[64:67], v[148:163]
ds_read_b64_tr_b16 v[120:121], v3 offset:53248
ds_read_b64_tr_b16 v[122:123], v3 offset:55296
buffer_load_dwordx4 v[40:43], v10, s[8:11], s21 offen offset:1024
s_waitcnt lgkmcnt(14)
v_mfma_f32_32x32x16_bf16 v[164:179], v[124:127], v[64:67], v[164:179]
ds_read_b64_tr_b16 v[124:125], v4 offset:53248
ds_read_b64_tr_b16 v[126:127], v4 offset:55296
buffer_load_dwordx4 v[44:47], v10, s[8:11], s21 offen offset:2048
s_waitcnt lgkmcnt(14)
v_mfma_f32_32x32x16_bf16 v[180:195], v[128:131], v[64:67], v[180:195]
ds_read_b64_tr_b16 v[128:129], v5 offset:53248
ds_read_b64_tr_b16 v[130:131], v5 offset:55296
buffer_load_dwordx4 v[48:51], v10, s[8:11], s21 offen offset:3072
s_add_u32 s21, s21, 4096
s_add_u32 s22, s22, 131072
s_add_u32 s24, s24, 1
s_cmp_lt_u32 s24, 4
s_cbranch_scc1 L_k2_gloop_8
s_waitcnt lgkmcnt(14)
v_mfma_f32_32x32x16_bf16 v[132:147], v[100:103], v[68:71], v[132:147]
ds_read_b64_tr_b16 v[100:101], v2 offset:57344
ds_read_b64_tr_b16 v[102:103], v2 offset:59392
s_waitcnt lgkmcnt(14)
v_mfma_f32_32x32x16_bf16 v[148:163], v[104:107], v[68:71], v[148:163]
ds_read_b64_tr_b16 v[104:105], v3 offset:57344
ds_read_b64_tr_b16 v[106:107], v3 offset:59392
s_waitcnt lgkmcnt(14)
v_mfma_f32_32x32x16_bf16 v[164:179], v[108:111], v[68:71], v[164:179]
ds_read_b64_tr_b16 v[108:109], v4 offset:57344
ds_read_b64_tr_b16 v[110:111], v4 offset:59392
s_waitcnt lgkmcnt(14)
v_mfma_f32_32x32x16_bf16 v[180:195], v[112:115], v[68:71], v[180:195]
ds_read_b64_tr_b16 v[112:113], v5 offset:57344
ds_read_b64_tr_b16 v[114:115], v5 offset:59392
s_waitcnt lgkmcnt(14)
v_mfma_f32_32x32x16_bf16 v[132:147], v[116:119], v[72:75], v[132:147]
ds_read_b64_tr_b16 v[116:117], v2 offset:61440
ds_read_b64_tr_b16 v[118:119], v2 offset:63488
s_waitcnt lgkmcnt(14)
v_mfma_f32_32x32x16_bf16 v[148:163], v[120:123], v[72:75], v[148:163]
ds_read_b64_tr_b16 v[120:121], v3 offset:61440
ds_read_b64_tr_b16 v[122:123], v3 offset:63488
s_waitcnt lgkmcnt(14)
v_mfma_f32_32x32x16_bf16 v[164:179], v[124:127], v[72:75], v[164:179]
ds_read_b64_tr_b16 v[124:125], v4 offset:61440
ds_read_b64_tr_b16 v[126:127], v4 offset:63488
s_waitcnt lgkmcnt(14)
v_mfma_f32_32x32x16_bf16 v[180:195], v[128:131], v[72:75], v[180:195]
ds_read_b64_tr_b16 v[128:129], v5 offset:61440
ds_read_b64_tr_b16 v[130:131], v5 offset:63488
s_waitcnt vmcnt(16)
s_barrier
s_waitcnt lgkmcnt(14)
v_mfma_f32_32x32x16_bf16 v[132:147], v[100:103], v[76:79], v[132:147]
ds_read_b64_tr_b16 v[100:101], v6 offset:0
ds_read_b64_tr_b16 v[102:103], v6 offset:2048
s_add_u32 m0, s23, 32768
s_nop 0
buffer_load_dwordx4 v11, s[12:15], s22 offen lds
s_waitcnt lgkmcnt(14)
v_mfma_f32_32x32x16_bf16 v[148:163], v[104:107], v[76:79], v[148:163]
ds_read_b64_tr_b16 v[104:105], v7 offset:0
ds_read_b64_tr_b16 v[106:107], v7 offset:2048
s_add_u32 m0, s23, 33792
s_nop 0
buffer_load_dwordx4 v12, s[12:15], s22 offen lds
s_waitcnt lgkmcnt(14)
v_mfma_f32_32x32x16_bf16 v[164:179], v[108:111], v[76:79], v[164:179]
ds_read_b64_tr_b16 v[108:109], v8 offset:0
ds_read_b64_tr_b16 v[110:111], v8 offset:2048
s_add_u32 m0, s23, 34816
s_nop 0
buffer_load_dwordx4 v13, s[12:15], s22 offen lds
s_waitcnt lgkmcnt(14)
v_mfma_f32_32x32x16_bf16 v[180:195], v[112:115], v[76:79], v[180:195]
ds_read_b64_tr_b16 v[112:113], v9 offset:0
ds_read_b64_tr_b16 v[114:115], v9 offset:2048
s_add_u32 m0, s23, 35840
s_nop 0
buffer_load_dwordx4 v14, s[12:15], s22 offen lds
s_waitcnt lgkmcnt(14)
v_mfma_f32_32x32x16_bf16 v[132:147], v[116:119], v[80:83], v[132:147]
ds_read_b64_tr_b16 v[116:117], v6 offset:4096
ds_read_b64_tr_b16 v[118:119], v6 offset:6144
buffer_load_dwordx4 v[52:55], v10, s[8:11], s21 offen offset:0
s_waitcnt lgkmcnt(14)
v_mfma_f32_32x32x16_bf16 v[148:163], v[120:123], v[80:83], v[148:163]
ds_read_b64_tr_b16 v[120:121], v7 offset:4096
ds_read_b64_tr_b16 v[122:123], v7 offset:6144
buffer_load_dwordx4 v[56:59], v10, s[8:11], s21 offen offset:1024
s_waitcnt lgkmcnt(14)
v_mfma_f32_32x32x16_bf16 v[164:179], v[124:127], v[80:83], v[164:179]
ds_read_b64_tr_b16 v[124:125], v8 offset:4096
ds_read_b64_tr_b16 v[126:127], v8 offset:6144
buffer_load_dwordx4 v[60:63], v10, s[8:11], s21 offen offset:2048
s_waitcnt lgkmcnt(14)
v_mfma_f32_32x32x16_bf16 v[180:195], v[128:131], v[80:83], v[180:195]
ds_read_b64_tr_b16 v[128:129], v9 offset:4096
ds_read_b64_tr_b16 v[130:131], v9 offset:6144
buffer_load_dwordx4 v[64:67], v10, s[8:11], s21 offen offset:3072
s_add_u32 s21, s21, 4096
s_add_u32 s22, s22, 131072
s_waitcnt lgkmcnt(14)
v_mfma_f32_32x32x16_bf16 v[132:147], v[100:103], v[84:87], v[132:147]
ds_read_b64_tr_b16 v[100:101], v6 offset:8192
ds_read_b64_tr_b16 v[102:103], v6 offset:10240
s_waitcnt lgkmcnt(14)
v_mfma_f32_32x32x16_bf16 v[148:163], v[104:107], v[84:87], v[148:163]
ds_read_b64_tr_b16 v[104:105], v7 offset:8192
ds_read_b64_tr_b16 v[106:107], v7 offset:10240
s_waitcnt lgkmcnt(14)
v_mfma_f32_32x32x16_bf16 v[164:179], v[108:111], v[84:87], v[164:179]
ds_read_b64_tr_b16 v[108:109], v8 offset:8192
ds_read_b64_tr_b16 v[110:111], v8 offset:10240
s_waitcnt lgkmcnt(14)
v_mfma_f32_32x32x16_bf16 v[180:195], v[112:115], v[84:87], v[180:195]
ds_read_b64_tr_b16 v[112:113], v9 offset:8192
ds_read_b64_tr_b16 v[114:115], v9 offset:10240
s_waitcnt lgkmcnt(14)
v_mfma_f32_32x32x16_bf16 v[132:147], v[116:119], v[88:91], v[132:147]
ds_read_b64_tr_b16 v[116:117], v6 offset:12288
ds_read_b64_tr_b16 v[118:119], v6 offset:14336
s_waitcnt lgkmcnt(14)
v_mfma_f32_32x32x16_bf16 v[148:163], v[120:123], v[88:91], v[148:163]
ds_read_b64_tr_b16 v[120:121], v7 offset:12288
ds_read_b64_tr_b16 v[122:123], v7 offset:14336
s_waitcnt lgkmcnt(14)
v_mfma_f32_32x32x16_bf16 v[164:179], v[124:127], v[88:91], v[164:179]
ds_read_b64_tr_b16 v[124:125], v8 offset:12288
ds_read_b64_tr_b16 v[126:127], v8 offset:14336
s_waitcnt lgkmcnt(14)
v_mfma_f32_32x32x16_bf16 v[180:195], v[128:131], v[88:91], v[180:195]
ds_read_b64_tr_b16 v[128:129], v9 offset:12288
ds_read_b64_tr_b16 v[130:131], v9 offset:14336
s_waitcnt vmcnt(16)
s_barrier
s_waitcnt lgkmcnt(14)
v_mfma_f32_32x32x16_bf16 v[132:147], v[100:103], v[92:95], v[132:147]
ds_read_b64_tr_b16 v[100:101], v2 offset:0
ds_read_b64_tr_b16 v[102:103], v2 offset:2048
s_waitcnt lgkmcnt(14)
v_mfma_f32_32x32x16_bf16 v[148:163], v[104:107], v[92:95], v[148:163]
ds_read_b64_tr_b16 v[104:105], v3 offset:0
ds_read_b64_tr_b16 v[106:107], v3 offset:2048
s_waitcnt lgkmcnt(14)
v_mfma_f32_32x32x16_bf16 v[164:179], v[108:111], v[92:95], v[164:179]
ds_read_b64_tr_b16 v[108:109], v4 offset:0
ds_read_b64_tr_b16 v[110:111], v4 offset:2048
s_waitcnt lgkmcnt(14)
v_mfma_f32_32x32x16_bf16 v[180:195], v[112:115], v[92:95], v[180:195]
ds_read_b64_tr_b16 v[112:113], v5 offset:0
ds_read_b64_tr_b16 v[114:115], v5 offset:2048
s_waitcnt lgkmcnt(14)
v_mfma_f32_32x32x16_bf16 v[132:147], v[116:119], v[96:99], v[132:147]
ds_read_b64_tr_b16 v[116:117], v2 offset:4096
ds_read_b64_tr_b16 v[118:119], v2 offset:6144
s_waitcnt lgkmcnt(14)
v_mfma_f32_32x32x16_bf16 v[148:163], v[120:123], v[96:99], v[148:163]
ds_read_b64_tr_b16 v[120:121], v3 offset:4096
ds_read_b64_tr_b16 v[122:123], v3 offset:6144
s_waitcnt lgkmcnt(14)
v_mfma_f32_32x32x16_bf16 v[164:179], v[124:127], v[96:99], v[164:179]
ds_read_b64_tr_b16 v[124:125], v4 offset:4096
ds_read_b64_tr_b16 v[126:127], v4 offset:6144
s_waitcnt lgkmcnt(14)
v_mfma_f32_32x32x16_bf16 v[180:195], v[128:131], v[96:99], v[180:195]
ds_read_b64_tr_b16 v[128:129], v5 offset:4096
ds_read_b64_tr_b16 v[130:131], v5 offset:6144
s_waitcnt lgkmcnt(14)
v_mfma_f32_32x32x16_bf16 v[132:147], v[100:103], v[20:23], v[132:147]
ds_read_b64_tr_b16 v[100:101], v2 offset:8192
ds_read_b64_tr_b16 v[102:103], v2 offset:10240
s_waitcnt lgkmcnt(14)
v_mfma_f32_32x32x16_bf16 v[148:163], v[104:107], v[20:23], v[148:163]
ds_read_b64_tr_b16 v[104:105], v3 offset:8192
ds_read_b64_tr_b16 v[106:107], v3 offset:10240
s_waitcnt lgkmcnt(14)
v_mfma_f32_32x32x16_bf16 v[164:179], v[108:111], v[20:23], v[164:179]
ds_read_b64_tr_b16 v[108:109], v4 offset:8192
ds_read_b64_tr_b16 v[110:111], v4 offset:10240
s_waitcnt lgkmcnt(14)
v_mfma_f32_32x32x16_bf16 v[180:195], v[112:115], v[20:23], v[180:195]
ds_read_b64_tr_b16 v[112:113], v5 offset:8192
ds_read_b64_tr_b16 v[114:115], v5 offset:10240
s_waitcnt lgkmcnt(14)
v_mfma_f32_32x32x16_bf16 v[132:147], v[116:119], v[24:27], v[132:147]
ds_read_b64_tr_b16 v[116:117], v2 offset:12288
ds_read_b64_tr_b16 v[118:119], v2 offset:14336
s_waitcnt lgkmcnt(14)
v_mfma_f32_32x32x16_bf16 v[148:163], v[120:123], v[24:27], v[148:163]
ds_read_b64_tr_b16 v[120:121], v3 offset:12288
ds_read_b64_tr_b16 v[122:123], v3 offset:14336
s_waitcnt lgkmcnt(14)
v_mfma_f32_32x32x16_bf16 v[164:179], v[124:127], v[24:27], v[164:179]
ds_read_b64_tr_b16 v[124:125], v4 offset:12288
ds_read_b64_tr_b16 v[126:127], v4 offset:14336
s_waitcnt lgkmcnt(14)
v_mfma_f32_32x32x16_bf16 v[180:195], v[128:131], v[24:27], v[180:195]
ds_read_b64_tr_b16 v[128:129], v5 offset:12288
ds_read_b64_tr_b16 v[130:131], v5 offset:14336
s_waitcnt vmcnt(8)
s_barrier
s_waitcnt lgkmcnt(14)
v_mfma_f32_32x32x16_bf16 v[132:147], v[100:103], v[28:31], v[132:147]
ds_read_b64_tr_b16 v[100:101], v2 offset:16384
ds_read_b64_tr_b16 v[102:103], v2 offset:18432
s_waitcnt lgkmcnt(14)
v_mfma_f32_32x32x16_bf16 v[148:163], v[104:107], v[28:31], v[148:163]
ds_read_b64_tr_b16 v[104:105], v3 offset:16384
ds_read_b64_tr_b16 v[106:107], v3 offset:18432
s_waitcnt lgkmcnt(14)
v_mfma_f32_32x32x16_bf16 v[164:179], v[108:111], v[28:31], v[164:179]
ds_read_b64_tr_b16 v[108:109], v4 offset:16384
ds_read_b64_tr_b16 v[110:111], v4 offset:18432
s_waitcnt lgkmcnt(14)
v_mfma_f32_32x32x16_bf16 v[180:195], v[112:115], v[28:31], v[180:195]
ds_read_b64_tr_b16 v[112:113], v5 offset:16384
ds_read_b64_tr_b16 v[114:115], v5 offset:18432
s_waitcnt lgkmcnt(14)
v_mfma_f32_32x32x16_bf16 v[132:147], v[116:119], v[32:35], v[132:147]
ds_read_b64_tr_b16 v[116:117], v2 offset:20480
ds_read_b64_tr_b16 v[118:119], v2 offset:22528
s_waitcnt lgkmcnt(14)
v_mfma_f32_32x32x16_bf16 v[148:163], v[120:123], v[32:35], v[148:163]
ds_read_b64_tr_b16 v[120:121], v3 offset:20480
ds_read_b64_tr_b16 v[122:123], v3 offset:22528
s_waitcnt lgkmcnt(14)
v_mfma_f32_32x32x16_bf16 v[164:179], v[124:127], v[32:35], v[164:179]
ds_read_b64_tr_b16 v[124:125], v4 offset:20480
ds_read_b64_tr_b16 v[126:127], v4 offset:22528
s_waitcnt lgkmcnt(14)
v_mfma_f32_32x32x16_bf16 v[180:195], v[128:131], v[32:35], v[180:195]
ds_read_b64_tr_b16 v[128:129], v5 offset:20480
ds_read_b64_tr_b16 v[130:131], v5 offset:22528
s_waitcnt lgkmcnt(14)
v_mfma_f32_32x32x16_bf16 v[132:147], v[100:103], v[36:39], v[132:147]
ds_read_b64_tr_b16 v[100:101], v2 offset:24576
ds_read_b64_tr_b16 v[102:103], v2 offset:26624
s_waitcnt lgkmcnt(14)
v_mfma_f32_32x32x16_bf16 v[148:163], v[104:107], v[36:39], v[148:163]
ds_read_b64_tr_b16 v[104:105], v3 offset:24576
ds_read_b64_tr_b16 v[106:107], v3 offset:26624
s_waitcnt lgkmcnt(14)
v_mfma_f32_32x32x16_bf16 v[164:179], v[108:111], v[36:39], v[164:179]
ds_read_b64_tr_b16 v[108:109], v4 offset:24576
ds_read_b64_tr_b16 v[110:111], v4 offset:26624
s_waitcnt lgkmcnt(14)
v_mfma_f32_32x32x16_bf16 v[180:195], v[112:115], v[36:39], v[180:195]
ds_read_b64_tr_b16 v[112:113], v5 offset:24576
ds_read_b64_tr_b16 v[114:115], v5 offset:26624
s_waitcnt lgkmcnt(14)
v_mfma_f32_32x32x16_bf16 v[132:147], v[116:119], v[40:43], v[132:147]
ds_read_b64_tr_b16 v[116:117], v2 offset:28672
ds_read_b64_tr_b16 v[118:119], v2 offset:30720
s_waitcnt lgkmcnt(14)
v_mfma_f32_32x32x16_bf16 v[148:163], v[120:123], v[40:43], v[148:163]
ds_read_b64_tr_b16 v[120:121], v3 offset:28672
ds_read_b64_tr_b16 v[122:123], v3 offset:30720
s_waitcnt lgkmcnt(14)
v_mfma_f32_32x32x16_bf16 v[164:179], v[124:127], v[40:43], v[164:179]
ds_read_b64_tr_b16 v[124:125], v4 offset:28672
ds_read_b64_tr_b16 v[126:127], v4 offset:30720
s_waitcnt lgkmcnt(14)
v_mfma_f32_32x32x16_bf16 v[180:195], v[128:131], v[40:43], v[180:195]
ds_read_b64_tr_b16 v[128:129], v5 offset:28672
ds_read_b64_tr_b16 v[130:131], v5 offset:30720
s_waitcnt vmcnt(0)
s_barrier
s_waitcnt lgkmcnt(14)
v_mfma_f32_32x32x16_bf16 v[132:147], v[100:103], v[44:47], v[132:147]
ds_read_b64_tr_b16 v[100:101], v2 offset:32768
ds_read_b64_tr_b16 v[102:103], v2 offset:34816
s_waitcnt lgkmcnt(14)
v_mfma_f32_32x32x16_bf16 v[148:163], v[104:107], v[44:47], v[148:163]
ds_read_b64_tr_b16 v[104:105], v3 offset:32768
ds_read_b64_tr_b16 v[106:107], v3 offset:34816
s_waitcnt lgkmcnt(14)
v_mfma_f32_32x32x16_bf16 v[164:179], v[108:111], v[44:47], v[164:179]
ds_read_b64_tr_b16 v[108:109], v4 offset:32768
ds_read_b64_tr_b16 v[110:111], v4 offset:34816
s_waitcnt lgkmcnt(14)
v_mfma_f32_32x32x16_bf16 v[180:195], v[112:115], v[44:47], v[180:195]
ds_read_b64_tr_b16 v[112:113], v5 offset:32768
ds_read_b64_tr_b16 v[114:115], v5 offset:34816
s_waitcnt lgkmcnt(14)
v_mfma_f32_32x32x16_bf16 v[132:147], v[116:119], v[48:51], v[132:147]
ds_read_b64_tr_b16 v[116:117], v2 offset:36864
ds_read_b64_tr_b16 v[118:119], v2 offset:38912
s_waitcnt lgkmcnt(14)
v_mfma_f32_32x32x16_bf16 v[148:163], v[120:123], v[48:51], v[148:163]
ds_read_b64_tr_b16 v[120:121], v3 offset:36864
ds_read_b64_tr_b16 v[122:123], v3 offset:38912
s_waitcnt lgkmcnt(14)
v_mfma_f32_32x32x16_bf16 v[164:179], v[124:127], v[48:51], v[164:179]
ds_read_b64_tr_b16 v[124:125], v4 offset:36864
ds_read_b64_tr_b16 v[126:127], v4 offset:38912
s_waitcnt lgkmcnt(14)
v_mfma_f32_32x32x16_bf16 v[180:195], v[128:131], v[48:51], v[180:195]
ds_read_b64_tr_b16 v[128:129], v5 offset:36864
ds_read_b64_tr_b16 v[130:131], v5 offset:38912
s_waitcnt lgkmcnt(14)
v_mfma_f32_32x32x16_bf16 v[132:147], v[100:103], v[52:55], v[132:147]
ds_read_b64_tr_b16 v[100:101], v2 offset:40960
ds_read_b64_tr_b16 v[102:103], v2 offset:43008
s_waitcnt lgkmcnt(14)
v_mfma_f32_32x32x16_bf16 v[148:163], v[104:107], v[52:55], v[148:163]
ds_read_b64_tr_b16 v[104:105], v3 offset:40960
ds_read_b64_tr_b16 v[106:107], v3 offset:43008
s_waitcnt lgkmcnt(14)
v_mfma_f32_32x32x16_bf16 v[164:179], v[108:111], v[52:55], v[164:179]
ds_read_b64_tr_b16 v[108:109], v4 offset:40960
ds_read_b64_tr_b16 v[110:111], v4 offset:43008
s_waitcnt lgkmcnt(14)
v_mfma_f32_32x32x16_bf16 v[180:195], v[112:115], v[52:55], v[180:195]
ds_read_b64_tr_b16 v[112:113], v5 offset:40960
ds_read_b64_tr_b16 v[114:115], v5 offset:43008
s_waitcnt lgkmcnt(14)
v_mfma_f32_32x32x16_bf16 v[132:147], v[116:119], v[56:59], v[132:147]
ds_read_b64_tr_b16 v[116:117], v2 offset:45056
ds_read_b64_tr_b16 v[118:119], v2 offset:47104
s_waitcnt lgkmcnt(14)
v_mfma_f32_32x32x16_bf16 v[148:163], v[120:123], v[56:59], v[148:163]
ds_read_b64_tr_b16 v[120:121], v3 offset:45056
ds_read_b64_tr_b16 v[122:123], v3 offset:47104
s_waitcnt lgkmcnt(14)
v_mfma_f32_32x32x16_bf16 v[164:179], v[124:127], v[56:59], v[164:179]
ds_read_b64_tr_b16 v[124:125], v4 offset:45056
ds_read_b64_tr_b16 v[126:127], v4 offset:47104
s_waitcnt lgkmcnt(14)
v_mfma_f32_32x32x16_bf16 v[180:195], v[128:131], v[56:59], v[180:195]
ds_read_b64_tr_b16 v[128:129], v5 offset:45056
ds_read_b64_tr_b16 v[130:131], v5 offset:47104
s_waitcnt lgkmcnt(14)
v_mfma_f32_32x32x16_bf16 v[132:147], v[100:103], v[60:63], v[132:147]
s_waitcnt lgkmcnt(12)
v_mfma_f32_32x32x16_bf16 v[148:163], v[104:107], v[60:63], v[148:163]
s_waitcnt lgkmcnt(10)
v_mfma_f32_32x32x16_bf16 v[164:179], v[108:111], v[60:63], v[164:179]
s_waitcnt lgkmcnt(8)
v_mfma_f32_32x32x16_bf16 v[180:195], v[112:115], v[60:63], v[180:195]
s_waitcnt lgkmcnt(6)
v_mfma_f32_32x32x16_bf16 v[132:147], v[116:119], v[64:67], v[132:147]
s_waitcnt lgkmcnt(4)
v_mfma_f32_32x32x16_bf16 v[148:163], v[120:123], v[64:67], v[148:163]
s_waitcnt lgkmcnt(2)
v_mfma_f32_32x32x16_bf16 v[164:179], v[124:127], v[64:67], v[164:179]
s_waitcnt lgkmcnt(0)
v_mfma_f32_32x32x16_bf16 v[180:195], v[128:131], v[64:67], v[180:195]
s_nop 15
s_cmp_eq_u32 s19, 1
s_cbranch_scc1 L_k2_sk1_9
buffer_store_dwordx4 v[164:167], v196, s[8:11], 0 offen offset:0 sc1
buffer_store_dwordx4 v[168:171], v196, s[8:11], 0 offen offset:1024 sc1
buffer_store_dwordx4 v[172:175], v196, s[8:11], 0 offen offset:2048 sc1
buffer_store_dwordx4 v[176:179], v196, s[8:11], 0 offen offset:3072 sc1
buffer_store_dwordx4 v[180:183], v197, s[8:11], 0 offen offset:0 sc1
buffer_store_dwordx4 v[184:187], v197, s[8:11], 0 offen offset:1024 sc1
buffer_store_dwordx4 v[188:191], v197, s[8:11], 0 offen offset:2048 sc1
buffer_store_dwordx4 v[192:195], v197, s[8:11], 0 offen offset:3072 sc1
s_branch L_k2_join_10
L_k2_sk1_9:
buffer_store_dwordx4 v[132:135], v196, s[8:11], 0 offen offset:0 sc1
buffer_store_dwordx4 v[136:139], v196, s[8:11], 0 offen offset:1024 sc1
buffer_store_dwordx4 v[140:143], v196, s[8:11], 0 offen offset:2048 sc1
buffer_store_dwordx4 v[144:147], v196, s[8:11], 0 offen offset:3072 sc1
buffer_store_dwordx4 v[148:151], v197, s[8:11], 0 offen offset:0 sc1
buffer_store_dwordx4 v[152:155], v197, s[8:11], 0 offen offset:1024 sc1
buffer_store_dwordx4 v[156:159], v197, s[8:11], 0 offen offset:2048 sc1
buffer_store_dwordx4 v[160:163], v197, s[8:11], 0 offen offset:3072 sc1
s_nop 1
v_mov_b32 v132, v164
v_mov_b32 v133, v165
v_mov_b32 v134, v166
v_mov_b32 v135, v167
v_mov_b32 v136, v168
v_mov_b32 v137, v169
v_mov_b32 v138, v170
v_mov_b32 v139, v171
v_mov_b32 v140, v172
v_mov_b32 v141, v173
v_mov_b32 v142, v174
v_mov_b32 v143, v175
v_mov_b32 v144, v176
v_mov_b32 v145, v177
v_mov_b32 v146, v178
v_mov_b32 v147, v179
v_mov_b32 v148, v180
v_mov_b32 v149, v181
v_mov_b32 v150, v182
v_mov_b32 v151, v183
v_mov_b32 v152, v184
v_mov_b32 v153, v185
v_mov_b32 v154, v186
v_mov_b32 v155, v187
v_mov_b32 v156, v188
v_mov_b32 v157, v189
v_mov_b32 v158, v190
v_mov_b32 v159, v191
v_mov_b32 v160, v192
v_mov_b32 v161, v193
v_mov_b32 v162, v194
v_mov_b32 v163, v195
L_k2_join_10:
s_lshl_b32 s30, s17, 1
s_add_u32 s30, s30, s19
v_xor_b32 v4, 65536, v196
v_add_u32 v5, 4096, v4
v_lshrrev_b32 v16, 5, v1
v_lshlrev_b32 v16, 2, v16
v_bfe_u32 v17, v1, 2, 2
v_add_u32 v16, v16, v17
v_lshlrev_b32 v16, 7, v16
v_bfe_u32 v18, v1, 4, 1
v_lshl_add_u32 v16, v18, 5, v16
v_and_b32 v18, 3, v1
v_lshl_add_u32 v16, v18, 3, v16
v_lshrrev_b32 v17, 1, v17
v_lshl_add_u32 v2, v17, 6, v16
v_xor_b32 v17, 1, v17
v_lshl_add_u32 v3, v17, 6, v16
s_lshl_b32 s26, s16, 2
s_add_u32 s26, s26, s18
s_mul_i32 s27, s26, 294912
s_add_u32 s27, s27, 16777216
v_lshlrev_b32 v16, 4, v1
v_add_u32 v10, s27, v16
v_lshrrev_b32 v16, 3, v1
s_lshl_b32 s27, s18, 4
v_add_u32 v17, s27, v16
v_lshlrev_b32 v17, 11, v17
v_bfe_u32 v18, v1, 2, 1
v_bfe_u32 v19, v1, 4, 1
v_xor_b32 v18, v18, v19
v_lshl_add_u32 v17, v18, 6, v17
v_and_b32 v18, 3, v1
v_lshl_add_u32 v17, v18, 4, v17
s_lshl_b32 s28, s30, 7
v_add_u32 v11, s28, v17
v_add_u32 v12, 16384, v11
s_lshl_b32 s27, s26, 5
v_add_u32 v17, s27, v16
v_lshlrev_b32 v17, 11, v17
v_and_b32 v18, 7, v1
v_lshl_add_u32 v17, v18, 4, v17
v_add_u32 v6, s28, v17
s_mul_i32 s27, s18, 8704
v_and_b32 v17, 31, v1
v_mul_u32_u24 v17, 272, v17
v_lshrrev_b32 v19, 5, v1
v_lshl_add_u32 v17, v19, 4, v17
v_add_u32 v7, s27, v17
v_mul_u32_u24 v17, 272, v16
v_lshl_add_u32 v17, v18, 5, v17
v_add_u32 v8, s27, v17
s_lshl_b32 s23, s18, 11
s_mov_b32 s21, 0
s_mov_b32 s22, 0
s_mov_b32 s52, s48
s_and_b32 s53, s49, 0xffff
s_mov_b32 s54, 2097152
s_mov_b32 s55, 0x00020000
s_mov_b32 s56, s50
s_and_b32 s57, s51, 0xffff
s_mov_b32 s58, 4194304
s_mov_b32 s59, 0x00020000
s_mov_b32 s60, s64
s_and_b32 s61, s65, 0xffff
s_mov_b32 s62, 4194304
s_mov_b32 s63, 0x00020000
s_lshl_b32 s31, s20, 1
s_add_u32 s31, s31, s19
s_xor_b32 s26, s31, 1
s_lshl_b32 s31, s31, 6
s_add_u32 s31, s31, 50331648
s_lshl_b32 s26, s26, 6
s_add_u32 s26, s26, 50331648
s_lshr_b32 s27, s16, 1
s_lshl_b32 s27, s27, 7
s_add_u32 s27, s27, 50348032
s_waitcnt vmcnt(0)
s_barrier
s_cmp_lg_u32 s18, 0
s_cbranch_scc1 L_k2_noflag_11
v_mov_b32 v16, 1
v_mov_b32 v17, 0
s_mov_b64 exec, 1
buffer_store_dword v16, v17, s[8:11], s31 offen sc1
s_mov_b64 exec, -1
L_k2_noflag_11:
s_add_u32 m0, s23, 0
s_nop 0
buffer_load_dwordx4 v11, s[52:55], s22 offen lds
s_add_u32 m0, s23, 1024
s_nop 0
buffer_load_dwordx4 v12, s[52:55], s22 offen lds
s_add_u32 s22, s22, 131072
s_add_u32 m0, s23, 8192
s_nop 0
buffer_load_dwordx4 v11, s[52:55], s22 offen lds
s_add_u32 m0, s23, 9216
s_nop 0
buffer_load_dwordx4 v12, s[52:55], s22 offen lds
s_add_u32 s22, s22, 131072
s_add_u32 m0, s23, 16384
s_nop 0
buffer_load_dwordx4 v11, s[52:55], s22 offen lds
s_add_u32 m0, s23, 17408
s_nop 0
buffer_load_dwordx4 v12, s[52:55], s22 offen lds
s_add_u32 s22, s22, 131072
s_add_u32 m0, s23, 24576
s_nop 0
buffer_load_dwordx4 v11, s[52:55], s22 offen lds
s_add_u32 m0, s23, 25600
s_nop 0
buffer_load_dwordx4 v12, s[52:55], s22 offen lds
s_add_u32 s22, s22, 131072
s_add_u32 m0, s23, 32768
s_nop 0
buffer_load_dwordx4 v11, s[52:55], s22 offen lds
s_add_u32 m0, s23, 33792
s_nop 0
buffer_load_dwordx4 v12, s[52:55], s22 offen lds
s_add_u32 s22, s22, 131072
s_add_u32 m0, s23, 40960
s_nop 0
buffer_load_dwordx4 v11, s[52:55], s22 offen lds
s_add_u32 m0, s23, 41984
s_nop 0
buffer_load_dwordx4 v12, s[52:55], s22 offen lds
s_add_u32 s22, s22, 131072
s_add_u32 m0, s23, 49152
s_nop 0
buffer_load_dwordx4 v11, s[52:55], s22 offen lds
s_add_u32 m0, s23, 50176
s_nop 0
buffer_load_dwordx4 v12, s[52:55], s22 offen lds
s_add_u32 s22, s22, 131072
s_add_u32 m0, s23, 57344
s_nop 0
buffer_load_dwordx4 v11, s[52:55], s22 offen lds
s_add_u32 m0, s23, 58368
s_nop 0
buffer_load_dwordx4 v12, s[52:55], s22 offen lds
s_add_u32 s22, s22, 131072
s_add_u32 m0, s23, 65536
s_nop 0
buffer_load_dwordx4 v11, s[52:55], s22 offen lds
s_add_u32 m0, s23, 66560
s_nop 0
buffer_load_dwordx4 v12, s[52:55], s22 offen lds
s_add_u32 s22, s22, 131072
s_mov_b32 s68, 0
buffer_load_dwordx4 v[232:235], v6, s[56:59], s68 offen
s_mov_b32 s69, 16384
buffer_load_dwordx4 v[236:239], v6, s[56:59], s69 offen
s_mov_b32 s70, 32768
buffer_load_dwordx4 v[240:243], v6, s[56:59], s70 offen
s_mov_b32 s71, 49152
buffer_load_dwordx4 v[244:247], v6, s[56:59], s71 offen
s_cmp_lg_u32 s18, 0
s_cbranch_scc1 L_k2_nopoll_12
v_and_b32 v16, 0, v1
v_lshlrev_b32 v16, 2, v16
L_k2_poll_13:
buffer_load_dword v17, v16, s[8:11], s26 offen sc1
s_waitcnt vmcnt(0)
v_cmp_eq_u32 vcc, 0, v17
s_cbranch_vccz L_k2_nopoll_12
s_sleep 2
s_branch L_k2_poll_13
L_k2_nopoll_12:
s_barrier
buffer_load_dwordx4 v[200:203], v4, s[8:11], 0 offen offset:0 sc1
buffer_load_dwordx4 v[204:207], v4, s[8:11], 0 offen offset:1024 sc1
buffer_load_dwordx4 v[208:211], v4, s[8:11], 0 offen offset:2048 sc1
buffer_load_dwordx4 v[212:215], v4, s[8:11], 0 offen offset:3072 sc1
buffer_load_dwordx4 v[216:219], v5, s[8:11], 0 offen offset:0 sc1
buffer_load_dwordx4 v[220:223], v5, s[8:11], 0 offen offset:1024 sc1
buffer_load_dwordx4 v[224:227], v5, s[8:11], 0 offen offset:2048 sc1
buffer_load_dwordx4 v[228:231], v5, s[8:11], 0 offen offset:3072 sc1
s_cmp_lg_u32 s18, 0
s_cbranch_scc1 L_k2_nopoll_14
v_and_b32 v16, 31, v1
v_lshlrev_b32 v16, 2, v16
L_k2_poll_15:
buffer_load_dword v17, v16, s[8:11], s27 offen sc1
s_waitcnt vmcnt(0)
v_cmp_eq_u32 vcc, 0, v17
s_cbranch_vccz L_k2_nopoll_14
s_sleep 2
s_branch L_k2_poll_15
L_k2_nopoll_14:
s_waitcnt vmcnt(0)
s_barrier
buffer_load_dwordx4 v[20:23], v10, s[8:11], s21 offen offset:0 sc1
buffer_load_dwordx4 v[24:27], v10, s[8:11], s21 offen offset:1024 sc1
buffer_load_dwordx4 v[28:31], v10, s[8:11], s21 offen offset:2048 sc1
buffer_load_dwordx4 v[32:35], v10, s[8:11], s21 offen offset:3072 sc1
s_add_u32 s21, s21, 4096
buffer_load_dwordx4 v[36:39], v10, s[8:11], s21 offen offset:0 sc1
buffer_load_dwordx4 v[40:43], v10, s[8:11], s21 offen offset:1024 sc1
buffer_load_dwordx4 v[44:47], v10, s[8:11], s21 offen offset:2048 sc1
buffer_load_dwordx4 v[48:51], v10, s[8:11], s21 offen offset:3072 sc1
s_add_u32 s21, s21, 4096
buffer_load_dwordx4 v[52:55], v10, s[8:11], s21 offen offset:0 sc1
buffer_load_dwordx4 v[56:59], v10, s[8:11], s21 offen offset:1024 sc1
buffer_load_dwordx4 v[60:63], v10, s[8:11], s21 offen offset:2048 sc1
buffer_load_dwordx4 v[64:67], v10, s[8:11], s21 offen offset:3072 sc1
s_add_u32 s21, s21, 4096
buffer_load_dwordx4 v[68:71], v10, s[8:11], s21 offen offset:0 sc1
buffer_load_dwordx4 v[72:75], v10, s[8:11], s21 offen offset:1024 sc1
buffer_load_dwordx4 v[76:79], v10, s[8:11], s21 offen offset:2048 sc1
buffer_load_dwordx4 v[80:83], v10, s[8:11], s21 offen offset:3072 sc1
s_add_u32 s21, s21, 4096
v_pk_add_f32 v[132:133], v[132:133], v[200:201]
v_pk_add_f32 v[134:135], v[134:135], v[202:203]
v_pk_add_f32 v[136:137], v[136:137], v[204:205]
v_pk_add_f32 v[138:139], v[138:139], v[206:207]
v_pk_add_f32 v[140:141], v[140:141], v[208:209]
v_pk_add_f32 v[142:143], v[142:143], v[210:211]
v_pk_add_f32 v[144:145], v[144:145], v[212:213]
v_pk_add_f32 v[146:147], v[146:147], v[214:215]
v_pk_add_f32 v[148:149], v[148:149], v[216:217]
v_pk_add_f32 v[150:151], v[150:151], v[218:219]
v_pk_add_f32 v[152:153], v[152:153], v[220:221]
v_pk_add_f32 v[154:155], v[154:155], v[222:223]
v_pk_add_f32 v[156:157], v[156:157], v[224:225]
v_pk_add_f32 v[158:159], v[158:159], v[226:227]
v_pk_add_f32 v[160:161], v[160:161], v[228:229]
v_pk_add_f32 v[162:163], v[162:163], v[230:231]
v_add_u32 v13, 0x10000, v2
v_add_u32 v14, 0x10000, v3
ds_read_b64_tr_b16 v[100:101], v2 offset:0
ds_read_b64_tr_b16 v[102:103], v2 offset:1024
ds_read_b64_tr_b16 v[104:105], v3 offset:0
ds_read_b64_tr_b16 v[106:107], v3 offset:1024
ds_read_b64_tr_b16 v[108:109], v2 offset:2048
ds_read_b64_tr_b16 v[110:111], v2 offset:3072
ds_read_b64_tr_b16 v[112:113], v3 offset:2048
ds_read_b64_tr_b16 v[114:115], v3 offset:3072
s_waitcnt vmcnt(12)
s_waitcnt lgkmcnt(6)
v_mfma_f32_32x32x16_bf16 v[132:147], v[100:103], v[20:23], v[132:147]
ds_read_b64_tr_b16 v[100:101], v2 offset:4096
ds_read_b64_tr_b16 v[102:103], v2 offset:5120
buffer_load_dwordx4 v[84:87], v10, s[8:11], s21 offen offset:0 sc1
s_waitcnt lgkmcnt(6)
v_mfma_f32_32x32x16_bf16 v[148:163], v[104:107], v[20:23], v[148:163]
ds_read_b64_tr_b16 v[104:105], v3 offset:4096
ds_read_b64_tr_b16 v[106:107], v3 offset:5120
buffer_load_dwordx4 v[88:91], v10, s[8:11], s21 offen offset:1024 sc1
s_waitcnt lgkmcnt(6)
v_mfma_f32_32x32x16_bf16 v[132:147], v[108:111], v[24:27], v[132:147]
ds_read_b64_tr_b16 v[108:109], v2 offset:6144
ds_read_b64_tr_b16 v[110:111], v2 offset:7168
buffer_load_dwordx4 v[92:95], v10, s[8:11], s21 offen offset:2048 sc1
s_waitcnt lgkmcnt(6)
v_mfma_f32_32x32x16_bf16 v[148:163], v[112:115], v[24:27], v[148:163]
ds_read_b64_tr_b16 v[112:113], v3 offset:6144
ds_read_b64_tr_b16 v[114:115], v3 offset:7168
buffer_load_dwordx4 v[96:99], v10, s[8:11], s21 offen offset:3072 sc1
s_add_u32 s21, s21, 4096
s_waitcnt lgkmcnt(6)
v_mfma_f32_32x32x16_bf16 v[132:147], v[100:103], v[28:31], v[132:147]
ds_read_b64_tr_b16 v[100:101], v2 offset:8192
ds_read_b64_tr_b16 v[102:103], v2 offset:9216
s_waitcnt lgkmcnt(6)
v_mfma_f32_32x32x16_bf16 v[148:163], v[104:107], v[28:31], v[148:163]
ds_read_b64_tr_b16 v[104:105], v3 offset:8192
ds_read_b64_tr_b16 v[106:107], v3 offset:9216
s_waitcnt lgkmcnt(6)
v_mfma_f32_32x32x16_bf16 v[132:147], v[108:111], v[32:35], v[132:147]
ds_read_b64_tr_b16 v[108:109], v2 offset:10240
ds_read_b64_tr_b16 v[110:111], v2 offset:11264
s_waitcnt lgkmcnt(6)
v_mfma_f32_32x32x16_bf16 v[148:163], v[112:115], v[32:35], v[148:163]
ds_read_b64_tr_b16 v[112:113], v3 offset:10240
ds_read_b64_tr_b16 v[114:115], v3 offset:11264
s_waitcnt vmcnt(12)
s_waitcnt lgkmcnt(6)
v_mfma_f32_32x32x16_bf16 v[132:147], v[100:103], v[36:39], v[132:147]
ds_read_b64_tr_b16 v[100:101], v2 offset:12288
ds_read_b64_tr_b16 v[102:103], v2 offset:13312
buffer_load_dwordx4 v[20:23], v10, s[8:11], s21 offen offset:0 sc1
s_waitcnt lgkmcnt(6)
v_mfma_f32_32x32x16_bf16 v[148:163], v[104:107], v[36:39], v[148:163]
ds_read_b64_tr_b16 v[104:105], v3 offset:12288
ds_read_b64_tr_b16 v[106:107], v3 offset:13312
buffer_load_dwordx4 v[24:27], v10, s[8:11], s21 offen offset:1024 sc1
s_waitcnt lgkmcnt(6)
v_mfma_f32_32x32x16_bf16 v[132:147], v[108:111], v[40:43], v[132:147]
ds_read_b64_tr_b16 v[108:109], v2 offset:14336
ds_read_b64_tr_b16 v[110:111], v2 offset:15360
buffer_load_dwordx4 v[28:31], v10, s[8:11], s21 offen offset:2048 sc1
s_waitcnt lgkmcnt(6)
v_mfma_f32_32x32x16_bf16 v[148:163], v[112:115], v[40:43], v[148:163]
ds_read_b64_tr_b16 v[112:113], v3 offset:14336
ds_read_b64_tr_b16 v[114:115], v3 offset:15360
buffer_load_dwordx4 v[32:35], v10, s[8:11], s21 offen offset:3072 sc1
s_add_u32 s21, s21, 4096
s_barrier
s_waitcnt lgkmcnt(6)
v_mfma_f32_32x32x16_bf16 v[132:147], v[100:103], v[44:47], v[132:147]
ds_read_b64_tr_b16 v[100:101], v2 offset:16384
ds_read_b64_tr_b16 v[102:103], v2 offset:17408
s_add_u32 m0, s23, 0
s_nop 0
buffer_load_dwordx4 v11, s[52:55], s22 offen lds
s_waitcnt lgkmcnt(6)
v_mfma_f32_32x32x16_bf16 v[148:163], v[104:107], v[44:47], v[148:163]
ds_read_b64_tr_b16 v[104:105], v3 offset:16384
ds_read_b64_tr_b16 v[106:107], v3 offset:17408
s_add_u32 m0, s23, 1024
s_nop 0
buffer_load_dwordx4 v12, s[52:55], s22 offen lds
s_add_u32 s22, s22, 131072
s_waitcnt lgkmcnt(6)
v_mfma_f32_32x32x16_bf16 v[132:147], v[108:111], v[48:51], v[132:147]
ds_read_b64_tr_b16 v[108:109], v2 offset:18432
ds_read_b64_tr_b16 v[110:111], v2 offset:19456
s_waitcnt lgkmcnt(6)
v_mfma_f32_32x32x16_bf16 v[148:163], v[112:115], v[48:51], v[148:163]
ds_read_b64_tr_b16 v[112:113], v3 offset:18432
ds_read_b64_tr_b16 v[114:115], v3 offset:19456
s_waitcnt vmcnt(14)
s_waitcnt lgkmcnt(6)
v_mfma_f32_32x32x16_bf16 v[132:147], v[100:103], v[52:55], v[132:147]
ds_read_b64_tr_b16 v[100:101], v2 offset:20480
ds_read_b64_tr_b16 v[102:103], v2 offset:21504
buffer_load_dwordx4 v[36:39], v10, s[8:11], s21 offen offset:0 sc1
s_waitcnt lgkmcnt(6)
v_mfma_f32_32x32x16_bf16 v[148:163], v[104:107], v[52:55], v[148:163]
ds_read_b64_tr_b16 v[104:105], v3 offset:20480
ds_read_b64_tr_b16 v[106:107], v3 offset:21504
buffer_load_dwordx4 v[40:43], v10, s[8:11], s21 offen offset:1024 sc1
s_waitcnt lgkmcnt(6)
v_mfma_f32_32x32x16_bf16 v[132:147], v[108:111], v[56:59], v[132:147]
ds_read_b64_tr_b16 v[108:109], v2 offset:22528
ds_read_b64_tr_b16 v[110:111], v2 offset:23552
buffer_load_dwordx4 v[44:47], v10, s[8:11], s21 offen offset:2048 sc1
s_waitcnt lgkmcnt(6)
v_mfma_f32_32x32x16_bf16 v[148:163], v[112:115], v[56:59], v[148:163]
ds_read_b64_tr_b16 v[112:113], v3 offset:22528
ds_read_b64_tr_b16 v[114:115], v3 offset:23552
buffer_load_dwordx4 v[48:51], v10, s[8:11], s21 offen offset:3072 sc1
s_add_u32 s21, s21, 4096
s_barrier
s_waitcnt lgkmcnt(6)
v_mfma_f32_32x32x16_bf16 v[132:147], v[100:103], v[60:63], v[132:147]
ds_read_b64_tr_b16 v[100:101], v2 offset:24576
ds_read_b64_tr_b16 v[102:103], v2 offset:25600
s_add_u32 m0, s23, 8192
s_nop 0
buffer_load_dwordx4 v11, s[52:55], s22 offen lds
s_waitcnt lgkmcnt(6)
v_mfma_f32_32x32x16_bf16 v[148:163], v[104:107], v[60:63], v[148:163]
ds_read_b64_tr_b16 v[104:105], v3 offset:24576
ds_read_b64_tr_b16 v[106:107], v3 offset:25600
s_add_u32 m0, s23, 9216
s_nop 0
buffer_load_dwordx4 v12, s[52:55], s22 offen lds
s_add_u32 s22, s22, 131072
s_waitcnt lgkmcnt(6)
v_mfma_f32_32x32x16_bf16 v[132:147], v[108:111], v[64:67], v[132:147]
ds_read_b64_tr_b16 v[108:109], v2 offset:26624
ds_read_b64_tr_b16 v[110:111], v2 offset:27648
s_waitcnt lgkmcnt(6)
v_mfma_f32_32x32x16_bf16 v[148:163], v[112:115], v[64:67], v[148:163]
ds_read_b64_tr_b16 v[112:113], v3 offset:26624
ds_read_b64_tr_b16 v[114:115], v3 offset:27648
s_waitcnt vmcnt(16)
s_waitcnt lgkmcnt(6)
v_mfma_f32_32x32x16_bf16 v[132:147], v[100:103], v[68:71], v[132:147]
ds_read_b64_tr_b16 v[100:101], v2 offset:28672
ds_read_b64_tr_b16 v[102:103], v2 offset:29696
buffer_load_dwordx4 v[52:55], v10, s[8:11], s21 offen offset:0 sc1
s_waitcnt lgkmcnt(6)
v_mfma_f32_32x32x16_bf16 v[148:163], v[104:107], v[68:71], v[148:163]
ds_read_b64_tr_b16 v[104:105], v3 offset:28672
ds_read_b64_tr_b16 v[106:107], v3 offset:29696
buffer_load_dwordx4 v[56:59], v10, s[8:11], s21 offen offset:1024 sc1
s_waitcnt lgkmcnt(6)
v_mfma_f32_32x32x16_bf16 v[132:147], v[108:111], v[72:75], v[132:147]
ds_read_b64_tr_b16 v[108:109], v2 offset:30720
ds_read_b64_tr_b16 v[110:111], v2 offset:31744
buffer_load_dwordx4 v[60:63], v10, s[8:11], s21 offen offset:2048 sc1
s_waitcnt lgkmcnt(6)
v_mfma_f32_32x32x16_bf16 v[148:163], v[112:115], v[72:75], v[148:163]
ds_read_b64_tr_b16 v[112:113], v3 offset:30720
ds_read_b64_tr_b16 v[114:115], v3 offset:31744
buffer_load_dwordx4 v[64:67], v10, s[8:11], s21 offen offset:3072 sc1
s_add_u32 s21, s21, 4096
s_barrier
s_waitcnt lgkmcnt(6)
v_mfma_f32_32x32x16_bf16 v[132:147], v[100:103], v[76:79], v[132:147]
ds_read_b64_tr_b16 v[100:101], v2 offset:32768
ds_read_b64_tr_b16 v[102:103], v2 offset:33792
s_add_u32 m0, s23, 16384
s_nop 0
buffer_load_dwordx4 v11, s[52:55], s22 offen lds
s_waitcnt lgkmcnt(6)
v_mfma_f32_32x32x16_bf16 v[148:163], v[104:107], v[76:79], v[148:163]
ds_read_b64_tr_b16 v[104:105], v3 offset:32768
ds_read_b64_tr_b16 v[106:107], v3 offset:33792
s_add_u32 m0, s23, 17408
s_nop 0
buffer_load_dwordx4 v12, s[52:55], s22 offen lds
s_add_u32 s22, s22, 131072
s_waitcnt lgkmcnt(6)
v_mfma_f32_32x32x16_bf16 v[132:147], v[108:111], v[80:83], v[132:147]
ds_read_b64_tr_b16 v[108:109], v2 offset:34816
ds_read_b64_tr_b16 v[110:111], v2 offset:35840
s_waitcnt lgkmcnt(6)
v_mfma_f32_32x32x16_bf16 v[148:163], v[112:115], v[80:83], v[148:163]
ds_read_b64_tr_b16 v[112:113], v3 offset:34816
ds_read_b64_tr_b16 v[114:115], v3 offset:35840
s_waitcnt vmcnt(18)
s_waitcnt lgkmcnt(6)
v_mfma_f32_32x32x16_bf16 v[132:147], v[100:103], v[84:87], v[132:147]
ds_read_b64_tr_b16 v[100:101], v2 offset:36864
ds_read_b64_tr_b16 v[102:103], v2 offset:37888
buffer_load_dwordx4 v[68:71], v10, s[8:11], s21 offen offset:0 sc1
s_waitcnt lgkmcnt(6)
v_mfma_f32_32x32x16_bf16 v[148:163], v[104:107], v[84:87], v[148:163]
ds_read_b64_tr_b16 v[104:105], v3 offset:36864
ds_read_b64_tr_b16 v[106:107], v3 offset:37888
buffer_load_dwordx4 v[72:75], v10, s[8:11], s21 offen offset:1024 sc1
s_waitcnt lgkmcnt(6)
v_mfma_f32_32x32x16_bf16 v[132:147], v[108:111], v[88:91], v[132:147]
ds_read_b64_tr_b16 v[108:109], v2 offset:38912
ds_read_b64_tr_b16 v[110:111], v2 offset:39936
buffer_load_dwordx4 v[76:79], v10, s[8:11], s21 offen offset:2048 sc1
s_waitcnt lgkmcnt(6)
v_mfma_f32_32x32x16_bf16 v[148:163], v[112:115], v[88:91], v[148:163]
ds_read_b64_tr_b16 v[112:113], v3 offset:38912
ds_read_b64_tr_b16 v[114:115], v3 offset:39936
buffer_load_dwordx4 v[80:83], v10, s[8:11], s21 offen offset:3072 sc1
s_add_u32 s21, s21, 4096
s_barrier
s_waitcnt lgkmcnt(6)
v_mfma_f32_32x32x16_bf16 v[132:147], v[100:103], v[92:95], v[132:147]
ds_read_b64_tr_b16 v[100:101], v2 offset:40960
ds_read_b64_tr_b16 v[102:103], v2 offset:41984
s_add_u32 m0, s23, 24576
s_nop 0
buffer_load_dwordx4 v11, s[52:55], s22 offen lds
s_waitcnt lgkmcnt(6)
v_mfma_f32_32x32x16_bf16 v[148:163], v[104:107], v[92:95], v[148:163]
ds_read_b64_tr_b16 v[104:105], v3 offset:40960
ds_read_b64_tr_b16 v[106:107], v3 offset:41984
s_add_u32 m0, s23, 25600
s_nop 0
buffer_load_dwordx4 v12, s[52:55], s22 offen lds
s_add_u32 s22, s22, 131072
s_waitcnt lgkmcnt(6)
v_mfma_f32_32x32x16_bf16 v[132:147], v[108:111], v[96:99], v[132:147]
ds_read_b64_tr_b16 v[108:109], v2 offset:43008
ds_read_b64_tr_b16 v[110:111], v2 offset:44032
s_waitcnt lgkmcnt(6)
v_mfma_f32_32x32x16_bf16 v[148:163], v[112:115], v[96:99], v[148:163]
ds_read_b64_tr_b16 v[112:113], v3 offset:43008
ds_read_b64_tr_b16 v[114:115], v3 offset:44032
s_waitcnt vmcnt(20)
s_waitcnt lgkmcnt(6)
v_mfma_f32_32x32x16_bf16 v[132:147], v[100:103], v[20:23], v[132:147]
ds_read_b64_tr_b16 v[100:101], v2 offset:45056
ds_read_b64_tr_b16 v[102:103], v2 offset:46080
buffer_load_dwordx4 v[84:87], v10, s[8:11], s21 offen offset:0 sc1
s_waitcnt lgkmcnt(6)
v_mfma_f32_32x32x16_bf16 v[148:163], v[104:107], v[20:23], v[148:163]
ds_read_b64_tr_b16 v[104:105], v3 offset:45056
ds_read_b64_tr_b16 v[106:107], v3 offset:46080
buffer_load_dwordx4 v[88:91], v10, s[8:11], s21 offen offset:1024 sc1
s_waitcnt lgkmcnt(6)
v_mfma_f32_32x32x16_bf16 v[132:147], v[108:111], v[24:27], v[132:147]
ds_read_b64_tr_b16 v[108:109], v2 offset:47104
ds_read_b64_tr_b16 v[110:111], v2 offset:48128
buffer_load_dwordx4 v[92:95], v10, s[8:11], s21 offen offset:2048 sc1
s_waitcnt lgkmcnt(6)
v_mfma_f32_32x32x16_bf16 v[148:163], v[112:115], v[24:27], v[148:163]
ds_read_b64_tr_b16 v[112:113], v3 offset:47104
ds_read_b64_tr_b16 v[114:115], v3 offset:48128
buffer_load_dwordx4 v[96:99], v10, s[8:11], s21 offen offset:3072 sc1
s_add_u32 s21, s21, 4096
s_barrier
s_waitcnt lgkmcnt(6)
v_mfma_f32_32x32x16_bf16 v[132:147], v[100:103], v[28:31], v[132:147]
ds_read_b64_tr_b16 v[100:101], v2 offset:49152
ds_read_b64_tr_b16 v[102:103], v2 offset:50176
s_add_u32 m0, s23, 32768
s_nop 0
buffer_load_dwordx4 v11, s[52:55], s22 offen lds
s_waitcnt lgkmcnt(6)
v_mfma_f32_32x32x16_bf16 v[148:163], v[104:107], v[28:31], v[148:163]
ds_read_b64_tr_b16 v[104:105], v3 offset:49152
ds_read_b64_tr_b16 v[106:107], v3 offset:50176
s_add_u32 m0, s23, 33792
s_nop 0
buffer_load_dwordx4 v12, s[52:55], s22 offen lds
s_add_u32 s22, s22, 131072
s_waitcnt lgkmcnt(6)
v_mfma_f32_32x32x16_bf16 v[132:147], v[108:111], v[32:35], v[132:147]
ds_read_b64_tr_b16 v[108:109], v2 offset:51200
ds_read_b64_tr_b16 v[110:111], v2 offset:52224
s_waitcnt lgkmcnt(6)
v_mfma_f32_32x32x16_bf16 v[148:163], v[112:115], v[32:35], v[148:163]
ds_read_b64_tr_b16 v[112:113], v3 offset:51200
ds_read_b64_tr_b16 v[114:115], v3 offset:52224
s_waitcnt vmcnt(20)
s_waitcnt lgkmcnt(6)
v_mfma_f32_32x32x16_bf16 v[132:147], v[100:103], v[36:39], v[132:147]
ds_read_b64_tr_b16 v[100:101], v2 offset:53248
ds_read_b64_tr_b16 v[102:103], v2 offset:54272
buffer_load_dwordx4 v[20:23], v10, s[8:11], s21 offen offset:0 sc1
s_waitcnt lgkmcnt(6)
v_mfma_f32_32x32x16_bf16 v[148:163], v[104:107], v[36:39], v[148:163]
ds_read_b64_tr_b16 v[104:105], v3 offset:53248
ds_read_b64_tr_b16 v[106:107], v3 offset:54272
buffer_load_dwordx4 v[24:27], v10, s[8:11], s21 offen offset:1024 sc1
s_waitcnt lgkmcnt(6)
v_mfma_f32_32x32x16_bf16 v[132:147], v[108:111], v[40:43], v[132:147]
ds_read_b64_tr_b16 v[108:109], v2 offset:55296
ds_read_b64_tr_b16 v[110:111], v2 offset:56320
buffer_load_dwordx4 v[28:31], v10, s[8:11], s21 offen offset:2048 sc1
s_waitcnt lgkmcnt(6)
v_mfma_f32_32x32x16_bf16 v[148:163], v[112:115], v[40:43], v[148:163]
ds_read_b64_tr_b16 v[112:113], v3 offset:55296
ds_read_b64_tr_b16 v[114:115], v3 offset:56320
buffer_load_dwordx4 v[32:35], v10, s[8:11], s21 offen offset:3072 sc1
s_add_u32 s21, s21, 4096
s_barrier
s_waitcnt lgkmcnt(6)
v_mfma_f32_32x32x16_bf16 v[132:147], v[100:103], v[44:47], v[132:147]
ds_read_b64_tr_b16 v[100:101], v2 offset:57344
ds_read_b64_tr_b16 v[102:103], v2 offset:58368
s_add_u32 m0, s23, 40960
s_nop 0
buffer_load_dwordx4 v11, s[52:55], s22 offen lds
s_waitcnt lgkmcnt(6)
v_mfma_f32_32x32x16_bf16 v[148:163], v[104:107], v[44:47], v[148:163]
ds_read_b64_tr_b16 v[104:105], v3 offset:57344
ds_read_b64_tr_b16 v[106:107], v3 offset:58368
s_add_u32 m0, s23, 41984
s_nop 0
buffer_load_dwordx4 v12, s[52:55], s22 offen lds
s_add_u32 s22, s22, 131072
s_waitcnt lgkmcnt(6)
v_mfma_f32_32x32x16_bf16 v[132:147], v[108:111], v[48:51], v[132:147]
ds_read_b64_tr_b16 v[108:109], v2 offset:59392
ds_read_b64_tr_b16 v[110:111], v2 offset:60416
s_waitcnt lgkmcnt(6)
v_mfma_f32_32x32x16_bf16 v[148:163], v[112:115], v[48:51], v[148:163]
ds_read_b64_tr_b16 v[112:113], v3 offset:59392
ds_read_b64_tr_b16 v[114:115], v3 offset:60416
s_waitcnt vmcnt(20)
s_waitcnt lgkmcnt(6)
v_mfma_f32_32x32x16_bf16 v[132:147], v[100:103], v[52:55], v[132:147]
ds_read_b64_tr_b16 v[100:101], v2 offset:61440
ds_read_b64_tr_b16 v[102:103], v2 offset:62464
buffer_load_dwordx4 v[36:39], v10, s[8:11], s21 offen offset:0 sc1
s_waitcnt lgkmcnt(6)
v_mfma_f32_32x32x16_bf16 v[148:163], v[104:107], v[52:55], v[148:163]
ds_read_b64_tr_b16 v[104:105], v3 offset:61440
ds_read_b64_tr_b16 v[106:107], v3 offset:62464
buffer_load_dwordx4 v[40:43], v10, s[8:11], s21 offen offset:1024 sc1
s_waitcnt lgkmcnt(6)
v_mfma_f32_32x32x16_bf16 v[132:147], v[108:111], v[56:59], v[132:147]
ds_read_b64_tr_b16 v[108:109], v2 offset:63488
ds_read_b64_tr_b16 v[110:111], v2 offset:64512
buffer_load_dwordx4 v[44:47], v10, s[8:11], s21 offen offset:2048 sc1
s_waitcnt lgkmcnt(6)
v_mfma_f32_32x32x16_bf16 v[148:163], v[112:115], v[56:59], v[148:163]
ds_read_b64_tr_b16 v[112:113], v3 offset:63488
ds_read_b64_tr_b16 v[114:115], v3 offset:64512
buffer_load_dwordx4 v[48:51], v10, s[8:11], s21 offen offset:3072 sc1
s_add_u32 s21, s21, 4096
s_barrier
s_waitcnt lgkmcnt(6)
v_mfma_f32_32x32x16_bf16 v[132:147], v[100:103], v[60:63], v[132:147]
ds_read_b64_tr_b16 v[100:101], v13 offset:0
ds_read_b64_tr_b16 v[102:103], v13 offset:1024
s_add_u32 m0, s23, 49152
s_nop 0
buffer_load_dwordx4 v11, s[52:55], s22 offen lds
s_waitcnt lgkmcnt(6)
v_mfma_f32_32x32x16_bf16 v[148:163], v[104:107], v[60:63], v[148:163]
ds_read_b64_tr_b16 v[104:105], v14 offset:0
ds_read_b64_tr_b16 v[106:107], v14 offset:1024
s_add_u32 m0, s23, 50176
s_nop 0
buffer_load_dwordx4 v12, s[52:55], s22 offen lds
s_add_u32 s22, s22, 131072
s_waitcnt lgkmcnt(6)
v_mfma_f32_32x32x16_bf16 v[132:147], v[108:111], v[64:67], v[132:147]
ds_read_b64_tr_b16 v[108:109], v13 offset:2048
ds_read_b64_tr_b16 v[110:111], v13 offset:3072
s_waitcnt lgkmcnt(6)
v_mfma_f32_32x32x16_bf16 v[148:163], v[112:115], v[64:67], v[148:163]
ds_read_b64_tr_b16 v[112:113], v14 offset:2048
ds_read_b64_tr_b16 v[114:115], v14 offset:3072
s_waitcnt vmcnt(20)
s_waitcnt lgkmcnt(6)
v_mfma_f32_32x32x16_bf16 v[132:147], v[100:103], v[68:71], v[132:147]
ds_read_b64_tr_b16 v[100:101], v13 offset:4096
ds_read_b64_tr_b16 v[102:103], v13 offset:5120
buffer_load_dwordx4 v[52:55], v10, s[8:11], s21 offen offset:0 sc1
s_waitcnt lgkmcnt(6)
v_mfma_f32_32x32x16_bf16 v[148:163], v[104:107], v[68:71], v[148:163]
ds_read_b64_tr_b16 v[104:105], v14 offset:4096
ds_read_b64_tr_b16 v[106:107], v14 offset:5120
buffer_load_dwordx4 v[56:59], v10, s[8:11], s21 offen offset:1024 sc1
s_waitcnt lgkmcnt(6)
v_mfma_f32_32x32x16_bf16 v[132:147], v[108:111], v[72:75], v[132:147]
ds_read_b64_tr_b16 v[108:109], v13 offset:6144
ds_read_b64_tr_b16 v[110:111], v13 offset:7168
buffer_load_dwordx4 v[60:63], v10, s[8:11], s21 offen offset:2048 sc1
s_waitcnt lgkmcnt(6)
v_mfma_f32_32x32x16_bf16 v[148:163], v[112:115], v[72:75], v[148:163]
ds_read_b64_tr_b16 v[112:113], v14 offset:6144
ds_read_b64_tr_b16 v[114:115], v14 offset:7168
buffer_load_dwordx4 v[64:67], v10, s[8:11], s21 offen offset:3072 sc1
s_add_u32 s21, s21, 4096
s_waitcnt vmcnt(40)
s_barrier
s_waitcnt lgkmcnt(6)
v_mfma_f32_32x32x16_bf16 v[132:147], v[100:103], v[76:79], v[132:147]
ds_read_b64_tr_b16 v[100:101], v2 offset:0
ds_read_b64_tr_b16 v[102:103], v2 offset:1024
s_waitcnt lgkmcnt(6)
v_mfma_f32_32x32x16_bf16 v[148:163], v[104:107], v[76:79], v[148:163]
ds_read_b64_tr_b16 v[104:105], v3 offset:0
ds_read_b64_tr_b16 v[106:107], v3 offset:1024
s_waitcnt lgkmcnt(6)
v_mfma_f32_32x32x16_bf16 v[132:147], v[108:111], v[80:83], v[132:147]
ds_read_b64_tr_b16 v[108:109], v2 offset:2048
ds_read_b64_tr_b16 v[110:111], v2 offset:3072
s_waitcnt lgkmcnt(6)
v_mfma_f32_32x32x16_bf16 v[148:163], v[112:115], v[80:83], v[148:163]
ds_read_b64_tr_b16 v[112:113], v3 offset:2048
ds_read_b64_tr_b16 v[114:115], v3 offset:3072
s_waitcnt vmcnt(18)
s_waitcnt lgkmcnt(6)
v_mfma_f32_32x32x16_bf16 v[132:147], v[100:103], v[84:87], v[132:147]
ds_read_b64_tr_b16 v[100:101], v2 offset:4096
ds_read_b64_tr_b16 v[102:103], v2 offset:5120
buffer_load_dwordx4 v[68:71], v10, s[8:11], s21 offen offset:0 sc1
s_waitcnt lgkmcnt(6)
v_mfma_f32_32x32x16_bf16 v[148:163], v[104:107], v[84:87], v[148:163]
ds_read_b64_tr_b16 v[104:105], v3 offset:4096
ds_read_b64_tr_b16 v[106:107], v3 offset:5120
buffer_load_dwordx4 v[72:75], v10, s[8:11], s21 offen offset:1024 sc1
s_waitcnt lgkmcnt(6)
v_mfma_f32_32x32x16_bf16 v[132:147], v[108:111], v[88:91], v[132:147]
ds_read_b64_tr_b16 v[108:109], v2 offset:6144
ds_read_b64_tr_b16 v[110:111], v2 offset:7168
buffer_load_dwordx4 v[76:79], v10, s[8:11], s21 offen offset:2048 sc1
s_waitcnt lgkmcnt(6)
v_mfma_f32_32x32x16_bf16 v[148:163], v[112:115], v[88:91], v[148:163]
ds_read_b64_tr_b16 v[112:113], v3 offset:6144
ds_read_b64_tr_b16 v[114:115], v3 offset:7168
buffer_load_dwordx4 v[80:83], v10, s[8:11], s21 offen offset:3072 sc1
s_add_u32 s21, s21, 4096
s_waitcnt vmcnt(38)
s_barrier
s_waitcnt lgkmcnt(6)
v_mfma_f32_32x32x16_bf16 v[132:147], v[100:103], v[92:95], v[132:147]
ds_read_b64_tr_b16 v[100:101], v2 offset:8192
ds_read_b64_tr_b16 v[102:103], v2 offset:9216
s_waitcnt lgkmcnt(6)
v_mfma_f32_32x32x16_bf16 v[148:163], v[104:107], v[92:95], v[148:163]
ds_read_b64_tr_b16 v[104:105], v3 offset:8192
ds_read_b64_tr_b16 v[106:107], v3 offset:9216
s_waitcnt lgkmcnt(6)
v_mfma_f32_32x32x16_bf16 v[132:147], v[108:111], v[96:99], v[132:147]
ds_read_b64_tr_b16 v[108:109], v2 offset:10240
ds_read_b64_tr_b16 v[110:111], v2 offset:11264
s_waitcnt lgkmcnt(6)
v_mfma_f32_32x32x16_bf16 v[148:163], v[112:115], v[96:99], v[148:163]
ds_read_b64_tr_b16 v[112:113], v3 offset:10240
ds_read_b64_tr_b16 v[114:115], v3 offset:11264
s_waitcnt vmcnt(16)
s_waitcnt lgkmcnt(6)
v_mfma_f32_32x32x16_bf16 v[132:147], v[100:103], v[20:23], v[132:147]
ds_read_b64_tr_b16 v[100:101], v2 offset:12288
ds_read_b64_tr_b16 v[102:103], v2 offset:13312
buffer_load_dwordx4 v[84:87], v10, s[8:11], s21 offen offset:0 sc1
s_waitcnt lgkmcnt(6)
v_mfma_f32_32x32x16_bf16 v[148:163], v[104:107], v[20:23], v[148:163]
ds_read_b64_tr_b16 v[104:105], v3 offset:12288
ds_read_b64_tr_b16 v[106:107], v3 offset:13312
buffer_load_dwordx4 v[88:91], v10, s[8:11], s21 offen offset:1024 sc1
s_waitcnt lgkmcnt(6)
v_mfma_f32_32x32x16_bf16 v[132:147], v[108:111], v[24:27], v[132:147]
ds_read_b64_tr_b16 v[108:109], v2 offset:14336
ds_read_b64_tr_b16 v[110:111], v2 offset:15360
buffer_load_dwordx4 v[92:95], v10, s[8:11], s21 offen offset:2048 sc1
s_waitcnt lgkmcnt(6)
v_mfma_f32_32x32x16_bf16 v[148:163], v[112:115], v[24:27], v[148:163]
ds_read_b64_tr_b16 v[112:113], v3 offset:14336
ds_read_b64_tr_b16 v[114:115], v3 offset:15360
buffer_load_dwordx4 v[96:99], v10, s[8:11], s21 offen offset:3072 sc1
s_add_u32 s21, s21, 4096
s_waitcnt vmcnt(36)
s_barrier
s_waitcnt lgkmcnt(6)
v_mfma_f32_32x32x16_bf16 v[132:147], v[100:103], v[28:31], v[132:147]
ds_read_b64_tr_b16 v[100:101], v2 offset:16384
ds_read_b64_tr_b16 v[102:103], v2 offset:17408
s_waitcnt lgkmcnt(6)
v_mfma_f32_32x32x16_bf16 v[148:163], v[104:107], v[28:31], v[148:163]
ds_read_b64_tr_b16 v[104:105], v3 offset:16384
ds_read_b64_tr_b16 v[106:107], v3 offset:17408
s_waitcnt lgkmcnt(6)
v_mfma_f32_32x32x16_bf16 v[132:147], v[108:111], v[32:35], v[132:147]
ds_read_b64_tr_b16 v[108:109], v2 offset:18432
ds_read_b64_tr_b16 v[110:111], v2 offset:19456
s_waitcnt lgkmcnt(6)
v_mfma_f32_32x32x16_bf16 v[148:163], v[112:115], v[32:35], v[148:163]
ds_read_b64_tr_b16 v[112:113], v3 offset:18432
ds_read_b64_tr_b16 v[114:115], v3 offset:19456
s_waitcnt vmcnt(14)
s_waitcnt lgkmcnt(6)
v_mfma_f32_32x32x16_bf16 v[132:147], v[100:103], v[36:39], v[132:147]
ds_read_b64_tr_b16 v[100:101], v2 offset:20480
ds_read_b64_tr_b16 v[102:103], v2 offset:21504
buffer_load_dwordx4 v[20:23], v10, s[8:11], s21 offen offset:0 sc1
s_waitcnt lgkmcnt(6)
v_mfma_f32_32x32x16_bf16 v[148:163], v[104:107], v[36:39], v[148:163]
ds_read_b64_tr_b16 v[104:105], v3 offset:20480
ds_read_b64_tr_b16 v[106:107], v3 offset:21504
buffer_load_dwordx4 v[24:27], v10, s[8:11], s21 offen offset:1024 sc1
s_waitcnt lgkmcnt(6)
v_mfma_f32_32x32x16_bf16 v[132:147], v[108:111], v[40:43], v[132:147]
ds_read_b64_tr_b16 v[108:109], v2 offset:22528
ds_read_b64_tr_b16 v[110:111], v2 offset:23552
buffer_load_dwordx4 v[28:31], v10, s[8:11], s21 offen offset:2048 sc1
s_waitcnt lgkmcnt(6)
v_mfma_f32_32x32x16_bf16 v[148:163], v[112:115], v[40:43], v[148:163]
ds_read_b64_tr_b16 v[112:113], v3 offset:22528
ds_read_b64_tr_b16 v[114:115], v3 offset:23552
buffer_load_dwordx4 v[32:35], v10, s[8:11], s21 offen offset:3072 sc1
s_add_u32 s21, s21, 4096
s_waitcnt vmcnt(34)
s_barrier
s_waitcnt lgkmcnt(6)
v_mfma_f32_32x32x16_bf16 v[132:147], v[100:103], v[44:47], v[132:147]
ds_read_b64_tr_b16 v[100:101], v2 offset:24576
ds_read_b64_tr_b16 v[102:103], v2 offset:25600
s_waitcnt lgkmcnt(6)
v_mfma_f32_32x32x16_bf16 v[148:163], v[104:107], v[44:47], v[148:163]
ds_read_b64_tr_b16 v[104:105], v3 offset:24576
ds_read_b64_tr_b16 v[106:107], v3 offset:25600
s_waitcnt lgkmcnt(6)
v_mfma_f32_32x32x16_bf16 v[132:147], v[108:111], v[48:51], v[132:147]
ds_read_b64_tr_b16 v[108:109], v2 offset:26624
ds_read_b64_tr_b16 v[110:111], v2 offset:27648
s_waitcnt lgkmcnt(6)
v_mfma_f32_32x32x16_bf16 v[148:163], v[112:115], v[48:51], v[148:163]
ds_read_b64_tr_b16 v[112:113], v3 offset:26624
ds_read_b64_tr_b16 v[114:115], v3 offset:27648
s_waitcnt vmcnt(12)
s_waitcnt lgkmcnt(6)
v_mfma_f32_32x32x16_bf16 v[132:147], v[100:103], v[52:55], v[132:147]
ds_read_b64_tr_b16 v[100:101], v2 offset:28672
ds_read_b64_tr_b16 v[102:103], v2 offset:29696
s_waitcnt lgkmcnt(6)
v_mfma_f32_32x32x16_bf16 v[148:163], v[104:107], v[52:55], v[148:163]
ds_read_b64_tr_b16 v[104:105], v3 offset:28672
ds_read_b64_tr_b16 v[106:107], v3 offset:29696
s_waitcnt lgkmcnt(6)
v_mfma_f32_32x32x16_bf16 v[132:147], v[108:111], v[56:59], v[132:147]
ds_read_b64_tr_b16 v[108:109], v2 offset:30720
ds_read_b64_tr_b16 v[110:111], v2 offset:31744
s_waitcnt lgkmcnt(6)
v_mfma_f32_32x32x16_bf16 v[148:163], v[112:115], v[56:59], v[148:163]
ds_read_b64_tr_b16 v[112:113], v3 offset:30720
ds_read_b64_tr_b16 v[114:115], v3 offset:31744
s_waitcnt vmcnt(28)
s_barrier
s_waitcnt lgkmcnt(6)
v_mfma_f32_32x32x16_bf16 v[132:147], v[100:103], v[60:63], v[132:147]
ds_read_b64_tr_b16 v[100:101], v2 offset:32768
ds_read_b64_tr_b16 v[102:103], v2 offset:33792
s_waitcnt lgkmcnt(6)
v_mfma_f32_32x32x16_bf16 v[148:163], v[104:107], v[60:63], v[148:163]
ds_read_b64_tr_b16 v[104:105], v3 offset:32768
ds_read_b64_tr_b16 v[106:107], v3 offset:33792
s_waitcnt lgkmcnt(6)
v_mfma_f32_32x32x16_bf16 v[132:147], v[108:111], v[64:67], v[132:147]
ds_read_b64_tr_b16 v[108:109], v2 offset:34816
ds_read_b64_tr_b16 v[110:111], v2 offset:35840
s_waitcnt lgkmcnt(6)
v_mfma_f32_32x32x16_bf16 v[148:163], v[112:115], v[64:67], v[148:163]
ds_read_b64_tr_b16 v[112:113], v3 offset:34816
ds_read_b64_tr_b16 v[114:115], v3 offset:35840
s_waitcnt vmcnt(8)
s_waitcnt lgkmcnt(6)
v_mfma_f32_32x32x16_bf16 v[132:147], v[100:103], v[68:71], v[132:147]
ds_read_b64_tr_b16 v[100:101], v2 offset:36864
ds_read_b64_tr_b16 v[102:103], v2 offset:37888
s_waitcnt lgkmcnt(6)
v_mfma_f32_32x32x16_bf16 v[148:163], v[104:107], v[68:71], v[148:163]
ds_read_b64_tr_b16 v[104:105], v3 offset:36864
ds_read_b64_tr_b16 v[106:107], v3 offset:37888
s_waitcnt lgkmcnt(6)
v_mfma_f32_32x32x16_bf16 v[132:147], v[108:111], v[72:75], v[132:147]
ds_read_b64_tr_b16 v[108:109], v2 offset:38912
ds_read_b64_tr_b16 v[110:111], v2 offset:39936
s_waitcnt lgkmcnt(6)
v_mfma_f32_32x32x16_bf16 v[148:163], v[112:115], v[72:75], v[148:163]
ds_read_b64_tr_b16 v[112:113], v3 offset:38912
ds_read_b64_tr_b16 v[114:115], v3 offset:39936
s_waitcnt vmcnt(22)
s_barrier
s_waitcnt lgkmcnt(6)
v_mfma_f32_32x32x16_bf16 v[132:147], v[100:103], v[76:79], v[132:147]
ds_read_b64_tr_b16 v[100:101], v2 offset:40960
ds_read_b64_tr_b16 v[102:103], v2 offset:41984
s_waitcnt lgkmcnt(6)
v_mfma_f32_32x32x16_bf16 v[148:163], v[104:107], v[76:79], v[148:163]
ds_read_b64_tr_b16 v[104:105], v3 offset:40960
ds_read_b64_tr_b16 v[106:107], v3 offset:41984
s_waitcnt lgkmcnt(6)
v_mfma_f32_32x32x16_bf16 v[132:147], v[108:111], v[80:83], v[132:147]
ds_read_b64_tr_b16 v[108:109], v2 offset:43008
ds_read_b64_tr_b16 v[110:111], v2 offset:44032
s_waitcnt lgkmcnt(6)
v_mfma_f32_32x32x16_bf16 v[148:163], v[112:115], v[80:83], v[148:163]
ds_read_b64_tr_b16 v[112:113], v3 offset:43008
ds_read_b64_tr_b16 v[114:115], v3 offset:44032
s_waitcnt vmcnt(4)
s_waitcnt lgkmcnt(6)
v_mfma_f32_32x32x16_bf16 v[132:147], v[100:103], v[84:87], v[132:147]
ds_read_b64_tr_b16 v[100:101], v2 offset:45056
ds_read_b64_tr_b16 v[102:103], v2 offset:46080
s_waitcnt lgkmcnt(6)
v_mfma_f32_32x32x16_bf16 v[148:163], v[104:107], v[84:87], v[148:163]
ds_read_b64_tr_b16 v[104:105], v3 offset:45056
ds_read_b64_tr_b16 v[106:107], v3 offset:46080
s_waitcnt lgkmcnt(6)
v_mfma_f32_32x32x16_bf16 v[132:147], v[108:111], v[88:91], v[132:147]
ds_read_b64_tr_b16 v[108:109], v2 offset:47104
ds_read_b64_tr_b16 v[110:111], v2 offset:48128
s_waitcnt lgkmcnt(6)
v_mfma_f32_32x32x16_bf16 v[148:163], v[112:115], v[88:91], v[148:163]
ds_read_b64_tr_b16 v[112:113], v3 offset:47104
ds_read_b64_tr_b16 v[114:115], v3 offset:48128
s_waitcnt vmcnt(16)
s_barrier
s_waitcnt lgkmcnt(6)
v_mfma_f32_32x32x16_bf16 v[132:147], v[100:103], v[92:95], v[132:147]
ds_read_b64_tr_b16 v[100:101], v2 offset:49152
ds_read_b64_tr_b16 v[102:103], v2 offset:50176
s_waitcnt lgkmcnt(6)
v_mfma_f32_32x32x16_bf16 v[148:163], v[104:107], v[92:95], v[148:163]
ds_read_b64_tr_b16 v[104:105], v3 offset:49152
ds_read_b64_tr_b16 v[106:107], v3 offset:50176
s_waitcnt lgkmcnt(6)
v_mfma_f32_32x32x16_bf16 v[132:147], v[108:111], v[96:99], v[132:147]
ds_read_b64_tr_b16 v[108:109], v2 offset:51200
ds_read_b64_tr_b16 v[110:111], v2 offset:52224
s_waitcnt lgkmcnt(6)
v_mfma_f32_32x32x16_bf16 v[148:163], v[112:115], v[96:99], v[148:163]
ds_read_b64_tr_b16 v[112:113], v3 offset:51200
ds_read_b64_tr_b16 v[114:115], v3 offset:52224
s_waitcnt vmcnt(0)
s_waitcnt lgkmcnt(6)
v_mfma_f32_32x32x16_bf16 v[132:147], v[100:103], v[20:23], v[132:147]
ds_read_b64_tr_b16 v[100:101], v2 offset:53248
ds_read_b64_tr_b16 v[102:103], v2 offset:54272
s_waitcnt lgkmcnt(6)
v_mfma_f32_32x32x16_bf16 v[148:163], v[104:107], v[20:23], v[148:163]
ds_read_b64_tr_b16 v[104:105], v3 offset:53248
ds_read_b64_tr_b16 v[106:107], v3 offset:54272
s_waitcnt lgkmcnt(6)
v_mfma_f32_32x32x16_bf16 v[132:147], v[108:111], v[24:27], v[132:147]
ds_read_b64_tr_b16 v[108:109], v2 offset:55296
ds_read_b64_tr_b16 v[110:111], v2 offset:56320
s_waitcnt lgkmcnt(6)
v_mfma_f32_32x32x16_bf16 v[148:163], v[112:115], v[24:27], v[148:163]
ds_read_b64_tr_b16 v[112:113], v3 offset:55296
ds_read_b64_tr_b16 v[114:115], v3 offset:56320
s_waitcnt lgkmcnt(6)
v_mfma_f32_32x32x16_bf16 v[132:147], v[100:103], v[28:31], v[132:147]
s_waitcnt lgkmcnt(4)
v_mfma_f32_32x32x16_bf16 v[148:163], v[104:107], v[28:31], v[148:163]
s_waitcnt lgkmcnt(2)
v_mfma_f32_32x32x16_bf16 v[132:147], v[108:111], v[32:35], v[132:147]
s_waitcnt lgkmcnt(0)
v_mfma_f32_32x32x16_bf16 v[148:163], v[112:115], v[32:35], v[148:163]
s_barrier
s_nop 15
ds_write_b128 v7, v[132:135] offset:0
ds_write_b128 v7, v[136:139] offset:32
ds_write_b128 v7, v[140:143] offset:64
ds_write_b128 v7, v[144:147] offset:96
ds_write_b128 v7, v[148:151] offset:128
ds_write_b128 v7, v[152:155] offset:160
ds_write_b128 v7, v[156:159] offset:192
ds_write_b128 v7, v[160:163] offset:224
s_waitcnt lgkmcnt(0)
ds_read_b128 v[20:23], v8 offset:0
ds_read_b128 v[24:27], v8 offset:16
ds_read_b128 v[28:31], v8 offset:2176
ds_read_b128 v[32:35], v8 offset:2192
ds_read_b128 v[36:39], v8 offset:4352
ds_read_b128 v[40:43], v8 offset:4368
ds_read_b128 v[44:47], v8 offset:6528
ds_read_b128 v[48:51], v8 offset:6544
s_mov_b32 s26, 0xffff0000
v_lshlrev_b32 v52, 16, v232
v_and_b32 v53, s26, v232
v_lshlrev_b32 v54, 16, v233
v_and_b32 v55, s26, v233
v_lshlrev_b32 v56, 16, v234
v_and_b32 v57, s26, v234
v_lshlrev_b32 v58, 16, v235
v_and_b32 v59, s26, v235
v_lshlrev_b32 v60, 16, v236
v_and_b32 v61, s26, v236
v_lshlrev_b32 v62, 16, v237
v_and_b32 v63, s26, v237
v_lshlrev_b32 v64, 16, v238
v_and_b32 v65, s26, v238
v_lshlrev_b32 v66, 16, v239
v_and_b32 v67, s26, v239
v_lshlrev_b32 v68, 16, v240
v_and_b32 v69, s26, v240
v_lshlrev_b32 v70, 16, v241
v_and_b32 v71, s26, v241
v_lshlrev_b32 v72, 16, v242
v_and_b32 v73, s26, v242
v_lshlrev_b32 v74, 16, v243
v_and_b32 v75, s26, v243
v_lshlrev_b32 v76, 16, v244
v_and_b32 v77, s26, v244
v_lshlrev_b32 v78, 16, v245
v_and_b32 v79, s26, v245
v_lshlrev_b32 v80, 16, v246
v_and_b32 v81, s26, v246
v_lshlrev_b32 v82, 16, v247
v_and_b32 v83, s26, v247
s_waitcnt lgkmcnt(0)
v_pk_add_f32 v[20:21], v[20:21], v[52:53]
v_pk_add_f32 v[22:23], v[22:23], v[54:55]
v_pk_add_f32 v[24:25], v[24:25], v[56:57]
v_pk_add_f32 v[26:27], v[26:27], v[58:59]
v_pk_add_f32 v[28:29], v[28:29], v[60:61]
v_pk_add_f32 v[30:31], v[30:31], v[62:63]
v_pk_add_f32 v[32:33], v[32:33], v[64:65]
v_pk_add_f32 v[34:35], v[34:35], v[66:67]
v_pk_add_f32 v[36:37], v[36:37], v[68:69]
v_pk_add_f32 v[38:39], v[38:39], v[70:71]
v_pk_add_f32 v[40:41], v[40:41], v[72:73]
v_pk_add_f32 v[42:43], v[42:43], v[74:75]
v_pk_add_f32 v[44:45], v[44:45], v[76:77]
v_pk_add_f32 v[46:47], v[46:47], v[78:79]
v_pk_add_f32 v[48:49], v[48:49], v[80:81]
v_pk_add_f32 v[50:51], v[50:51], v[82:83]
v_cvt_pk_bf16_f32 v232, v20, v21
v_cvt_pk_bf16_f32 v233, v22, v23
v_cvt_pk_bf16_f32 v234, v24, v25
v_cvt_pk_bf16_f32 v235, v26, v27
v_cvt_pk_bf16_f32 v236, v28, v29
v_cvt_pk_bf16_f32 v237, v30, v31
v_cvt_pk_bf16_f32 v238, v32, v33
v_cvt_pk_bf16_f32 v239, v34, v35
v_cvt_pk_bf16_f32 v240, v36, v37
v_cvt_pk_bf16_f32 v241, v38, v39
v_cvt_pk_bf16_f32 v242, v40, v41
v_cvt_pk_bf16_f32 v243, v42, v43
v_cvt_pk_bf16_f32 v244, v44, v45
v_cvt_pk_bf16_f32 v245, v46, v47
v_cvt_pk_bf16_f32 v246, v48, v49
v_cvt_pk_bf16_f32 v247, v50, v51
buffer_store_dwordx4 v[232:235], v6, s[60:63], s68 offen
buffer_store_dwordx4 v[236:239], v6, s[60:63], s69 offen
buffer_store_dwordx4 v[240:243], v6, s[60:63], s70 offen
buffer_store_dwordx4 v[244:247], v6, s[60:63], s71 offen
s_endpgm
L_k2_done:
s_endpgm
.section .rodata,"a"
.p2align 6
.amdhsa_kernel ln_kernel
  .amdhsa_next_free_vgpr 112
  .amdhsa_next_free_sgpr 64
  .amdhsa_accum_offset 112
  .amdhsa_group_segment_fixed_size 0
  .amdhsa_kernarg_size 80
  .amdhsa_user_sgpr_count 2
  .amdhsa_user_sgpr_kernarg_segment_ptr 1
  .amdhsa_system_sgpr_workgroup_id_x 1
.end_amdhsa_kernel
.p2align 6
.amdhsa_kernel gemm1_kernel
  .amdhsa_next_free_vgpr 256
  .amdhsa_next_free_sgpr 102
  .amdhsa_accum_offset 256
  .amdhsa_group_segment_fixed_size 0
  .amdhsa_kernarg_size 80
  .amdhsa_user_sgpr_count 2
  .amdhsa_user_sgpr_kernarg_segment_ptr 1
  .amdhsa_system_sgpr_workgroup_id_x 1
.end_amdhsa_kernel
.p2align 6
.amdhsa_kernel attn_kernel
  .amdhsa_next_free_vgpr 256
  .amdhsa_next_free_sgpr 80
  .amdhsa_accum_offset 256
  .amdhsa_group_segment_fixed_size 0
  .amdhsa_kernarg_size 80
  .amdhsa_user_sgpr_count 2
  .amdhsa_user_sgpr_kernarg_segment_ptr 1
  .amdhsa_system_sgpr_workgroup_id_x 1
.end_amdhsa_kernel
```
